```python
import torch

def _softmax(x, axis=-1):
    return torch.softmax(x, dim=axis)
def _gelu(x):
    return torch.nn.functional.gelu(x, approximate="tanh")
def _silu(x):
    return torch.nn.functional.silu(x)
def _sigmoid(x):
    return torch.sigmoid(x)
def _layernorm(x, axis=-1, eps=1e-5):
    m = x.mean(dim=axis, keepdim=True)
    v = x.var(dim=axis, keepdim=True, unbiased=False)
    return (x - m) / torch.sqrt(v + eps)
def _scatter_add(tgt, idx, src, axis=0):
    return tgt.clone().index_add_(axis, idx, src)
def _segment_sum(src, seg, n):
    out = torch.zeros((n,) + src.shape[1:], dtype=src.dtype)
    return out.index_add_(0, seg, src)
def _pad(x, pw):
    flat = tuple(v for pair in reversed(pw) for v in pair)
    return torch.nn.functional.pad(x, flat)

kernel_name = 'sequential_preLN__sliding_block__glu_gated_reglu__prompt'

def setup_inputs():

    _w = (lambda a: (lambda t: t.to(torch.bfloat16) if t.is_floating_point() else t)(torch.as_tensor(a)))
    def _A_setup():
        B, S, D = 1, 2048, 640
        return {
            "x": _w((lambda *s: torch.randn(*s, dtype=torch.bfloat16) * 0.05)(B, S, D)),
            "wqkv": _w((lambda *s: torch.randn(*s, dtype=torch.bfloat16) * 0.05)(D, 3 * D)),
            "wo": _w((lambda *s: torch.randn(*s, dtype=torch.bfloat16) * 0.05)(D, D)),
        }
    _A_in = _A_setup()

    def _B_setup():
        B, S, D, F = 1, 2048, 640, 1728
        return {
            "x": _w((lambda *s: torch.randn(*s, dtype=torch.bfloat16) * 0.05)(B, S, D)),
            "W_gate": _w((lambda *s: torch.randn(*s, dtype=torch.bfloat16) * 0.8)(D, F) * (2.0 / D) ** 0.5),
            "W_up": _w((lambda *s: torch.randn(*s, dtype=torch.bfloat16) * 0.8)(D, F) * (2.0 / D) ** 0.5),
            "W_down": _w((lambda *s: torch.randn(*s, dtype=torch.bfloat16) * 0.8)(F, D) * (1.0 / F) ** 0.5),
        }
    _B_in = _B_setup()

    return {
        "A_x": _A_in["x"],
        "A_wqkv": _A_in["wqkv"],
        "A_wo": _A_in["wo"],
        "B_x": _B_in["x"],
        "B_W_gate": _B_in["W_gate"],
        "B_W_up": _B_in["W_up"],
        "B_W_down": _B_in["W_down"],
    }

def reference(A_x, A_wqkv, A_wo, B_x, B_W_gate, B_W_up, B_W_down):
    def _A_ref(x, wqkv, wo):
        B, S, D = x.shape
        H = 32; Dh = D // H; W = 256
        qkv = (lambda x, *d: x.permute(*d))((x @ wqkv).reshape(B, S, 3, H, Dh), 2, 0, 3, 1, 4)
        q, k, v = qkv[0], qkv[1], qkv[2]
        scores = torch.einsum("bhqd,bhkd->bhqk", q, k) * (Dh ** -0.5)
        idx = torch.arange(S)
        mask = (idx[:, None] - idx[None, :] >= 0) & (idx[:, None] - idx[None, :] < W)
        scores = torch.where(mask[None, None], scores, -1e9)
        p = _softmax(scores, axis=-1)
        o = torch.einsum("bhqk,bhkd->bhqd", p, v)
        return (lambda x, *d: x.permute(*d))(o, 0, 2, 1, 3).reshape(B, S, D) @ wo

    def _B_ref(x, W_gate, W_up, W_down):
        gate = torch.einsum("bsd,df->bsf", x, W_gate)
        up = torch.einsum("bsd,df->bsf", x, W_up)
        gate = gate * (lambda x, dt: x.to(dt))(gate > 0, gate.dtype)
        h = gate * up
        return torch.einsum("bsf,fd->bsd", h, W_down)

    x = A_x
    h = x + _A_ref(_layernorm(x, axis=-1), A_wqkv, A_wo)
    h2 = h + _B_ref(_layernorm(h, axis=-1), B_W_gate, B_W_up, B_W_down)
    return h2
```

```asm
; @launch grid=(256,1,1) block=(512,1,1) lds=163840
.amdgcn_target "amdgcn-amd-amdhsa--gfx950"
.text
.globl sequential_preLN__sliding_block__glu_gated_reglu__prompt_kernel
.p2align 12
.type sequential_preLN__sliding_block__glu_gated_reglu__prompt_kernel,@function
sequential_preLN__sliding_block__glu_gated_reglu__prompt_kernel:
    s_cmp_ge_u32 s2, 256
    s_cbranch_scc1 sequential_preLN__sliding_block__glu_gated_reglu__prompt_kernel_done
    s_load_dwordx16 s[64:79], s[0:1], 0
    s_load_dwordx4 s[80:83], s[0:1], 64
    v_lshrrev_b32 v1, 6, v0
    s_nop 0
    v_readfirstlane_b32 s3, v1
    v_and_b32 v1, 63, v0
    s_mov_b32 s87, 1500000
    s_cmp_lg_u32 s3, 0
    s_cbranch_scc1 k1_nopf
    s_getpc_b64 s[28:29]
    s_bfe_u32 s30, s2, 0x40003
    s_lshl_b32 s30, s30, 10
    v_lshl_add_u32 v2, v1, 4, s30
    global_load_dwordx4 v[196:199], v2, s[28:29]
k1_nopf:
    s_and_b32 s4, s2, 1
    s_lshl_b32 s4, s4, 3
    s_lshr_b32 s5, s2, 5
    s_add_u32 s4, s4, s5
    s_bfe_u32 s5, s2, 0x20001
    s_lshl_b32 s5, s5, 2
    s_bfe_u32 s6, s2, 0x20003
    s_add_u32 s5, s5, s6
    s_and_b32 s7, s3, 3
    s_cmp_eq_u32 s4, 15
    s_cbranch_scc1 k1_spare
    s_cmp_lt_u32 s3, 4
    s_cbranch_scc1 k1_compute
    s_lshr_b32 s30, s2, 5
    s_mul_i32 s31, s30, 11
    s_lshr_b32 s31, s31, 5
    s_and_b32 s32, s2, 1
    s_sub_u32 s31, s32, s31
    s_mul_i32 s31, s31, 3
    s_add_u32 s30, s30, s31
    s_lshr_b32 s31, s5, 2
    s_add_u32 s30, s30, s31
    s_and_b32 s31, s5, 1
    s_add_u32 s30, s30, s31
    s_sub_u32 s31, s30, 5
    s_cselect_b32 s30, s30, s31
    s_lshl_b32 s54, s30, 11
    s_lshl_b32 s30, s30, 1
    v_lshrrev_b32 v16, 4, v1
    v_and_b32 v17, 7, v1
    v_xor_b32 v17, v17, v16
    v_lshrrev_b32 v18, 3, v1
    v_mul_u32_u24 v18, 1280, v18
    v_lshl_add_u32 v20, v17, 4, v18
    v_xor_b32 v21, 64, v20
    v_add_u32 v21, 9216, v21
    v_add_u32 v22, 18432, v20
    v_add_u32 v23, 18432, v21
    v_and_b32 v17, 15, v1
    v_lshlrev_b32 v18, 1, v16
    v_xor_b32 v17, v17, v18
    v_mul_u32_u24 v18, 3840, v16
    v_lshl_add_u32 v24, v17, 4, v18
    v_add_u32 v25, 14336, v24
    v_xor_b32 v26, 128, v24
    v_add_u32 v26, 28672, v26
    v_add_u32 v27, 14336, v26
    s_lshl_b32 s34, s5, 2
    s_add_u32 s34, s34, s7
    s_mul_i32 s34, s34, 40960
    s_mul_i32 s35, s7, 61440
    s_lshl_b32 s28, s4, 8
    s_add_u32 s35, s35, s28
    s_lshl_b32 s36, s7, 12
    s_lshl_b32 s37, s30, 7
    s_add_u32 s37, s37, s34
    s_mul_i32 s38, s30, 245760
    s_add_u32 s38, s38, s35
    s_add_u32 s39, s34, 1280
    s_mov_b32 m0, s36
    s_waitcnt lgkmcnt(0)
    s_mov_b32 s8, s64
    s_mov_b32 s9, s65
    s_mov_b32 s10, 2621440
    s_mov_b32 s11, 0x00020000
    s_mov_b32 s12, s66
    s_mov_b32 s13, s67
    s_mov_b32 s14, 2457600
    s_mov_b32 s15, 0x00020000
    buffer_load_dwordx4 v20, s[8:11], s37 offen offset:0 lds
    buffer_load_dwordx4 v21, s[8:11], s37 offen offset:1024 lds
    buffer_load_dwordx4 v22, s[8:11], s37 offen offset:2048 lds
    buffer_load_dwordx4 v23, s[8:11], s37 offen offset:3072 lds
    s_add_u32 m0, s36, 16384
    s_add_u32 s37, s37, 128
    s_add_u32 s36, s36, 0x8000
    s_and_b32 s36, s36, 0x1ffff
    buffer_load_dwordx4 v24, s[12:15], s38 offen offset:0 lds
    buffer_load_dwordx4 v25, s[12:15], s38 offen offset:1024 lds
    buffer_load_dwordx4 v26, s[12:15], s38 offen offset:2048 lds
    buffer_load_dwordx4 v27, s[12:15], s38 offen offset:3072 lds
    s_mov_b32 m0, s36
    s_add_u32 s38, s38, 245760
    s_cmp_eq_u32 s37, s39
    s_cselect_b32 s37, s34, s37
    s_cselect_b32 s38, s35, s38
    buffer_load_dwordx4 v20, s[8:11], s37 offen offset:0 lds
    buffer_load_dwordx4 v21, s[8:11], s37 offen offset:1024 lds
    buffer_load_dwordx4 v22, s[8:11], s37 offen offset:2048 lds
    buffer_load_dwordx4 v23, s[8:11], s37 offen offset:3072 lds
    s_add_u32 m0, s36, 16384
    s_add_u32 s37, s37, 128
    s_add_u32 s36, s36, 0x8000
    s_and_b32 s36, s36, 0x1ffff
    buffer_load_dwordx4 v24, s[12:15], s38 offen offset:0 lds
    buffer_load_dwordx4 v25, s[12:15], s38 offen offset:1024 lds
    buffer_load_dwordx4 v26, s[12:15], s38 offen offset:2048 lds
    buffer_load_dwordx4 v27, s[12:15], s38 offen offset:3072 lds
    s_mov_b32 m0, s36
    s_add_u32 s38, s38, 245760
    s_cmp_eq_u32 s37, s39
    s_cselect_b32 s37, s34, s37
    s_cselect_b32 s38, s35, s38
    s_mov_b32 s16, s82
    s_mov_b32 s17, s83
    s_mov_b32 s18, 33554432
    s_mov_b32 s19, 0x00020000
    v_mov_b32 v40, 0
    v_and_b32 v2, 31, v1
    v_lshrrev_b32 v3, 5, v1
    v_bfe_u32 v4, v1, 1, 3
    v_xor_b32 v4, v4, v3
    v_lshlrev_b32 v4, 4, v4
    v_lshl_add_u32 v4, v2, 7, v4
    v_bfe_u32 v5, v1, 2, 2
    s_lshl_b32 s29, s7, 12
    v_add_u32 v180, s29, v4
    v_xor_b32 v181, 32, v180
    v_xor_b32 v182, 64, v180
    v_xor_b32 v183, 96, v180
    s_lshl_b32 s28, s7, 1
    v_bfe_u32 v7, v1, 4, 1
    v_add_u32 v7, s28, v7
    v_and_b32 v185, 15, v1
    v_lshlrev_b32 v185, 1, v185
    v_lshl_add_u32 v185, v7, 5, v185
    v_add_u32 v185, 81920, v185
    v_lshl_add_u32 v6, v3, 2, v5
    v_xor_b32 v7, v7, v6
    v_lshl_add_u32 v6, v3, 3, v5
    v_lshlrev_b32 v6, 8, v6
    v_lshl_add_u32 v184, v7, 5, v6
    v_and_b32 v7, 3, v1
    v_lshl_add_u32 v184, v7, 3, v184
    v_add_u32 v184, 16384, v184
    s_lshl_b32 s28, s7, 7
    s_add_u32 s28, s28, 159744
    v_lshl_add_u32 v186, v2, 2, s28
    s_cmp_lt_u32 s4, 5
    s_cselect_b32 s55, 0x3ea52b5c, 1.0
    v_add_u32 v189, -1, v3
    v_lshrrev_b32 v7, 2, v1
    v_lshrrev_b32 v6, 4, v1
    v_xor_b32 v7, v7, v6
    v_and_b32 v7, 1, v7
    v_add_u32 v7, -1, v7
    v_and_b32 v172, 0x3f803f80, v7
    v_and_b32 v173, 0x3f803f80, v7
    v_and_b32 v174, 0x3f803f80, v7
    v_and_b32 v175, 0x3f803f80, v7
    s_mul_i32 s28, s5, 10240
    s_add_u32 s28, s28, 8650752
    s_mul_i32 s29, s4, 10240
    s_add_u32 s29, s29, 9043968
    s_sub_u32 s28, s28, s29
    s_lshl_b32 s31, s7, 9
    s_add_u32 s29, s29, s31
    v_and_b32 v187, s28, v189
    v_lshl_add_u32 v187, v2, 4, v187
    v_add_u32 v187, s29, v187
    s_bitcmp1_b32 0x307, s4
    s_cselect_b32 s28, 0, 2146435072
    s_bitcmp1_b32 0x3111, s5
    s_cselect_b32 s29, 0, 2146435072
    s_xor_b32 s28, s28, s29
    v_and_b32 v188, s28, v189
    v_xor_b32 v188, s29, v188
    v_max_u32 v188, v188, v187
    v_mov_b32 v178, 0
    v_mov_b32 v179, 0
    s_getpc_b64 s[56:57]
k1_pc:
    s_add_u32 s56, s56, k2_setup-k1_pc
    s_addc_u32 s57, s57, 0
    s_lshr_b32 s28, s2, 3
    s_lshl_b32 s28, s28, 2
    s_add_u32 s28, s28, s7
    s_lshl_b32 s28, s28, 9
    s_min_u32 s28, s28, code_end-k2_setup-512
    v_lshl_add_u32 v44, v1, 3, s28
    s_mul_i32 s27, s7, 6144
    s_add_u32 s27, s27, 131072
    s_lshl_b32 s53, s7, 5
    s_lshr_b32 s28, s2, 3
    s_add_u32 s53, s53, s28
    s_cmp_lt_u32 s53, 1
    s_cselect_b32 s28, 0, 2146435072
    s_lshl_b32 s53, s53, 13
    s_and_b32 s29, s2, 7
    s_mul_i32 s29, s29, 1310720
    s_add_u32 s53, s53, s29
    s_add_u32 s53, s53, 13991936
    s_max_u32 s53, s53, s28
    v_lshlrev_b32 v38, 7, v1
    s_mul_i32 s40, s5, 15
    s_add_u32 s40, s40, s4
    s_sub_u32 s52, s40, 180
    s_cbranch_scc0 k1_setA
    s_and_b32 s47, s7, 1
    s_cmp_eq_u32 s47, 1
    s_cselect_b32 s48, s74, s72
    s_cselect_b32 s49, s75, s73
    s_mov_b32 s50, 2211840
    s_mov_b32 s51, 0x00020000
    s_mul_i32 s41, s40, 57
    s_lshr_b32 s41, s41, 9
    s_mul_i32 s44, s41, 9
    s_sub_u32 s44, s40, s44
    s_lshl_b32 s43, s41, 1
    s_lshr_b32 s41, s7, 1
    s_add_u32 s43, s43, s41
    s_mul_i32 s41, s43, 55296
    s_mul_i32 s42, s44, 384
    s_add_u32 s41, s41, s42
    v_lshrrev_b32 v28, 3, v1
    v_mul_u32_u24 v28, 3456, v28
    v_and_b32 v29, 7, v1
    v_lshl_add_u32 v32, v29, 4, v28
    v_add_u32 v33, 26624, v32
    v_add_u32 v34, 128, v32
    v_add_u32 v35, 128, v33
    v_add_u32 v36, 128, v34
    v_add_u32 v37, 128, v35
    s_and_b32 s42, s43, -2
    s_add_u32 s42, s42, s47
    s_cmp_ge_u32 s43, 30
    s_cselect_b32 s58, 1, 7
    s_cselect_b32 s59, 10, 1
    s_cselect_b32 s60, 180, 0
    s_mul_i32 s61, s42, s58
    s_add_u32 s60, s60, s61
    s_lshl_b32 s60, s60, 10
    s_add_u32 s60, s60, 28835840
    s_lshl_b32 s59, s59, 10
    s_and_b32 s61, s43, 1
    s_lshl_b32 s61, s61, 9
    s_add_u32 s60, s60, s61
    s_mul_i32 s61, s59, 7
    s_sub_u32 s61, 286720, s61
    s_cmp_eq_u32 s44, 8
    s_cselect_b32 s63, 0, 2146435072
    s_mul_i32 s62, s44, 12
    v_bfe_u32 v28, v1, 4, 1
    v_add_u32 v29, s62, v28
    v_lshrrev_b32 v30, 5, v1
    v_and_b32 v31, 15, v1
    v_lshlrev_b32 v31, 4, v31
    v_lshl_add_u32 v31, v30, 8, v31
    v_add_u32 v31, s60, v31
    v_mul_u32_u24 v41, 147, v29
    v_lshrrev_b32 v41, 10, v41
    v_mad_u32_u24 v41, v41, s61, v31
    v_mad_u32_u24 v104, v29, s59, v41
    v_add_u32 v29, 2, v29
    v_mul_u32_u24 v41, 147, v29
    v_lshrrev_b32 v41, 10, v41
    v_mad_u32_u24 v41, v41, s61, v31
    v_mad_u32_u24 v105, v29, s59, v41
    v_add_u32 v29, 2, v29
    v_mul_u32_u24 v41, 147, v29
    v_lshrrev_b32 v41, 10, v41
    v_mad_u32_u24 v41, v41, s61, v31
    v_mad_u32_u24 v106, v29, s59, v41
    v_add_u32 v29, 2, v29
    v_mul_u32_u24 v41, 147, v29
    v_lshrrev_b32 v41, 10, v41
    v_mad_u32_u24 v41, v41, s61, v31
    v_mad_u32_u24 v107, v29, s59, v41
    v_add_u32 v29, 2, v29
    v_mul_u32_u24 v41, 147, v29
    v_lshrrev_b32 v41, 10, v41
    v_mad_u32_u24 v41, v41, s61, v31
    v_mad_u32_u24 v108, v29, s59, v41
    v_add_u32 v29, 2, v29
    v_mul_u32_u24 v41, 147, v29
    v_lshrrev_b32 v41, 10, v41
    v_mad_u32_u24 v41, v41, s61, v31
    v_mad_u32_u24 v109, v29, s59, v41
    v_add_u32 v29, 2, v29
    v_mul_u32_u24 v41, 147, v29
    v_lshrrev_b32 v41, 10, v41
    v_mad_u32_u24 v41, v41, s61, v31
    v_mad_u32_u24 v110, v29, s59, v41
    v_max_u32 v110, s63, v110
    v_add_u32 v29, 2, v29
    v_mul_u32_u24 v41, 147, v29
    v_lshrrev_b32 v41, 10, v41
    v_mad_u32_u24 v41, v41, s61, v31
    v_mad_u32_u24 v111, v29, s59, v41
    v_max_u32 v111, s63, v111
    v_add_u32 v29, 2, v29
    s_mul_i32 s26, s44, 40
    s_add_u32 s26, s26, s43
    s_lshl_b32 s26, s26, 1
    s_add_u32 s26, s26, s47
    s_lshl_b32 s26, s26, 3
    s_add_u32 s26, s26, 8531968
    v_lshlrev_b32 v30, 3, v30
    v_bfe_u32 v31, v1, 2, 2
    v_add_u32 v30, v30, v31
    v_lshlrev_b32 v30, 7, v30
    v_lshl_add_u32 v30, v28, 5, v30
    v_and_b32 v31, 3, v1
    v_lshl_add_u32 v30, v31, 3, v30
    v_add_u32 v39, s27, v30
k1_setE:
    v_mov_b32 v88, 0
    v_mov_b32 v89, 0
    v_mov_b32 v90, 0
    v_mov_b32 v91, 0
    s_waitcnt vmcnt(8)
    s_barrier
    global_load_dwordx2 v[42:43], v40, s[80:81] sc1
    buffer_load_dwordx4 v20, s[8:11], s37 offen offset:0 lds
    ds_read_b128 v[116:119], v180 offset:0
    ds_read_b64_tr_b16 v[112:113], v184 offset:0
    ds_read_b64_tr_b16 v[114:115], v184 offset:1024
    ds_read_b128 v[124:127], v181 offset:0
    ds_read_b64_tr_b16 v[120:121], v184 offset:4096
    ds_read_b64_tr_b16 v[122:123], v184 offset:5120
    buffer_load_dwordx4 v21, s[8:11], s37 offen offset:1024 lds
    ds_read_b128 v[132:135], v182 offset:0
    ds_read_b64_tr_b16 v[128:129], v184 offset:8192
    ds_read_b64_tr_b16 v[130:131], v184 offset:9216
    ds_read_b128 v[140:143], v183 offset:0
    ds_read_b64_tr_b16 v[136:137], v184 offset:12288
    ds_read_b64_tr_b16 v[138:139], v184 offset:13312
    buffer_load_dwordx4 v22, s[8:11], s37 offen offset:2048 lds
    s_waitcnt lgkmcnt(9)
    v_mfma_f32_16x16x32_bf16 v[152:155], v[172:175], v[112:115], 0
    v_mfma_f32_16x16x32_bf16 v[156:159], v[172:175], v[116:119], 0
    v_dot2_f32_bf16 v160, v116, v116, 0
    v_dot2_f32_bf16 v161, v117, v117, 0
    v_dot2_f32_bf16 v162, v118, v118, 0
    buffer_load_dwordx4 v23, s[8:11], s37 offen offset:3072 lds
    s_add_u32 m0, s36, 16384
    s_add_u32 s37, s37, 128
    s_add_u32 s36, s36, 0x8000
    s_and_b32 s36, s36, 0x1ffff
    v_dot2_f32_bf16 v163, v119, v119, 0
    s_waitcnt lgkmcnt(6)
    v_mfma_f32_16x16x32_bf16 v[152:155], v[172:175], v[120:123], v[152:155]
    v_mfma_f32_16x16x32_bf16 v[156:159], v[172:175], v[124:127], v[156:159]
    v_dot2_f32_bf16 v160, v124, v124, v160
    v_dot2_f32_bf16 v161, v125, v125, v161
    buffer_load_dwordx4 v24, s[12:15], s38 offen offset:0 lds
    v_dot2_f32_bf16 v162, v126, v126, v162
    v_dot2_f32_bf16 v163, v127, v127, v163
    s_waitcnt lgkmcnt(3)
    v_mfma_f32_16x16x32_bf16 v[152:155], v[172:175], v[128:131], v[152:155]
    v_mfma_f32_16x16x32_bf16 v[156:159], v[172:175], v[132:135], v[156:159]
    v_dot2_f32_bf16 v160, v132, v132, v160
    buffer_load_dwordx4 v25, s[12:15], s38 offen offset:1024 lds
    v_dot2_f32_bf16 v161, v133, v133, v161
    v_dot2_f32_bf16 v162, v134, v134, v162
    v_dot2_f32_bf16 v163, v135, v135, v163
    s_waitcnt lgkmcnt(0)
    v_mfma_f32_16x16x32_bf16 v[152:155], v[172:175], v[136:139], v[152:155]
    v_mfma_f32_16x16x32_bf16 v[156:159], v[172:175], v[140:143], v[156:159]
    buffer_load_dwordx4 v26, s[12:15], s38 offen offset:2048 lds
    v_dot2_f32_bf16 v160, v140, v140, v160
    v_dot2_f32_bf16 v161, v141, v141, v161
    v_dot2_f32_bf16 v162, v142, v142, v162
    v_dot2_f32_bf16 v163, v143, v143, v163
    buffer_load_dwordx4 v27, s[12:15], s38 offen offset:3072 lds
    s_mov_b32 m0, s36
    s_add_u32 s38, s38, 245760
    s_cmp_eq_u32 s37, s39
    s_cselect_b32 s37, s34, s37
    s_cselect_b32 s38, s35, s38
    s_add_u32 m0, s27, 0
    s_nop 0
    buffer_load_dwordx4 v32, s[48:51], s41 offen offset:0 lds
    buffer_load_dwordx4 v33, s[48:51], s41 offen offset:1024 lds
    s_mov_b32 m0, s36
    s_waitcnt vmcnt(11)
    s_barrier
    buffer_load_dwordx4 v20, s[8:11], s37 offen offset:0 lds
    ds_read_b128 v[116:119], v180 offset:32768
    ds_read_b64_tr_b16 v[112:113], v184 offset:32768
    ds_read_b64_tr_b16 v[114:115], v184 offset:33792
    ds_read_b128 v[124:127], v181 offset:32768
    ds_read_b64_tr_b16 v[120:121], v184 offset:36864
    ds_read_b64_tr_b16 v[122:123], v184 offset:37888
    ds_read_b128 v[132:135], v182 offset:32768
    buffer_load_dwordx4 v21, s[8:11], s37 offen offset:1024 lds
    ds_read_b64_tr_b16 v[128:129], v184 offset:40960
    ds_read_b64_tr_b16 v[130:131], v184 offset:41984
    ds_read_b128 v[140:143], v183 offset:32768
    ds_read_b64_tr_b16 v[136:137], v184 offset:45056
    ds_read_b64_tr_b16 v[138:139], v184 offset:46080
    s_waitcnt lgkmcnt(9)
    v_mfma_f32_16x16x32_bf16 v[152:155], v[172:175], v[112:115], v[152:155]
    buffer_load_dwordx4 v22, s[8:11], s37 offen offset:2048 lds
    v_mfma_f32_16x16x32_bf16 v[156:159], v[172:175], v[116:119], v[156:159]
    v_dot2_f32_bf16 v160, v116, v116, v160
    v_dot2_f32_bf16 v161, v117, v117, v161
    v_dot2_f32_bf16 v162, v118, v118, v162
    v_dot2_f32_bf16 v163, v119, v119, v163
    s_waitcnt lgkmcnt(6)
    v_mfma_f32_16x16x32_bf16 v[152:155], v[172:175], v[120:123], v[152:155]
    buffer_load_dwordx4 v23, s[8:11], s37 offen offset:3072 lds
    s_add_u32 m0, s36, 16384
    s_add_u32 s37, s37, 128
    s_add_u32 s36, s36, 0x8000
    s_and_b32 s36, s36, 0x1ffff
    v_mfma_f32_16x16x32_bf16 v[156:159], v[172:175], v[124:127], v[156:159]
    v_dot2_f32_bf16 v160, v124, v124, v160
    v_dot2_f32_bf16 v161, v125, v125, v161
    v_dot2_f32_bf16 v162, v126, v126, v162
    v_dot2_f32_bf16 v163, v127, v127, v163
    s_waitcnt lgkmcnt(3)
    v_mfma_f32_16x16x32_bf16 v[152:155], v[172:175], v[128:131], v[152:155]
    buffer_load_dwordx4 v24, s[12:15], s38 offen offset:0 lds
    v_mfma_f32_16x16x32_bf16 v[156:159], v[172:175], v[132:135], v[156:159]
    v_dot2_f32_bf16 v160, v132, v132, v160
    v_dot2_f32_bf16 v161, v133, v133, v161
    v_dot2_f32_bf16 v162, v134, v134, v162
    v_dot2_f32_bf16 v163, v135, v135, v163
    s_waitcnt lgkmcnt(0)
    v_mfma_f32_16x16x32_bf16 v[152:155], v[172:175], v[136:139], v[152:155]
    buffer_load_dwordx4 v25, s[12:15], s38 offen offset:1024 lds
    v_mfma_f32_16x16x32_bf16 v[156:159], v[172:175], v[140:143], v[156:159]
    v_dot2_f32_bf16 v160, v140, v140, v160
    v_dot2_f32_bf16 v161, v141, v141, v161
    v_dot2_f32_bf16 v162, v142, v142, v162
    v_dot2_f32_bf16 v163, v143, v143, v163
    s_nop 0
    v_add_f32 v160, v160, v161
    s_nop 0
    v_add_f32 v162, v162, v163
    buffer_load_dwordx4 v26, s[12:15], s38 offen offset:2048 lds
    v_add_f32 v161, v160, v162
    v_mov_b32 v160, v161
    s_nop 1
    v_permlane32_swap_b32 v160, v161
    v_add_f32 v161, v160, v161
    v_bfi_b32 v160, v189, v156, v152
    buffer_load_dwordx4 v27, s[12:15], s38 offen offset:3072 lds
    s_mov_b32 m0, s36
    s_add_u32 s38, s38, 245760
    s_cmp_eq_u32 s37, s39
    s_cselect_b32 s37, s34, s37
    s_cselect_b32 s38, s35, s38
    s_add_u32 m0, s27, 2048
    s_nop 0
    buffer_load_dwordx4 v34, s[48:51], s41 offen offset:0 lds
    buffer_load_dwordx4 v35, s[48:51], s41 offen offset:1024 lds
    s_mov_b32 m0, s36
    s_waitcnt vmcnt(12)
    s_barrier
    s_max_i32 s87, s87, 100
    s_branch sequentia_t3
sequentia_n1:
    global_load_dwordx2 v[42:43], v40, s[80:81] sc1
    s_waitcnt vmcnt(0)
sequentia_t3:
    v_readfirstlane_b32 s84, v42
    v_readfirstlane_b32 s85, v43
    s_sub_u32 s87, s87, 1
    s_cbranch_scc1 sequentia_d2
    s_cmp_eq_u32 s84, 0
    s_cbranch_scc1 sequentia_n1
sequentia_d2:
    v_mov_b32 v162, s84
    v_mov_b32 v163, s85
    buffer_store_dwordx4 v[160:163], v188, s[16:19], s54 offen sc1
    buffer_load_dwordx4 v20, s[8:11], s37 offen offset:0 lds
    buffer_load_dwordx4 v21, s[8:11], s37 offen offset:1024 lds
    buffer_load_dwordx4 v22, s[8:11], s37 offen offset:2048 lds
    buffer_load_dwordx4 v23, s[8:11], s37 offen offset:3072 lds
    s_add_u32 m0, s36, 16384
    s_add_u32 s37, s37, 128
    s_add_u32 s36, s36, 0x8000
    s_and_b32 s36, s36, 0x1ffff
    buffer_load_dwordx4 v24, s[12:15], s38 offen offset:0 lds
    buffer_load_dwordx4 v25, s[12:15], s38 offen offset:1024 lds
    buffer_load_dwordx4 v26, s[12:15], s38 offen offset:2048 lds
    buffer_load_dwordx4 v27, s[12:15], s38 offen offset:3072 lds
    s_mov_b32 m0, s36
    s_add_u32 s38, s38, 245760
    s_cmp_eq_u32 s37, s39
    s_cselect_b32 s37, s34, s37
    s_cselect_b32 s38, s35, s38
    s_add_u32 m0, s27, 4096
    s_nop 0
    buffer_load_dwordx4 v36, s[48:51], s41 offen offset:0 lds
    buffer_load_dwordx4 v37, s[48:51], s41 offen offset:1024 lds
    s_mov_b32 m0, s36
    s_waitcnt vmcnt(13)
    s_barrier
    buffer_load_dwordx4 v20, s[8:11], s37 offen offset:0 lds
    buffer_load_dwordx4 v21, s[8:11], s37 offen offset:1024 lds
    buffer_load_dwordx4 v22, s[8:11], s37 offen offset:2048 lds
    buffer_load_dwordx4 v23, s[8:11], s37 offen offset:3072 lds
    s_add_u32 m0, s36, 16384
    s_add_u32 s37, s37, 128
    s_add_u32 s36, s36, 0x8000
    s_and_b32 s36, s36, 0x1ffff
    buffer_load_dwordx4 v24, s[12:15], s38 offen offset:0 lds
    buffer_load_dwordx4 v25, s[12:15], s38 offen offset:1024 lds
    buffer_load_dwordx4 v26, s[12:15], s38 offen offset:2048 lds
    buffer_load_dwordx4 v27, s[12:15], s38 offen offset:3072 lds
    s_mov_b32 m0, s36
    s_add_u32 s38, s38, 245760
    s_cmp_eq_u32 s37, s39
    s_cselect_b32 s37, s34, s37
    s_cselect_b32 s38, s35, s38
    global_load_dwordx2 v[46:47], v44, s[56:57]
    s_waitcnt vmcnt(11)
    s_barrier
    buffer_load_dwordx4 v20, s[8:11], s37 offen offset:0 lds
    buffer_load_dwordx4 v21, s[8:11], s37 offen offset:1024 lds
    buffer_load_dwordx4 v22, s[8:11], s37 offen offset:2048 lds
    buffer_load_dwordx4 v23, s[8:11], s37 offen offset:3072 lds
    s_add_u32 m0, s36, 16384
    s_add_u32 s37, s37, 128
    s_add_u32 s36, s36, 0x8000
    s_and_b32 s36, s36, 0x1ffff
    buffer_load_dwordx4 v24, s[12:15], s38 offen offset:0 lds
    buffer_load_dwordx4 v25, s[12:15], s38 offen offset:1024 lds
    buffer_load_dwordx4 v26, s[12:15], s38 offen offset:2048 lds
    buffer_load_dwordx4 v27, s[12:15], s38 offen offset:3072 lds
    s_mov_b32 m0, s36
    s_add_u32 s38, s38, 245760
    s_cmp_eq_u32 s37, s39
    s_cselect_b32 s37, s34, s37
    s_cselect_b32 s38, s35, s38
    s_waitcnt vmcnt(9)
    s_barrier
    buffer_load_dwordx4 v20, s[8:11], s37 offen offset:0 lds
    buffer_load_dwordx4 v21, s[8:11], s37 offen offset:1024 lds
    buffer_load_dwordx4 v22, s[8:11], s37 offen offset:2048 lds
    buffer_load_dwordx4 v23, s[8:11], s37 offen offset:3072 lds
    s_add_u32 m0, s36, 16384
    s_add_u32 s37, s37, 128
    s_add_u32 s36, s36, 0x8000
    s_and_b32 s36, s36, 0x1ffff
    buffer_load_dwordx4 v24, s[12:15], s38 offen offset:0 lds
    buffer_load_dwordx4 v25, s[12:15], s38 offen offset:1024 lds
    buffer_load_dwordx4 v26, s[12:15], s38 offen offset:2048 lds
    buffer_load_dwordx4 v27, s[12:15], s38 offen offset:3072 lds
    s_mov_b32 m0, s36
    s_add_u32 s38, s38, 245760
    s_cmp_eq_u32 s37, s39
    s_cselect_b32 s37, s34, s37
    s_cselect_b32 s38, s35, s38
    s_waitcnt vmcnt(25)
    s_cmp_lt_u32 s52, 60
    s_cbranch_scc1 k1_trA
    ds_read_b64_tr_b16 v[64:65], v39 offset:0
    ds_read_b64_tr_b16 v[66:67], v39 offset:512
    ds_read_b64_tr_b16 v[68:69], v39 offset:64
    ds_read_b64_tr_b16 v[70:71], v39 offset:576
    ds_read_b64_tr_b16 v[72:73], v39 offset:2048
    ds_read_b64_tr_b16 v[74:75], v39 offset:2560
    ds_read_b64_tr_b16 v[76:77], v39 offset:2112
    ds_read_b64_tr_b16 v[78:79], v39 offset:2624
    ds_read_b64_tr_b16 v[80:81], v39 offset:4096
    ds_read_b64_tr_b16 v[82:83], v39 offset:4608
    ds_read_b64_tr_b16 v[84:85], v39 offset:4160
    ds_read_b64_tr_b16 v[86:87], v39 offset:4672
k1_trE:
    s_waitcnt lgkmcnt(0)
    buffer_store_dwordx4 v[64:67], v104, s[16:19], 0 offen sc1
    buffer_store_dwordx4 v[68:71], v105, s[16:19], 0 offen sc1
    s_waitcnt vmcnt(10)
    s_barrier
    buffer_load_dwordx4 v20, s[8:11], s37 offen offset:0 lds
    buffer_load_dwordx4 v21, s[8:11], s37 offen offset:1024 lds
    buffer_load_dwordx4 v22, s[8:11], s37 offen offset:2048 lds
    buffer_load_dwordx4 v23, s[8:11], s37 offen offset:3072 lds
    s_add_u32 m0, s36, 16384
    s_add_u32 s37, s37, 128
    s_add_u32 s36, s36, 0x8000
    s_and_b32 s36, s36, 0x1ffff
    buffer_load_dwordx4 v24, s[12:15], s38 offen offset:0 lds
    buffer_load_dwordx4 v25, s[12:15], s38 offen offset:1024 lds
    buffer_load_dwordx4 v26, s[12:15], s38 offen offset:2048 lds
    buffer_load_dwordx4 v27, s[12:15], s38 offen offset:3072 lds
    s_mov_b32 m0, s36
    s_add_u32 s38, s38, 245760
    s_cmp_eq_u32 s37, s39
    s_cselect_b32 s37, s34, s37
    s_cselect_b32 s38, s35, s38
    buffer_load_dwordx4 v[112:115], v187, s[16:19], 0 offen offset:0 sc1
    buffer_load_dwordx4 v[116:119], v187, s[16:19], 0 offen offset:2048 sc1
    s_mov_b32 s28, 4096
    buffer_load_dwordx4 v[120:123], v187, s[16:19], s28 offen offset:0 sc1
    buffer_load_dwordx4 v[124:127], v187, s[16:19], s28 offen offset:2048 sc1
    s_mov_b32 s28, 8192
    buffer_load_dwordx4 v[128:131], v187, s[16:19], s28 offen offset:0 sc1
    buffer_store_dwordx4 v[72:75], v106, s[16:19], 0 offen sc1
    buffer_store_dwordx4 v[76:79], v107, s[16:19], 0 offen sc1
    s_waitcnt vmcnt(17)
    s_barrier
    buffer_load_dwordx4 v20, s[8:11], s37 offen offset:0 lds
    buffer_load_dwordx4 v21, s[8:11], s37 offen offset:1024 lds
    buffer_load_dwordx4 v22, s[8:11], s37 offen offset:2048 lds
    buffer_load_dwordx4 v23, s[8:11], s37 offen offset:3072 lds
    s_add_u32 m0, s36, 16384
    s_add_u32 s37, s37, 128
    s_add_u32 s36, s36, 0x8000
    s_and_b32 s36, s36, 0x1ffff
    buffer_load_dwordx4 v24, s[12:15], s38 offen offset:0 lds
    buffer_load_dwordx4 v25, s[12:15], s38 offen offset:1024 lds
    buffer_load_dwordx4 v26, s[12:15], s38 offen offset:2048 lds
    buffer_load_dwordx4 v27, s[12:15], s38 offen offset:3072 lds
    s_mov_b32 m0, s36
    s_add_u32 s38, s38, 245760
    s_cmp_eq_u32 s37, s39
    s_cselect_b32 s37, s34, s37
    s_cselect_b32 s38, s35, s38
    buffer_store_dwordx4 v[80:83], v108, s[16:19], 0 offen sc1
    buffer_store_dwordx4 v[84:87], v109, s[16:19], 0 offen sc1
    s_waitcnt vmcnt(17)
    s_barrier
    buffer_store_dwordx4 v[88:91], v110, s[16:19], 0 offen sc1
    buffer_store_dwordx4 v[88:91], v111, s[16:19], 0 offen sc1
    buffer_load_dword v46, v38, s[16:19], s53 offen
    s_max_i32 s87, s87, 100
    s_waitcnt vmcnt(15)
k1_gt:
    v_cmp_ne_u64 vcc, s[84:85], v[114:115]
    v_cmp_ne_u64 s[88:89], s[84:85], v[118:119]
    s_nop 1
    s_or_b64 vcc, vcc, s[88:89]
    v_cmp_ne_u64 s[88:89], s[84:85], v[122:123]
    s_nop 1
    s_or_b64 vcc, vcc, s[88:89]
    v_cmp_ne_u64 s[88:89], s[84:85], v[126:127]
    s_nop 1
    s_or_b64 vcc, vcc, s[88:89]
    v_cmp_ne_u64 s[88:89], s[84:85], v[130:131]
    s_nop 1
    s_or_b64 vcc, vcc, s[88:89]
    s_cbranch_vccnz k1_gr
k1_gd:
    v_add_f32 v112, v112, v116
    v_add_f32 v113, v113, v117
    v_add_f32 v120, v120, v124
    v_add_f32 v121, v121, v125
    v_add_f32 v112, v112, v128
    v_add_f32 v113, v113, v129
    v_add_f32 v112, v112, v120
    v_add_f32 v113, v113, v121
    v_mul_f32 v156, 0xbacccccd, v112
    v_cvt_pk_bf16_f32 v153, v112, v112
    v_mul_f32 v113, 0x3acccccd, v113
    v_lshlrev_b32 v7, 16, v153
    v_fma_f32 v113, -v156, v156, v113
    v_sub_f32 v112, v112, v7
    v_cvt_pk_bf16_f32 v176, v156, v156
    v_max_f32 v113, 0, v113
    v_cvt_pk_bf16_f32 v154, v112, v112
    v_cvt_pk_bf16_f32 v113, v113, v113
    v_lshlrev_b32 v7, 16, v154
    v_lshlrev_b32 v113, 16, v113
    v_sub_f32 v112, v112, v7
    v_add_f32 v113, 0x3727c5ac, v113
    v_cvt_pk_bf16_f32 v155, v112, v112
    v_cvt_pk_bf16_f32 v113, v113, v113
    v_and_b32 v176, v189, v176
    v_lshlrev_b32 v113, 16, v113
    v_and_b32 v177, 0xffff, v176
    v_sqrt_f32 v113, v113
    v_add_u32 v180, 65536, v180
    v_cvt_pk_bf16_f32 v113, v113, v113
    v_xor_b32 v184, 32, v185
    v_xor_b32 v181, 32, v180
    v_lshlrev_b32 v113, 16, v113
    v_xor_b32 v187, 64, v185
    v_rcp_f32 v113, v113
    s_nop 0
    v_mul_f32 v113, s55, v113
    s_waitcnt vmcnt(5)
    ds_write_b128 v181, v[88:91]
    ds_write_b128 v180, v[176:179]
    s_mov_b32 exec_lo, 0
    ds_write_b16 v185, v153
    ds_write_b16 v184, v154 offset:256
    ds_write_b16 v187, v155 offset:512
    s_mov_b64 exec, 0xffffffff
    ds_write_b32 v186, v113
    s_mov_b64 exec, -1
    s_waitcnt lgkmcnt(0)
    s_barrier
    s_mov_b32 s27, s52
    s_waitcnt vmcnt(1)
k1_join:
    v_min_u32 v13, 9, v1
    v_lshlrev_b32 v13, 4, v13
    v_add_u32 v13, 8527872, v13
    buffer_load_dwordx4 v[52:55], v13, s[16:19], 0 offen sc1
    v_mov_b32 v8, 0x3f80
    v_mov_b32 v9, 0
    v_mov_b32 v10, 0x3f80
    v_mov_b32 v11, 0
    v_and_b32 v12, 255, v0
    v_lshlrev_b32 v12, 4, v12
    v_add_u32 v12, 152000, v12
    ds_write_b128 v12, v[8:11]
    ds_write_b128 v12, v[8:11] offset:1024
    s_getreg_b32 s28, hwreg(HW_REG_XCC_ID, 0, 4)
    v_mov_b32 v48, s84
    v_mov_b32 v49, s85
    v_mov_b32 v50, s28
    v_mov_b32 v51, 0
    s_and_b32 s28, s2, 7
    s_lshl_b32 s28, s28, 5
    s_lshr_b32 s29, s2, 3
    s_add_u32 s28, s28, s29
    s_lshl_b32 s28, s28, 4
    s_add_u32 s28, s28, 8585216
    s_cmp_eq_u32 s7, 0
    s_cselect_b32 s28, s28, 2146435072
    s_mov_b64 exec, 1
    buffer_store_dwordx2 v[48:49], v40, s[16:19], s26 offen sc1
    buffer_store_dwordx4 v[48:51], v40, s[16:19], s28 offen sc1
    s_mov_b64 exec, -1
    v_mov_b32 v194, s84
    v_mov_b32 v195, s85
    v_mov_b32 v192, 0
    s_lshr_b32 s4, s2, 3
    s_and_b32 s5, s2, 7
    s_mul_i32 s25, s5, 1310720
    s_add_u32 s25, s25, 13631488
    s_mov_b32 s8, s64
    s_mov_b32 s9, s65
    s_mov_b32 s10, 2621440
    s_mov_b32 s11, 0x00020000
    v_and_b32 v2, 31, v1
    v_lshrrev_b32 v3, 5, v1
    s_and_b32 s24, s4, 1
    s_lshr_b32 s6, s4, 1
    s_mul_i32 s6, s6, 5
    s_lshl_b32 s28, s24, 1
    s_add_u32 s6, s6, s28
    v_and_b32 v16, 1, v1
    v_lshl_add_u32 v16, v16, 1, s6
    v_lshrrev_b32 v16, 4, v16
    v_bfe_u32 v17, v1, 3, 2
    v_mul_u32_u24 v18, 5, v17
    v_add_u32 v16, v16, v18
    s_lshl_b32 s28, s5, 1
    s_sub_u32 s29, s28, 2
    v_bfe_u32 v18, v1, 1, 2
    v_add_u32 v18, s29, v18
    v_min_u32 v17, 1, v17
    v_add_u32 v17, -1, v17
    v_and_b32 v17, s28, v17
    v_max_i32 v18, v18, v17
    v_lshl_add_u32 v16, v16, 4, v18
    v_lshlrev_b32 v16, 7, v16
    v_add_u32 v247, 8388608, v16
    s_lshl_b32 s28, s5, 9
    s_add_u32 s28, s28, 8585216
    v_lshl_add_u32 v244, v2, 4, s28
    s_lshl_b32 s28, s3, 4
    v_and_b32 v245, 15, v1
    v_add_u32 v245, s28, v245
    v_min_u32 v245, 116, v245
    s_and_b32 s28, s4, 7
    s_lshl_b32 s28, s28, 8
    s_add_u32 s28, s28, 8528544
    s_and_b32 s29, s4, 15
    s_mul_i32 s29, s29, 150
    s_lshr_b32 s29, s29, 8
    s_min_u32 s29, s29, 7
    s_mul_i32 s29, s29, 640
    s_add_u32 s29, s29, 8531376
    v_mov_b32 v17, 8527872
    v_mov_b32 v18, s28
    v_mov_b32 v19, s29
    v_cmp_le_u32 s[32:33], 22, v245
    v_cmp_le_u32 s[34:35], 37, v245
    v_cmp_le_u32 s[36:37], 32, v1
    v_cndmask_b32 v17, v17, v18, s[32:33]
    v_cndmask_b32 v17, v17, v19, s[34:35]
    v_lshl_add_u32 v245, v245, 4, v17
    v_cndmask_b32 v244, v244, v245, s[36:37]
    s_lshl_b32 s6, s6, 12
    s_mul_i32 s28, s5, 983040
    s_add_u32 s6, s6, s28
    s_lshl_b32 s21, s3, 10
    s_add_u32 s29, s6, s21
    s_add_u32 s29, s29, 323584
    s_cmp_lt_u32 s3, 4
    s_cselect_b32 s28, 978944, 0
    s_sub_u32 s29, s29, s28
    s_cselect_b32 s20, 2146435072, s29
    v_lshlrev_b32 v4, 4, v1
    v_add_u32 v5, s24, v3
    v_lshlrev_b32 v5, 12, v5
    v_lshlrev_b32 v6, 4, v2
    v_add_u32 v5, v5, v6
    s_lshl_b32 s22, s3, 9
    s_add_u32 s22, s22, s6
    s_xor_b32 s23, s24, 1
    s_lshl_b32 s23, s23, 13
    s_add_u32 s23, s23, s22
    v_and_b32 v18, 0x13, v2
    v_bfe_u32 v19, v2, 2, 1
    v_lshl_or_b32 v18, v19, 3, v18
    v_bfe_u32 v19, v2, 3, 1
    v_lshl_or_b32 v18, v19, 2, v18
    s_lshl_b32 s29, s3, 9
    s_add_u32 s29, s29, 102400
    v_lshl_add_u32 v18, v18, 4, s29
    s_xor_b32 s30, s24, 1
    s_mul_i32 s30, s30, 16512
    v_add_u32 v221, s30, v18
    v_add_u32 v20, s24, v3
    v_mul_u32_u24 v20, 8256, v20
    v_add_u32 v220, v18, v20
    v_bfe_u32 v21, v1, 2, 2
    v_lshl_add_u32 v20, v3, 3, v21
    s_add_u32 s29, s29, 24832
    v_lshl_add_u32 v20, v20, 4, s29
    v_and_b32 v21, 1, v1
    v_add_u32 v21, s24, v21
    v_mul_u32_u24 v21, 8256, v21
    v_and_b32 v22, 2, v1
    v_lshl_add_u32 v21, v22, 2, v21
    s_lshl_b32 s31, s24, 3
    s_add_u32 s30, s30, s31
    v_mov_b32 v23, s30
    v_and_b32 v22, 19, v1
    v_cmp_eq_u32 s[32:33], 16, v22
    s_nop 1
    v_cndmask_b32 v21, v21, v23, s[32:33]
    v_add_u32 v20, v20, v21
    v_cmp_lt_u32 s[32:33], 16, v22
    v_mov_b32 v22, 152000
    s_nop 0
    v_cndmask_b32 v20, v20, v22, s[32:33]
    v_lshlrev_b32 v21, 3, v3
    v_sub_u32 v21, v2, v21
    v_cmp_le_i32 s[32:33], 0, v21
    v_cmp_le_i32 s[34:35], 1, v21
    v_cmp_le_i32 s[36:37], 2, v21
    v_cmp_le_i32 s[38:39], 3, v21
    v_cmp_le_i32 s[40:41], 4, v21
    v_cmp_le_i32 s[42:43], 5, v21
    v_cmp_le_i32 s[44:45], 6, v21
    v_cmp_le_i32 s[46:47], 7, v21
    v_cmp_le_i32 s[48:49], 16, v21
    v_cmp_le_i32 s[50:51], 17, v21
    v_cmp_le_i32 s[52:53], 18, v21
    v_cmp_le_i32 s[54:55], 19, v21
    v_cmp_le_i32 s[56:57], 20, v21
    v_cmp_le_i32 s[58:59], 21, v21
    v_cmp_le_i32 s[60:61], 22, v21
    v_cmp_le_i32 s[62:63], 23, v21
    v_mov_b32 v22, 0xffff
    v_mov_b32 v23, 0xffff0000
    v_cndmask_b32 v24, 0, v22, s[32:33]
    v_cndmask_b32 v9, 0, v23, s[34:35]
    v_or_b32 v24, v24, v9
    v_cndmask_b32 v25, 0, v22, s[36:37]
    v_cndmask_b32 v9, 0, v23, s[38:39]
    v_or_b32 v25, v25, v9
    v_cndmask_b32 v26, 0, v22, s[40:41]
    v_cndmask_b32 v9, 0, v23, s[42:43]
    v_or_b32 v26, v26, v9
    v_cndmask_b32 v27, 0, v22, s[44:45]
    v_cndmask_b32 v9, 0, v23, s[46:47]
    v_or_b32 v27, v27, v9
    v_cndmask_b32 v28, 0, v22, s[48:49]
    v_cndmask_b32 v9, 0, v23, s[50:51]
    v_or_b32 v28, v28, v9
    v_cndmask_b32 v29, 0, v22, s[52:53]
    v_cndmask_b32 v9, 0, v23, s[54:55]
    v_or_b32 v29, v29, v9
    v_cndmask_b32 v30, 0, v22, s[56:57]
    v_cndmask_b32 v9, 0, v23, s[58:59]
    v_or_b32 v30, v30, v9
    v_cndmask_b32 v31, 0, v22, s[60:61]
    v_cndmask_b32 v9, 0, v23, s[62:63]
    v_or_b32 v31, v31, v9
    v_add_u32 v8, -1, v3
    v_and_b32 v228, 0x3f803f80, v8
    v_mov_b32 v229, 0
    v_mov_b32 v233, 0
    v_mov_b32 v230, 0
    v_mov_b32 v234, 0
    v_mov_b32 v231, 0
    v_mov_b32 v235, 0
    s_sub_u32 s28, s24, 1
    v_and_b32 v7, s28, v8
    v_xor_b32 v8, v7, v8
    s_add_u32 m0, s21, 102400
    v_and_b32 v21, 15, v1
    v_mul_u32_u24 v21, 1280, v21
    v_lshrrev_b32 v22, 4, v1
    v_lshl_add_u32 v23, v22, 3, v21
    v_lshl_add_u32 v22, v22, 4, v21
    s_lshl_b32 s29, s5, 4
    s_lshr_b32 s30, s4, 3
    s_lshl_b32 s30, s30, 2
    s_add_u32 s29, s29, s30
    s_add_u32 s29, s29, s3
    s_mul_i32 s29, s29, 20480
    s_and_b32 s30, s4, 7
    s_mul_i32 s30, s30, 160
    s_add_u32 s29, s29, s30
    s_lshr_b32 s66, s4, 3
    s_lshl_b32 s66, s66, 2
    s_add_u32 s66, s66, s3
    s_lshr_b32 s67, s66, 3
    s_lshl_b32 s68, s5, 1
    s_add_u32 s67, s67, s68
    s_mul_i32 s67, s67, 10240
    s_and_b32 s66, s66, 7
    s_lshl_b32 s66, s66, 8
    s_add_u32 s66, s66, s67
    s_add_u32 s66, s66, 8650752
    v_and_b32 v21, 15, v1
    v_lshlrev_b32 v21, 4, v21
    s_and_b32 s69, s4, 15
    s_mul_i32 s69, s69, 286720
    s_mul_i32 s70, s3, 3072
    s_add_u32 s69, s69, s70
    s_add_u32 s69, s69, 28835840
    s_add_u32 s70, s70, 102400
    s_cmp_lt_u32 s3, 4
    s_cselect_b32 s66, s66, 2146435072
    s_add_u32 s67, s66, 4096
    s_add_u32 s68, s66, 8192
    s_max_i32 s87, s87, 100
    s_waitcnt vmcnt(2)
    s_branch sequentia_t6
sequentia_p4:
    s_sleep 4
    buffer_load_dwordx4 v[52:55], v13, s[16:19], 0 offen sc1
    s_waitcnt vmcnt(0)
sequentia_t6:
    v_cmp_ne_u64 vcc, s[84:85], v[52:53]
    v_cmp_ne_u64 s[88:89], s[84:85], v[54:55]
    s_nop 1
    s_or_b64 vcc, vcc, s[88:89]
    s_sub_u32 s87, s87, 1
    s_cbranch_scc1 sequentia_d5
    s_cbranch_vccnz sequentia_p4
sequentia_d5:
    s_waitcnt lgkmcnt(0)
    s_barrier
    s_branch k2_go
k1_setA:
    s_mov_b32 s48, s76
    s_mov_b32 s49, s77
    s_mov_b32 s50, 2211840
    s_mov_b32 s51, 0x00020000
    s_lshr_b32 s43, s52, 1
    s_add_u32 s43, s43, 24
    s_and_b32 s44, s52, 1
    s_lshl_b32 s44, s44, 2
    s_add_u32 s44, s44, s7
    s_mul_i32 s41, s43, 40960
    s_mul_i32 s42, s44, 160
    s_add_u32 s41, s41, s42
    v_add_u32 v28, 0, v1
    v_mul_u32_u24 v29, 205, v28
    v_lshrrev_b32 v29, 11, v29
    v_mul_u32_u24 v29, 1120, v29
    v_lshl_add_u32 v32, v28, 4, v29
    v_add_u32 v28, 64, v1
    v_mul_u32_u24 v29, 205, v28
    v_lshrrev_b32 v29, 11, v29
    v_mul_u32_u24 v29, 1120, v29
    v_lshl_add_u32 v33, v28, 4, v29
    v_add_u32 v33, -1024, v33
    v_add_u32 v28, 128, v1
    v_mul_u32_u24 v29, 205, v28
    v_lshrrev_b32 v29, 11, v29
    v_mul_u32_u24 v29, 1120, v29
    v_lshl_add_u32 v34, v28, 4, v29
    v_add_u32 v28, 192, v1
    v_mul_u32_u24 v29, 205, v28
    v_lshrrev_b32 v29, 11, v29
    v_mul_u32_u24 v29, 1120, v29
    v_lshl_add_u32 v35, v28, 4, v29
    v_add_u32 v35, -1024, v35
    v_add_u32 v28, 256, v1
    v_mul_u32_u24 v29, 205, v28
    v_lshrrev_b32 v29, 11, v29
    v_mul_u32_u24 v29, 1120, v29
    v_lshl_add_u32 v36, v28, 4, v29
    v_lshrrev_b32 v29, 4, v1
    v_lshlrev_b32 v29, 3, v29
    v_bfe_u32 v30, v1, 2, 2
    v_add_u32 v29, v29, v30
    v_mul_u32_u24 v29, 160, v29
    v_add_u32 v29, s27, v29
    v_and_b32 v30, 3, v1
    v_lshl_add_u32 v45, v30, 3, v29
    v_lshl_add_u32 v39, v30, 4, v29
    s_mul_i32 s28, s43, 37
    s_lshr_b32 s28, s28, 8
    s_mul_i32 s26, s28, 28
    s_lshl_b32 s29, s43, 2
    s_sub_u32 s26, s29, s26
    s_lshr_b32 s26, 0x4392108, s26
    s_bitcmp1_b32 s26, 3
    s_cselect_b32 s29, 2, 5
    s_mul_i32 s28, s28, s29
    s_cselect_b32 s29, 0, 16
    s_and_b32 s26, s26, 7
    s_add_u32 s29, s29, s28
    s_add_u32 s29, s29, s26
    s_mul_i32 s28, s44, 54
    s_add_u32 s28, s28, s29
    s_mul_i32 s28, s28, 5120
    s_add_u32 s28, s28, 26214400
    v_lshl_add_u32 v104, v1, 4, s28
    v_add_u32 v105, 1024, v104
    v_add_u32 v106, 2048, v104
    v_add_u32 v107, 3072, v104
    v_add_u32 v108, 4096, v104
    s_lshl_b32 s26, s44, 5
    s_lshr_b32 s28, s52, 1
    s_add_u32 s26, s26, s28
    s_lshl_b32 s26, s26, 3
    s_add_u32 s26, s26, 8528896
    v_mov_b32 v37, 2146435072
    v_mov_b32 v109, 2146435072
    v_mov_b32 v110, 2146435072
    v_mov_b32 v111, 2146435072
    s_branch k1_setE
k1_trA:
    ds_read_b64_tr_b16 v[64:65], v39 offset:0
    ds_read_b64_tr_b16 v[66:67], v39 offset:640
    ds_read_b64_tr_b16 v[68:69], v39 offset:8
    ds_read_b64_tr_b16 v[70:71], v39 offset:648
    ds_read_b64_tr_b16 v[72:73], v39 offset:64
    ds_read_b64_tr_b16 v[74:75], v39 offset:704
    ds_read_b64_tr_b16 v[76:77], v39 offset:72
    ds_read_b64_tr_b16 v[78:79], v39 offset:712
    ds_read_b64_tr_b16 v[80:81], v45 offset:128
    ds_read_b64_tr_b16 v[82:83], v45 offset:768
    s_branch k1_trE
k1_gr:
    s_sub_u32 s87, s87, 1
    s_cbranch_scc1 k1_gd
    buffer_load_dwordx4 v[112:115], v187, s[16:19], 0 offen offset:0 sc1
    buffer_load_dwordx4 v[116:119], v187, s[16:19], 0 offen offset:2048 sc1
    s_mov_b32 s28, 4096
    buffer_load_dwordx4 v[120:123], v187, s[16:19], s28 offen offset:0 sc1
    buffer_load_dwordx4 v[124:127], v187, s[16:19], s28 offen offset:2048 sc1
    s_mov_b32 s28, 8192
    buffer_load_dwordx4 v[128:131], v187, s[16:19], s28 offen offset:0 sc1
    s_waitcnt vmcnt(0)
    s_branch k1_gt
k1_compute:
    v_mov_b32 v192, 0
    s_lshl_b32 s28, s2, 3
    s_add_u32 s28, s28, s3
    s_cmp_lg_u32 s28, 1
    s_cbranch_scc1 k1_nonon
    s_memrealtime s[28:29]
    s_waitcnt lgkmcnt(0)
    s_or_b32 s28, s28, 1
    v_mov_b32 v194, s28
    v_mov_b32 v195, s29
    s_mov_b64 exec, 1
    global_store_dwordx2 v192, v[194:195], s[80:81] sc1
    s_mov_b64 exec, -1
k1_nonon:
    v_and_b32 v2, 15, v1
    v_lshrrev_b32 v3, 4, v1
    v_bfe_u32 v5, v1, 2, 2
    s_lshr_b32 s28, s3, 1
    s_and_b32 s30, s3, 1
    v_lshrrev_b32 v4, 1, v2
    v_xor_b32 v4, v4, v3
    v_lshlrev_b32 v4, 4, v4
    v_lshl_add_u32 v4, v2, 7, v4
    s_lshl_b32 s29, s28, 13
    v_add_u32 v20, s29, v4
    v_xor_b32 v21, 64, v20
    v_xor_b32 v6, s30, v3
    v_and_b32 v6, 1, v6
    v_lshl_add_u32 v6, v6, 2, v5
    v_lshl_add_u32 v7, v3, 3, v5
    v_lshlrev_b32 v7, 8, v7
    v_lshl_add_u32 v7, v6, 5, v7
    v_and_b32 v6, 3, v1
    v_lshl_add_u32 v7, v6, 3, v7
    v_add_u32 v22, 16384, v7
    v_xor_b32 v23, 32, v22
    v_xor_b32 v24, 64, v22
    v_xor_b32 v25, 96, v22
    v_mov_b32 v10, v20
    v_mov_b32 v11, v21
    v_mov_b32 v12, v22
    v_mov_b32 v13, v23
    v_mov_b32 v14, v24
    v_mov_b32 v15, v25
    v_lshrrev_b32 v8, 5, v1
    v_lshlrev_b32 v8, 12, v8
    v_and_b32 v9, 31, v1
    v_lshl_add_u32 v8, v9, 4, v8
    s_lshr_b32 s32, s5, 1
    s_mul_i32 s32, s32, 983040
    s_and_b32 s33, s5, 1
    s_lshl_b32 s33, s33, 11
    s_add_u32 s32, s32, s33
    s_lshl_b32 s33, s4, 16
    s_add_u32 s32, s32, s33
    s_lshl_b32 s33, s30, 15
    s_add_u32 s32, s32, s33
    s_lshl_b32 s33, s28, 10
    s_add_u32 s32, s32, s33
    s_xor_b32 s33, s32, 8192
    s_xor_b32 s34, s32, 16384
    s_xor_b32 s35, s32, 24576
    s_lshl_b32 s27, s4, 4
    s_add_u32 s27, s27, s5
    s_lshl_b32 s27, s27, 7
    s_add_u32 s27, s27, 8388608
    s_mov_b32 s26, 2146435072
    s_lshl_b32 s28, s28, 8
    s_add_u32 s28, s28, 159744
    v_lshl_add_u32 v58, v2, 2, s28
    v_mov_b32 v34, 0
    v_mov_b32 v35, 0
    v_mov_b32 v36, 0
    v_mov_b32 v37, 0
    s_nop 1
    v_mfma_f32_32x32x16_bf16 v[64:79], v[34:37], v[34:37], 0
    v_mfma_f32_32x32x16_bf16 v[80:95], v[34:37], v[34:37], 0
    v_mfma_f32_32x32x16_bf16 v[96:111], v[34:37], v[34:37], 0
    v_mfma_f32_32x32x16_bf16 v[112:127], v[34:37], v[34:37], 0
    s_waitcnt lgkmcnt(0)
    s_mov_b32 s16, s82
    s_mov_b32 s17, s83
    s_mov_b32 s18, 33554432
    s_mov_b32 s19, 0x00020000
    s_cmp_eq_u32 s3, 0
    s_cselect_b32 s28, s27, 2146435072
    v_lshlrev_b32 v193, 4, v1
    s_mov_b64 exec, 0xff
    buffer_store_dwordx4 v[34:37], v193, s[16:19], s28 offen sc1
    s_mov_b64 exec, -1
    s_mov_b32 s45, 10
    s_mov_b32 s46, 0x8000
    s_barrier
    ds_read_b64_tr_b16 v[128:129], v12 offset:0
    ds_read_b64_tr_b16 v[130:131], v12 offset:1024
    ds_read_b128 v[144:147], v10 offset:0
    ds_read_b128 v[148:151], v10 offset:2048
    ds_read_b128 v[152:155], v10 offset:4096
    ds_read_b128 v[156:159], v10 offset:6144
    ds_read_b64_tr_b16 v[132:133], v13 offset:0
    ds_read_b64_tr_b16 v[134:135], v13 offset:1024
    ds_read_b64_tr_b16 v[136:137], v14 offset:0
    ds_read_b64_tr_b16 v[138:139], v14 offset:1024
    ds_read_b64_tr_b16 v[140:141], v15 offset:0
    ds_read_b64_tr_b16 v[142:143], v15 offset:1024
    s_branch k1_cmid
.p2align 3
    s_nop 0
k1_cloop:
    s_barrier
    v_mfma_f32_16x16x32_bf16 v[64:67], v[160:163], v[176:179], v[64:67]
    s_nop 5
    s_nop 0
    ds_read_b64_tr_b16 v[128:129], v12 offset:0
    v_mfma_f32_16x16x32_bf16 v[68:71], v[160:163], v[180:183], v[68:71]
    s_nop 5
    s_nop 0
    ds_read_b64_tr_b16 v[130:131], v12 offset:1024
    v_mfma_f32_16x16x32_bf16 v[72:75], v[160:163], v[184:187], v[72:75]
    s_nop 5
    s_nop 0
    ds_read_b128 v[144:147], v10 offset:0
    v_mfma_f32_16x16x32_bf16 v[76:79], v[160:163], v[188:191], v[76:79]
    s_nop 5
    s_nop 0
    ds_read_b128 v[148:151], v10 offset:2048
    s_waitcnt lgkmcnt(8)
    s_nop 0
    v_mfma_f32_16x16x32_bf16 v[80:83], v[164:167], v[176:179], v[80:83]
    s_nop 5
    s_nop 0
    ds_read_b128 v[152:155], v10 offset:4096
    v_mfma_f32_16x16x32_bf16 v[84:87], v[164:167], v[180:183], v[84:87]
    s_nop 5
    s_nop 0
    ds_read_b128 v[156:159], v10 offset:6144
    v_mfma_f32_16x16x32_bf16 v[88:91], v[164:167], v[184:187], v[88:91]
    s_nop 5
    s_nop 0
    ds_read_b64_tr_b16 v[132:133], v13 offset:0
    v_mfma_f32_16x16x32_bf16 v[92:95], v[164:167], v[188:191], v[92:95]
    s_nop 5
    s_nop 0
    ds_read_b64_tr_b16 v[134:135], v13 offset:1024
    s_waitcnt lgkmcnt(10)
    s_nop 0
    v_mfma_f32_16x16x32_bf16 v[96:99], v[168:171], v[176:179], v[96:99]
    s_nop 5
    s_nop 0
    ds_read_b64_tr_b16 v[136:137], v14 offset:0
    v_mfma_f32_16x16x32_bf16 v[100:103], v[168:171], v[180:183], v[100:103]
    s_nop 5
    s_nop 0
    ds_read_b64_tr_b16 v[138:139], v14 offset:1024
    v_mfma_f32_16x16x32_bf16 v[104:107], v[168:171], v[184:187], v[104:107]
    s_nop 5
    s_nop 0
    ds_read_b64_tr_b16 v[140:141], v15 offset:0
    v_mfma_f32_16x16x32_bf16 v[108:111], v[168:171], v[188:191], v[108:111]
    s_nop 5
    s_nop 0
    ds_read_b64_tr_b16 v[142:143], v15 offset:1024
    s_waitcnt lgkmcnt(12)
    s_nop 0
    v_mfma_f32_16x16x32_bf16 v[112:115], v[172:175], v[176:179], v[112:115]
    s_nop 5
    s_nop 0
    s_add_u32 s46, s46, 0x8000
    v_mfma_f32_16x16x32_bf16 v[116:119], v[172:175], v[180:183], v[116:119]
    s_nop 5
    s_nop 0
    s_and_b32 s46, s46, 0x1ffff
    v_mfma_f32_16x16x32_bf16 v[120:123], v[172:175], v[184:187], v[120:123]
    s_nop 5
    s_nop 0
    v_mfma_f32_16x16x32_bf16 v[124:127], v[172:175], v[188:191], v[124:127]
    s_nop 5
    s_nop 0
k1_cmid:
    s_waitcnt lgkmcnt(6)
    s_sub_u32 s45, s45, 1
    v_mfma_f32_16x16x32_bf16 v[64:67], v[128:131], v[144:147], v[64:67]
    s_nop 5
    s_nop 0
    ds_read_b64_tr_b16 v[160:161], v12 offset:8192
    v_mfma_f32_16x16x32_bf16 v[68:71], v[128:131], v[148:151], v[68:71]
    s_nop 5
    s_nop 0
    ds_read_b64_tr_b16 v[162:163], v12 offset:9216
    v_mfma_f32_16x16x32_bf16 v[72:75], v[128:131], v[152:155], v[72:75]
    s_nop 5
    s_nop 0
    ds_read_b128 v[176:179], v11 offset:0
    v_mfma_f32_16x16x32_bf16 v[76:79], v[128:131], v[156:159], v[76:79]
    s_nop 5
    s_nop 0
    ds_read_b128 v[180:183], v11 offset:2048
    s_waitcnt lgkmcnt(8)
    s_nop 0
    v_mfma_f32_16x16x32_bf16 v[80:83], v[132:135], v[144:147], v[80:83]
    s_nop 5
    s_nop 0
    ds_read_b128 v[184:187], v11 offset:4096
    v_mfma_f32_16x16x32_bf16 v[84:87], v[132:135], v[148:151], v[84:87]
    s_nop 5
    s_nop 0
    ds_read_b128 v[188:191], v11 offset:6144
    v_mfma_f32_16x16x32_bf16 v[88:91], v[132:135], v[152:155], v[88:91]
    s_nop 5
    s_nop 0
    ds_read_b64_tr_b16 v[164:165], v13 offset:8192
    v_mfma_f32_16x16x32_bf16 v[92:95], v[132:135], v[156:159], v[92:95]
    s_nop 5
    s_nop 0
    ds_read_b64_tr_b16 v[166:167], v13 offset:9216
    s_waitcnt lgkmcnt(10)
    s_nop 0
    v_mfma_f32_16x16x32_bf16 v[96:99], v[136:139], v[144:147], v[96:99]
    s_nop 5
    s_nop 0
    ds_read_b64_tr_b16 v[168:169], v14 offset:8192
    v_mfma_f32_16x16x32_bf16 v[100:103], v[136:139], v[148:151], v[100:103]
    s_nop 5
    s_nop 0
    ds_read_b64_tr_b16 v[170:171], v14 offset:9216
    v_mfma_f32_16x16x32_bf16 v[104:107], v[136:139], v[152:155], v[104:107]
    s_nop 5
    s_nop 0
    ds_read_b64_tr_b16 v[172:173], v15 offset:8192
    v_mfma_f32_16x16x32_bf16 v[108:111], v[136:139], v[156:159], v[108:111]
    s_nop 5
    s_nop 0
    ds_read_b64_tr_b16 v[174:175], v15 offset:9216
    s_waitcnt lgkmcnt(12)
    s_nop 0
    v_mfma_f32_16x16x32_bf16 v[112:115], v[140:143], v[144:147], v[112:115]
    s_nop 5
    s_nop 0
    v_add_u32 v10, s46, v20
    v_add_u32 v11, s46, v21
    v_mfma_f32_16x16x32_bf16 v[116:119], v[140:143], v[148:151], v[116:119]
    s_nop 5
    s_nop 0
    v_add_u32 v12, s46, v22
    v_add_u32 v13, s46, v23
    v_mfma_f32_16x16x32_bf16 v[120:123], v[140:143], v[152:155], v[120:123]
    s_nop 5
    s_nop 0
    v_add_u32 v14, s46, v24
    v_add_u32 v15, s46, v25
    v_mfma_f32_16x16x32_bf16 v[124:127], v[140:143], v[156:159], v[124:127]
    s_nop 5
    s_nop 0
    s_cmp_lg_u32 s45, 6
    s_waitcnt lgkmcnt(6)
    s_cbranch_scc1 k1_cloop
.p2align 3
    s_nop 0
k1_cloop2:
    s_barrier
    v_mfma_f32_16x16x32_bf16 v[64:67], v[160:163], v[176:179], v[64:67]
    s_nop 2
    s_nop 0
    ds_read_b64_tr_b16 v[128:129], v12 offset:0
    v_mfma_f32_16x16x32_bf16 v[68:71], v[160:163], v[180:183], v[68:71]
    s_nop 2
    s_nop 0
    ds_read_b64_tr_b16 v[130:131], v12 offset:1024
    v_mfma_f32_16x16x32_bf16 v[72:75], v[160:163], v[184:187], v[72:75]
    s_nop 2
    s_nop 0
    ds_read_b128 v[144:147], v10 offset:0
    v_mfma_f32_16x16x32_bf16 v[76:79], v[160:163], v[188:191], v[76:79]
    s_nop 2
    s_nop 0
    ds_read_b128 v[148:151], v10 offset:2048
    s_waitcnt lgkmcnt(8)
    s_nop 0
    v_mfma_f32_16x16x32_bf16 v[80:83], v[164:167], v[176:179], v[80:83]
    s_nop 2
    s_nop 0
    ds_read_b128 v[152:155], v10 offset:4096
    v_mfma_f32_16x16x32_bf16 v[84:87], v[164:167], v[180:183], v[84:87]
    s_nop 2
    s_nop 0
    ds_read_b128 v[156:159], v10 offset:6144
    v_mfma_f32_16x16x32_bf16 v[88:91], v[164:167], v[184:187], v[88:91]
    s_nop 2
    s_nop 0
    ds_read_b64_tr_b16 v[132:133], v13 offset:0
    v_mfma_f32_16x16x32_bf16 v[92:95], v[164:167], v[188:191], v[92:95]
    s_nop 2
    s_nop 0
    ds_read_b64_tr_b16 v[134:135], v13 offset:1024
    s_waitcnt lgkmcnt(10)
    s_nop 0
    v_mfma_f32_16x16x32_bf16 v[96:99], v[168:171], v[176:179], v[96:99]
    s_nop 2
    s_nop 0
    ds_read_b64_tr_b16 v[136:137], v14 offset:0
    v_mfma_f32_16x16x32_bf16 v[100:103], v[168:171], v[180:183], v[100:103]
    s_nop 2
    s_nop 0
    ds_read_b64_tr_b16 v[138:139], v14 offset:1024
    v_mfma_f32_16x16x32_bf16 v[104:107], v[168:171], v[184:187], v[104:107]
    s_nop 2
    s_nop 0
    ds_read_b64_tr_b16 v[140:141], v15 offset:0
    v_mfma_f32_16x16x32_bf16 v[108:111], v[168:171], v[188:191], v[108:111]
    s_nop 2
    s_nop 0
    ds_read_b64_tr_b16 v[142:143], v15 offset:1024
    s_waitcnt lgkmcnt(12)
    s_nop 0
    v_mfma_f32_16x16x32_bf16 v[112:115], v[172:175], v[176:179], v[112:115]
    s_nop 2
    s_nop 0
    s_add_u32 s46, s46, 0x8000
    v_mfma_f32_16x16x32_bf16 v[116:119], v[172:175], v[180:183], v[116:119]
    s_nop 2
    s_nop 0
    s_and_b32 s46, s46, 0x1ffff
    v_mfma_f32_16x16x32_bf16 v[120:123], v[172:175], v[184:187], v[120:123]
    s_nop 2
    s_nop 0
    v_mfma_f32_16x16x32_bf16 v[124:127], v[172:175], v[188:191], v[124:127]
    s_nop 2
    s_nop 0
    s_waitcnt lgkmcnt(6)
    s_sub_u32 s45, s45, 1
    v_mfma_f32_16x16x32_bf16 v[64:67], v[128:131], v[144:147], v[64:67]
    s_nop 2
    s_nop 0
    ds_read_b64_tr_b16 v[160:161], v12 offset:8192
    v_mfma_f32_16x16x32_bf16 v[68:71], v[128:131], v[148:151], v[68:71]
    s_nop 2
    s_nop 0
    ds_read_b64_tr_b16 v[162:163], v12 offset:9216
    v_mfma_f32_16x16x32_bf16 v[72:75], v[128:131], v[152:155], v[72:75]
    s_nop 2
    s_nop 0
    ds_read_b128 v[176:179], v11 offset:0
    v_mfma_f32_16x16x32_bf16 v[76:79], v[128:131], v[156:159], v[76:79]
    s_nop 2
    s_nop 0
    ds_read_b128 v[180:183], v11 offset:2048
    s_waitcnt lgkmcnt(8)
    s_nop 0
    v_mfma_f32_16x16x32_bf16 v[80:83], v[132:135], v[144:147], v[80:83]
    s_nop 2
    s_nop 0
    ds_read_b128 v[184:187], v11 offset:4096
    v_mfma_f32_16x16x32_bf16 v[84:87], v[132:135], v[148:151], v[84:87]
    s_nop 2
    s_nop 0
    ds_read_b128 v[188:191], v11 offset:6144
    v_mfma_f32_16x16x32_bf16 v[88:91], v[132:135], v[152:155], v[88:91]
    s_nop 2
    s_nop 0
    ds_read_b64_tr_b16 v[164:165], v13 offset:8192
    v_mfma_f32_16x16x32_bf16 v[92:95], v[132:135], v[156:159], v[92:95]
    s_nop 2
    s_nop 0
    ds_read_b64_tr_b16 v[166:167], v13 offset:9216
    s_waitcnt lgkmcnt(10)
    s_nop 0
    v_mfma_f32_16x16x32_bf16 v[96:99], v[136:139], v[144:147], v[96:99]
    s_nop 2
    s_nop 0
    ds_read_b64_tr_b16 v[168:169], v14 offset:8192
    v_mfma_f32_16x16x32_bf16 v[100:103], v[136:139], v[148:151], v[100:103]
    s_nop 2
    s_nop 0
    ds_read_b64_tr_b16 v[170:171], v14 offset:9216
    v_mfma_f32_16x16x32_bf16 v[104:107], v[136:139], v[152:155], v[104:107]
    s_nop 2
    s_nop 0
    ds_read_b64_tr_b16 v[172:173], v15 offset:8192
    v_mfma_f32_16x16x32_bf16 v[108:111], v[136:139], v[156:159], v[108:111]
    s_nop 2
    s_nop 0
    ds_read_b64_tr_b16 v[174:175], v15 offset:9216
    s_waitcnt lgkmcnt(12)
    s_nop 0
    v_mfma_f32_16x16x32_bf16 v[112:115], v[140:143], v[144:147], v[112:115]
    s_nop 2
    s_nop 0
    v_add_u32 v10, s46, v20
    v_add_u32 v11, s46, v21
    v_mfma_f32_16x16x32_bf16 v[116:119], v[140:143], v[148:151], v[116:119]
    s_nop 2
    s_nop 0
    v_add_u32 v12, s46, v22
    v_add_u32 v13, s46, v23
    v_mfma_f32_16x16x32_bf16 v[120:123], v[140:143], v[152:155], v[120:123]
    s_nop 2
    s_nop 0
    v_add_u32 v14, s46, v24
    v_add_u32 v15, s46, v25
    v_mfma_f32_16x16x32_bf16 v[124:127], v[140:143], v[156:159], v[124:127]
    s_nop 2
    s_nop 0
    s_cmp_lg_u32 s45, 0
    s_waitcnt lgkmcnt(6)
    s_cbranch_scc1 k1_cloop2
    global_load_dwordx2 v[194:195], v192, s[80:81] sc1
    v_mfma_f32_16x16x32_bf16 v[64:67], v[160:163], v[176:179], v[64:67]
    ds_read_b64_tr_b16 v[128:129], v12 offset:0
    v_mfma_f32_16x16x32_bf16 v[68:71], v[160:163], v[180:183], v[68:71]
    ds_read_b64_tr_b16 v[130:131], v12 offset:1024
    v_mfma_f32_16x16x32_bf16 v[72:75], v[160:163], v[184:187], v[72:75]
    ds_read_b128 v[144:147], v10 offset:0
    v_mfma_f32_16x16x32_bf16 v[76:79], v[160:163], v[188:191], v[76:79]
    ds_read_b128 v[148:151], v10 offset:2048
    s_waitcnt lgkmcnt(8)
    s_nop 0
    v_mfma_f32_16x16x32_bf16 v[80:83], v[164:167], v[176:179], v[80:83]
    ds_read_b128 v[152:155], v10 offset:4096
    v_mfma_f32_16x16x32_bf16 v[84:87], v[164:167], v[180:183], v[84:87]
    ds_read_b128 v[156:159], v10 offset:6144
    v_mfma_f32_16x16x32_bf16 v[88:91], v[164:167], v[184:187], v[88:91]
    ds_read_b64_tr_b16 v[132:133], v13 offset:0
    v_mfma_f32_16x16x32_bf16 v[92:95], v[164:167], v[188:191], v[92:95]
    ds_read_b64_tr_b16 v[134:135], v13 offset:1024
    s_waitcnt lgkmcnt(10)
    s_nop 0
    v_mfma_f32_16x16x32_bf16 v[96:99], v[168:171], v[176:179], v[96:99]
    ds_read_b64_tr_b16 v[136:137], v14 offset:0
    v_mfma_f32_16x16x32_bf16 v[100:103], v[168:171], v[180:183], v[100:103]
    ds_read_b64_tr_b16 v[138:139], v14 offset:1024
    v_mfma_f32_16x16x32_bf16 v[104:107], v[168:171], v[184:187], v[104:107]
    ds_read_b64_tr_b16 v[140:141], v15 offset:0
    v_mfma_f32_16x16x32_bf16 v[108:111], v[168:171], v[188:191], v[108:111]
    ds_read_b64_tr_b16 v[142:143], v15 offset:1024
    s_waitcnt lgkmcnt(12)
    s_nop 0
    v_mfma_f32_16x16x32_bf16 v[112:115], v[172:175], v[176:179], v[112:115]
    ds_read_b32 v42, v58 offset:0
    v_mfma_f32_16x16x32_bf16 v[116:119], v[172:175], v[180:183], v[116:119]
    ds_read_b32 v44, v58 offset:64
    v_mfma_f32_16x16x32_bf16 v[120:123], v[172:175], v[184:187], v[120:123]
    ds_read_b32 v46, v58 offset:128
    v_mfma_f32_16x16x32_bf16 v[124:127], v[172:175], v[188:191], v[124:127]
    ds_read_b32 v48, v58 offset:192
    s_waitcnt lgkmcnt(4)
    v_mfma_f32_16x16x32_bf16 v[64:67], v[128:131], v[144:147], v[64:67]
    v_mfma_f32_16x16x32_bf16 v[68:71], v[128:131], v[148:151], v[68:71]
    v_mfma_f32_16x16x32_bf16 v[72:75], v[128:131], v[152:155], v[72:75]
    s_waitcnt lgkmcnt(0)
    v_mfma_f32_16x16x32_bf16 v[76:79], v[128:131], v[156:159], v[76:79]
    v_mul_f32 v64, v64, v42
    v_mul_f32 v65, v65, v42
    v_mfma_f32_16x16x32_bf16 v[80:83], v[132:135], v[144:147], v[80:83]
    v_mul_f32 v66, v66, v42
    v_mul_f32 v67, v67, v42
    v_mfma_f32_16x16x32_bf16 v[84:87], v[132:135], v[148:151], v[84:87]
    v_mul_f32 v68, v68, v44
    v_mul_f32 v69, v69, v44
    v_mfma_f32_16x16x32_bf16 v[88:91], v[132:135], v[152:155], v[88:91]
    v_mul_f32 v70, v70, v44
    v_mul_f32 v71, v71, v44
    v_mfma_f32_16x16x32_bf16 v[92:95], v[132:135], v[156:159], v[92:95]
    v_cvt_pk_bf16_f32 v64, v64, v65
    v_cvt_pk_bf16_f32 v65, v66, v67
    v_mfma_f32_16x16x32_bf16 v[96:99], v[136:139], v[144:147], v[96:99]
    v_cvt_pk_bf16_f32 v66, v68, v69
    v_cvt_pk_bf16_f32 v67, v70, v71
    v_mfma_f32_16x16x32_bf16 v[100:103], v[136:139], v[148:151], v[100:103]
    v_mul_f32 v72, v72, v46
    v_mul_f32 v73, v73, v46
    v_mfma_f32_16x16x32_bf16 v[104:107], v[136:139], v[152:155], v[104:107]
    v_permlane16_swap_b32 v64, v66
    v_permlane16_swap_b32 v65, v67
    v_mfma_f32_16x16x32_bf16 v[108:111], v[136:139], v[156:159], v[108:111]
    buffer_store_dwordx4 v[64:67], v8, s[16:19], s32 offen offset:0 sc1
    v_mul_f32 v74, v74, v46
    v_mfma_f32_16x16x32_bf16 v[112:115], v[140:143], v[144:147], v[112:115]
    v_mul_f32 v75, v75, v46
    v_mul_f32 v76, v76, v48
    v_mfma_f32_16x16x32_bf16 v[116:119], v[140:143], v[148:151], v[116:119]
    v_mul_f32 v77, v77, v48
    v_mul_f32 v78, v78, v48
    v_mfma_f32_16x16x32_bf16 v[120:123], v[140:143], v[152:155], v[120:123]
    v_mul_f32 v79, v79, v48
    v_cvt_pk_bf16_f32 v72, v72, v73
    v_mfma_f32_16x16x32_bf16 v[124:127], v[140:143], v[156:159], v[124:127]
    v_cvt_pk_bf16_f32 v73, v74, v75
    v_cvt_pk_bf16_f32 v74, v76, v77
    v_cvt_pk_bf16_f32 v75, v78, v79
    v_pk_mul_f32 v[80:81], v[80:81], v[42:43] op_sel_hi:[1,0]
    v_pk_mul_f32 v[82:83], v[82:83], v[42:43] op_sel_hi:[1,0]
    v_permlane16_swap_b32 v72, v74
    v_permlane16_swap_b32 v73, v75
    buffer_store_dwordx4 v[72:75], v8, s[16:19], s32 offen offset:512 sc1
    v_pk_mul_f32 v[84:85], v[84:85], v[44:45] op_sel_hi:[1,0]
    v_pk_mul_f32 v[86:87], v[86:87], v[44:45] op_sel_hi:[1,0]
    v_cvt_pk_bf16_f32 v80, v80, v81
    v_cvt_pk_bf16_f32 v81, v82, v83
    v_cvt_pk_bf16_f32 v82, v84, v85
    v_cvt_pk_bf16_f32 v83, v86, v87
    v_pk_mul_f32 v[88:89], v[88:89], v[46:47] op_sel_hi:[1,0]
    v_pk_mul_f32 v[90:91], v[90:91], v[46:47] op_sel_hi:[1,0]
    v_permlane16_swap_b32 v80, v82
    v_permlane16_swap_b32 v81, v83
    buffer_store_dwordx4 v[80:83], v8, s[16:19], s33 offen offset:0 sc1
    v_pk_mul_f32 v[92:93], v[92:93], v[48:49] op_sel_hi:[1,0]
    v_pk_mul_f32 v[94:95], v[94:95], v[48:49] op_sel_hi:[1,0]
    v_cvt_pk_bf16_f32 v88, v88, v89
    v_cvt_pk_bf16_f32 v89, v90, v91
    v_cvt_pk_bf16_f32 v90, v92, v93
    v_cvt_pk_bf16_f32 v91, v94, v95
    v_pk_mul_f32 v[96:97], v[96:97], v[42:43] op_sel_hi:[1,0]
    v_pk_mul_f32 v[98:99], v[98:99], v[42:43] op_sel_hi:[1,0]
    v_permlane16_swap_b32 v88, v90
    v_permlane16_swap_b32 v89, v91
    buffer_store_dwordx4 v[88:91], v8, s[16:19], s33 offen offset:512 sc1
    v_pk_mul_f32 v[100:101], v[100:101], v[44:45] op_sel_hi:[1,0]
    v_pk_mul_f32 v[102:103], v[102:103], v[44:45] op_sel_hi:[1,0]
    v_cvt_pk_bf16_f32 v96, v96, v97
    v_cvt_pk_bf16_f32 v97, v98, v99
    v_cvt_pk_bf16_f32 v98, v100, v101
    v_cvt_pk_bf16_f32 v99, v102, v103
    v_pk_mul_f32 v[104:105], v[104:105], v[46:47] op_sel_hi:[1,0]
    v_pk_mul_f32 v[106:107], v[106:107], v[46:47] op_sel_hi:[1,0]
    v_permlane16_swap_b32 v96, v98
    v_permlane16_swap_b32 v97, v99
    buffer_store_dwordx4 v[96:99], v8, s[16:19], s34 offen offset:0 sc1
    v_pk_mul_f32 v[108:109], v[108:109], v[48:49] op_sel_hi:[1,0]
    v_pk_mul_f32 v[110:111], v[110:111], v[48:49] op_sel_hi:[1,0]
    v_cvt_pk_bf16_f32 v104, v104, v105
    v_cvt_pk_bf16_f32 v105, v106, v107
    v_cvt_pk_bf16_f32 v106, v108, v109
    v_cvt_pk_bf16_f32 v107, v110, v111
    v_pk_mul_f32 v[112:113], v[112:113], v[42:43] op_sel_hi:[1,0]
    v_pk_mul_f32 v[114:115], v[114:115], v[42:43] op_sel_hi:[1,0]
    v_permlane16_swap_b32 v104, v106
    v_permlane16_swap_b32 v105, v107
    buffer_store_dwordx4 v[104:107], v8, s[16:19], s34 offen offset:512 sc1
    v_pk_mul_f32 v[116:117], v[116:117], v[44:45] op_sel_hi:[1,0]
    v_pk_mul_f32 v[118:119], v[118:119], v[44:45] op_sel_hi:[1,0]
    v_cvt_pk_bf16_f32 v112, v112, v113
    v_cvt_pk_bf16_f32 v113, v114, v115
    v_cvt_pk_bf16_f32 v114, v116, v117
    v_cvt_pk_bf16_f32 v115, v118, v119
    v_pk_mul_f32 v[120:121], v[120:121], v[46:47] op_sel_hi:[1,0]
    v_pk_mul_f32 v[122:123], v[122:123], v[46:47] op_sel_hi:[1,0]
    v_permlane16_swap_b32 v112, v114
    v_permlane16_swap_b32 v113, v115
    buffer_store_dwordx4 v[112:115], v8, s[16:19], s35 offen offset:0 sc1
    v_pk_mul_f32 v[124:125], v[124:125], v[48:49] op_sel_hi:[1,0]
    v_pk_mul_f32 v[126:127], v[126:127], v[48:49] op_sel_hi:[1,0]
    v_cvt_pk_bf16_f32 v120, v120, v121
    v_cvt_pk_bf16_f32 v121, v122, v123
    v_cvt_pk_bf16_f32 v122, v124, v125
    v_cvt_pk_bf16_f32 v123, v126, v127
    s_nop 0
    v_permlane16_swap_b32 v120, v122
    v_permlane16_swap_b32 v121, v123
    buffer_store_dwordx4 v[120:123], v8, s[16:19], s35 offen offset:512 sc1
    s_waitcnt vmcnt(8)
    s_max_i32 s87, s87, 100
    s_branch sequentia_t9
sequentia_n7:
    global_load_dwordx2 v[194:195], v192, s[80:81] sc1
    s_waitcnt vmcnt(0)
sequentia_t9:
    v_readfirstlane_b32 s84, v194
    v_readfirstlane_b32 s85, v195
    s_sub_u32 s87, s87, 1
    s_cbranch_scc1 sequentia_d8
    s_cmp_eq_u32 s84, 0
    s_cbranch_scc1 sequentia_n7
sequentia_d8:
    v_mov_b32 v194, s84
    v_mov_b32 v195, s85
k2_setup:
    s_lshr_b32 s4, s2, 3
    s_and_b32 s5, s2, 7
    s_mul_i32 s25, s5, 1310720
    s_add_u32 s25, s25, 13631488
    s_mov_b32 s8, s64
    s_mov_b32 s9, s65
    s_mov_b32 s10, 2621440
    s_mov_b32 s11, 0x00020000
    v_and_b32 v2, 31, v1
    v_lshrrev_b32 v3, 5, v1
    s_and_b32 s24, s4, 1
    s_lshr_b32 s6, s4, 1
    s_mul_i32 s6, s6, 5
    s_lshl_b32 s28, s24, 1
    s_add_u32 s6, s6, s28
    v_and_b32 v16, 1, v1
    v_lshl_add_u32 v16, v16, 1, s6
    v_lshrrev_b32 v16, 4, v16
    v_bfe_u32 v17, v1, 3, 2
    v_mul_u32_u24 v18, 5, v17
    v_add_u32 v16, v16, v18
    s_lshl_b32 s28, s5, 1
    s_sub_u32 s29, s28, 2
    v_bfe_u32 v18, v1, 1, 2
    v_add_u32 v18, s29, v18
    v_min_u32 v17, 1, v17
    v_add_u32 v17, -1, v17
    v_and_b32 v17, s28, v17
    v_max_i32 v18, v18, v17
    v_lshl_add_u32 v16, v16, 4, v18
    v_lshlrev_b32 v16, 7, v16
    v_add_u32 v247, 8388608, v16
    s_lshl_b32 s28, s5, 9
    s_add_u32 s28, s28, 8585216
    v_lshl_add_u32 v244, v2, 4, s28
    s_lshl_b32 s28, s3, 4
    v_and_b32 v245, 15, v1
    v_add_u32 v245, s28, v245
    v_min_u32 v245, 116, v245
    s_and_b32 s28, s4, 7
    s_lshl_b32 s28, s28, 8
    s_add_u32 s28, s28, 8528544
    s_and_b32 s29, s4, 15
    s_mul_i32 s29, s29, 150
    s_lshr_b32 s29, s29, 8
    s_min_u32 s29, s29, 7
    s_mul_i32 s29, s29, 640
    s_add_u32 s29, s29, 8531376
    v_mov_b32 v17, 8527872
    v_mov_b32 v18, s28
    v_mov_b32 v19, s29
    v_cmp_le_u32 s[32:33], 22, v245
    v_cmp_le_u32 s[34:35], 37, v245
    v_cmp_le_u32 s[36:37], 32, v1
    v_cndmask_b32 v17, v17, v18, s[32:33]
    v_cndmask_b32 v17, v17, v19, s[34:35]
    v_lshl_add_u32 v245, v245, 4, v17
    v_cndmask_b32 v244, v244, v245, s[36:37]
    s_lshl_b32 s6, s6, 12
    s_mul_i32 s28, s5, 983040
    s_add_u32 s6, s6, s28
    s_lshl_b32 s21, s3, 10
    s_add_u32 s29, s6, s21
    s_add_u32 s29, s29, 323584
    s_cmp_lt_u32 s3, 4
    s_cselect_b32 s28, 978944, 0
    s_sub_u32 s29, s29, s28
    s_cselect_b32 s20, 2146435072, s29
    v_lshlrev_b32 v4, 4, v1
    v_add_u32 v5, s24, v3
    v_lshlrev_b32 v5, 12, v5
    v_lshlrev_b32 v6, 4, v2
    v_add_u32 v5, v5, v6
    s_lshl_b32 s22, s3, 9
    s_add_u32 s22, s22, s6
    s_xor_b32 s23, s24, 1
    s_lshl_b32 s23, s23, 13
    s_add_u32 s23, s23, s22
    v_and_b32 v18, 0x13, v2
    v_bfe_u32 v19, v2, 2, 1
    v_lshl_or_b32 v18, v19, 3, v18
    v_bfe_u32 v19, v2, 3, 1
    v_lshl_or_b32 v18, v19, 2, v18
    s_lshl_b32 s29, s3, 9
    s_add_u32 s29, s29, 102400
    v_lshl_add_u32 v18, v18, 4, s29
    s_xor_b32 s30, s24, 1
    s_mul_i32 s30, s30, 16512
    v_add_u32 v221, s30, v18
    v_add_u32 v20, s24, v3
    v_mul_u32_u24 v20, 8256, v20
    v_add_u32 v220, v18, v20
    v_bfe_u32 v21, v1, 2, 2
    v_lshl_add_u32 v20, v3, 3, v21
    s_add_u32 s29, s29, 24832
    v_lshl_add_u32 v20, v20, 4, s29
    v_and_b32 v21, 1, v1
    v_add_u32 v21, s24, v21
    v_mul_u32_u24 v21, 8256, v21
    v_and_b32 v22, 2, v1
    v_lshl_add_u32 v21, v22, 2, v21
    s_lshl_b32 s31, s24, 3
    s_add_u32 s30, s30, s31
    v_mov_b32 v23, s30
    v_and_b32 v22, 19, v1
    v_cmp_eq_u32 s[32:33], 16, v22
    s_nop 1
    v_cndmask_b32 v21, v21, v23, s[32:33]
    v_add_u32 v20, v20, v21
    v_cmp_lt_u32 s[32:33], 16, v22
    v_mov_b32 v22, 152000
    s_nop 0
    v_cndmask_b32 v20, v20, v22, s[32:33]
    v_lshlrev_b32 v21, 3, v3
    v_sub_u32 v21, v2, v21
    v_cmp_le_i32 s[32:33], 0, v21
    v_cmp_le_i32 s[34:35], 1, v21
    v_cmp_le_i32 s[36:37], 2, v21
    v_cmp_le_i32 s[38:39], 3, v21
    v_cmp_le_i32 s[40:41], 4, v21
    v_cmp_le_i32 s[42:43], 5, v21
    v_cmp_le_i32 s[44:45], 6, v21
    v_cmp_le_i32 s[46:47], 7, v21
    v_cmp_le_i32 s[48:49], 16, v21
    v_cmp_le_i32 s[50:51], 17, v21
    v_cmp_le_i32 s[52:53], 18, v21
    v_cmp_le_i32 s[54:55], 19, v21
    v_cmp_le_i32 s[56:57], 20, v21
    v_cmp_le_i32 s[58:59], 21, v21
    v_cmp_le_i32 s[60:61], 22, v21
    v_cmp_le_i32 s[62:63], 23, v21
    v_mov_b32 v22, 0xffff
    v_mov_b32 v23, 0xffff0000
    v_cndmask_b32 v24, 0, v22, s[32:33]
    v_cndmask_b32 v9, 0, v23, s[34:35]
    v_or_b32 v24, v24, v9
    v_cndmask_b32 v25, 0, v22, s[36:37]
    v_cndmask_b32 v9, 0, v23, s[38:39]
    v_or_b32 v25, v25, v9
    v_cndmask_b32 v26, 0, v22, s[40:41]
    v_cndmask_b32 v9, 0, v23, s[42:43]
    v_or_b32 v26, v26, v9
    v_cndmask_b32 v27, 0, v22, s[44:45]
    v_cndmask_b32 v9, 0, v23, s[46:47]
    v_or_b32 v27, v27, v9
    v_cndmask_b32 v28, 0, v22, s[48:49]
    v_cndmask_b32 v9, 0, v23, s[50:51]
    v_or_b32 v28, v28, v9
    v_cndmask_b32 v29, 0, v22, s[52:53]
    v_cndmask_b32 v9, 0, v23, s[54:55]
    v_or_b32 v29, v29, v9
    v_cndmask_b32 v30, 0, v22, s[56:57]
    v_cndmask_b32 v9, 0, v23, s[58:59]
    v_or_b32 v30, v30, v9
    v_cndmask_b32 v31, 0, v22, s[60:61]
    v_cndmask_b32 v9, 0, v23, s[62:63]
    v_or_b32 v31, v31, v9
    v_add_u32 v8, -1, v3
    v_and_b32 v228, 0x3f803f80, v8
    v_mov_b32 v229, 0
    v_mov_b32 v233, 0
    v_mov_b32 v230, 0
    v_mov_b32 v234, 0
    v_mov_b32 v231, 0
    v_mov_b32 v235, 0
    s_sub_u32 s28, s24, 1
    v_and_b32 v7, s28, v8
    v_xor_b32 v8, v7, v8
    s_add_u32 m0, s21, 102400
    v_and_b32 v21, 15, v1
    v_mul_u32_u24 v21, 1280, v21
    v_lshrrev_b32 v22, 4, v1
    v_lshl_add_u32 v23, v22, 3, v21
    v_lshl_add_u32 v22, v22, 4, v21
    s_lshl_b32 s29, s5, 4
    s_lshr_b32 s30, s4, 3
    s_lshl_b32 s30, s30, 2
    s_add_u32 s29, s29, s30
    s_add_u32 s29, s29, s3
    s_mul_i32 s29, s29, 20480
    s_and_b32 s30, s4, 7
    s_mul_i32 s30, s30, 160
    s_add_u32 s29, s29, s30
    s_lshr_b32 s66, s4, 3
    s_lshl_b32 s66, s66, 2
    s_add_u32 s66, s66, s3
    s_lshr_b32 s67, s66, 3
    s_lshl_b32 s68, s5, 1
    s_add_u32 s67, s67, s68
    s_mul_i32 s67, s67, 10240
    s_and_b32 s66, s66, 7
    s_lshl_b32 s66, s66, 8
    s_add_u32 s66, s66, s67
    s_add_u32 s66, s66, 8650752
    v_and_b32 v21, 15, v1
    v_lshlrev_b32 v21, 4, v21
    s_and_b32 s69, s4, 15
    s_mul_i32 s69, s69, 286720
    s_mul_i32 s70, s3, 3072
    s_add_u32 s69, s69, s70
    s_add_u32 s69, s69, 28835840
    s_add_u32 s70, s70, 102400
    s_cmp_lt_u32 s3, 4
    s_cselect_b32 s66, s66, 2146435072
    s_add_u32 s67, s66, 4096
    s_add_u32 s68, s66, 8192
    buffer_load_dwordx4 v[10:13], v22, s[8:11], s29 offen
    buffer_load_dwordx4 v[14:17], v22, s[8:11], s29 offen offset:64
    buffer_load_dwordx2 v[18:19], v23, s[8:11], s29 offen offset:128
    buffer_load_dwordx4 v[128:131], v21, s[16:19], s66 offen offset:0 sc1
    buffer_load_dwordx4 v[132:135], v21, s[16:19], s66 offen offset:2048 sc1
    buffer_load_dwordx4 v[136:139], v21, s[16:19], s67 offen offset:0 sc1
    buffer_load_dwordx4 v[140:143], v21, s[16:19], s67 offen offset:2048 sc1
    buffer_load_dwordx4 v[144:147], v21, s[16:19], s68 offen offset:0 sc1
    s_cmp_eq_u32 s3, 0
    s_cselect_b32 s27, s27, 2146435072
    s_waitcnt vmcnt(8)
    s_barrier
    s_mov_b64 exec, 1
    buffer_store_dwordx2 v[194:195], v192, s[16:19], s27 offen sc1
    s_mov_b64 exec, -1
    s_max_i32 s87, s87, 100
    s_waitcnt vmcnt(1)
    s_branch sequentia_t12
sequentia_p10:
    s_sleep 8
    buffer_load_dwordx4 v[128:131], v21, s[16:19], s66 offen offset:0 sc1
    buffer_load_dwordx4 v[132:135], v21, s[16:19], s66 offen offset:2048 sc1
    buffer_load_dwordx4 v[136:139], v21, s[16:19], s67 offen offset:0 sc1
    buffer_load_dwordx4 v[140:143], v21, s[16:19], s67 offen offset:2048 sc1
    buffer_load_dwordx4 v[144:147], v21, s[16:19], s68 offen offset:0 sc1
    s_waitcnt vmcnt(0)
sequentia_t12:
    v_cmp_ne_u64 vcc, s[84:85], v[130:131]
    v_cmp_ne_u64 s[88:89], s[84:85], v[134:135]
    s_nop 1
    s_or_b64 vcc, vcc, s[88:89]
    v_cmp_ne_u64 s[88:89], s[84:85], v[138:139]
    s_nop 1
    s_or_b64 vcc, vcc, s[88:89]
    v_cmp_ne_u64 s[88:89], s[84:85], v[142:143]
    s_nop 1
    s_or_b64 vcc, vcc, s[88:89]
    v_cmp_ne_u64 s[88:89], s[84:85], v[146:147]
    s_nop 1
    s_or_b64 vcc, vcc, s[88:89]
    s_sub_u32 s87, s87, 1
    s_cbranch_scc1 sequentia_d11
    s_cbranch_vccnz sequentia_p10
sequentia_d11:
    v_add_f32 v128, v128, v132
    v_add_f32 v136, v136, v140
    v_add_f32 v128, v128, v144
    v_add_f32 v254, v128, v136
    s_cmp_lg_u32 s3, 0
    s_cbranch_scc1 k2_go
    s_max_i32 s87, s87, 100
    s_mov_b64 exec, 16777215
sequentia_p16:
sequentia_t18:
    buffer_load_dwordx2 v[236:237], v247, s[16:19], 0 offen sc1
    s_waitcnt vmcnt(0)
    v_cmp_ne_u64 vcc, s[84:85], v[236:237]
    s_sub_u32 s87, s87, 1
    s_cbranch_scc1 sequentia_d17
    s_and_b32 s28, vcc_lo, 65535
    s_cbranch_scc1 sequentia_p16
sequentia_d17:
    s_mov_b64 exec, -1
k2_go:
    s_barrier
    buffer_load_dwordx4 v4, s[16:19], s20 offen sc1 lds
    s_add_u32 m0, s21, 110656
    s_add_u32 s20, s20, 4096
    buffer_load_dwordx4 v4, s[16:19], s20 offen sc1 lds
    s_add_u32 m0, s21, 118912
    s_add_u32 s20, s20, 4096
    buffer_load_dwordx4 v4, s[16:19], s20 offen sc1 lds
    s_add_u32 m0, s21, 127232
    s_add_u32 s20, s20, 319488
    buffer_load_dwordx4 v[212:215], v5, s[16:19], s22 offen sc1
    buffer_load_dwordx4 v[216:219], v6, s[16:19], s23 offen sc1
    s_cmp_lg_u32 s3, 0
    s_cbranch_scc1 k2_vok
    s_max_i32 s87, s87, 100
    s_and_b32 s28, vcc_lo, 16711680
    s_cbranch_scc0 sequentia_d20
    s_mov_b64 exec, 16711680
sequentia_p19:
    s_sleep 2
sequentia_t21:
    buffer_load_dwordx2 v[236:237], v247, s[16:19], 0 offen sc1
    s_waitcnt vmcnt(0)
    v_cmp_ne_u64 vcc, s[84:85], v[236:237]
    s_sub_u32 s87, s87, 1
    s_cbranch_scc1 sequentia_d20
    s_and_b32 s28, vcc_lo, 16711680
    s_cbranch_scc1 sequentia_p19
sequentia_d20:
    s_mov_b64 exec, -1
k2_vok:
    s_mov_b64 exec, 0
    s_cmp_eq_u32 s3, 1
    s_cbranch_scc1 pg_1
    s_cmp_eq_u32 s3, 2
    s_cbranch_scc1 pg_2
    s_cmp_eq_u32 s3, 3
    s_cbranch_scc1 pg_3
    s_cmp_eq_u32 s3, 4
    s_cbranch_scc1 pg_4
    s_cmp_eq_u32 s3, 5
    s_cbranch_scc1 pg_5
    s_cmp_eq_u32 s3, 6
    s_cbranch_scc1 pg_6
    s_cmp_eq_u32 s3, 7
    s_cbranch_scc1 pg_7
pg_ret:
    s_mov_b64 exec, -1
    s_waitcnt vmcnt(0)
    v_and_b32 v216, v7, v216
    v_and_b32 v217, v7, v217
    v_and_b32 v218, v8, v218
    v_and_b32 v219, v8, v219
    s_barrier
    ds_read_b128 v[32:35], v220 offset:0
    ds_read_b128 v[36:39], v221 offset:0
    ds_read_b128 v[40:43], v220 offset:4096
    ds_read_b128 v[44:47], v221 offset:4096
    ds_read_b128 v[48:51], v220 offset:512
    ds_read_b128 v[52:55], v221 offset:512
    s_cmp_eq_u32 s5, 0
    s_cbranch_scc1 k2_first
    s_waitcnt lgkmcnt(4)
    v_mfma_f32_32x32x16_bf16 v[64:79], v[32:35], v[212:215], 0
    buffer_load_dwordx4 v4, s[16:19], s20 offen sc1 lds
    s_add_u32 m0, s21, 135488
    s_add_u32 s20, s20, 4096
    ds_read_b128 v[56:59], v220 offset:1024
    ds_read_b128 v[60:63], v221 offset:1024
    s_waitcnt lgkmcnt(4)
    v_mfma_f32_32x32x16_bf16 v[192:207], v[40:43], v[212:215], 0
    buffer_load_dwordx4 v4, s[16:19], s20 offen sc1 lds
    s_add_u32 m0, s21, 143744
    s_add_u32 s20, s20, 4096
    v_mfma_f32_32x32x16_bf16 v[64:79], v[36:39], v[216:219], v[64:79]
    ds_read_b128 v[32:35], v220 offset:1536
    ds_read_b128 v[36:39], v221 offset:1536
    buffer_load_dwordx4 v4, s[16:19], s20 offen sc1 lds
    s_waitcnt lgkmcnt(4)
    v_mfma_f32_32x32x16_bf16 v[80:95], v[48:51], v[212:215], 0
    buffer_load_dwordx4 v[236:239], v244, s[16:19], 0 offen sc1
    s_and_b32 s20, s4, 7
    s_mul_i32 s20, s20, 102400
    s_add_u32 s20, s20, 25165824
    s_add_u32 s21, s21, 98304
    s_add_u32 s31, s20, s21
    s_add_u32 s28, s21, 8515584
    s_add_u32 s29, s21, 57344
    s_cmp_lt_u32 s3, 4
    s_cselect_b32 s31, s31, s28
    s_cselect_b32 s21, s21, s29
    s_mul_i32 s28, s3, 12288
    s_add_u32 s28, s28, 0
    s_add_u32 s20, s20, s28
    s_mov_b32 m0, s28
    v_mfma_f32_32x32x16_bf16 v[192:207], v[44:47], v[216:219], v[192:207]
    ds_read_b128 v[40:43], v220 offset:2048
    ds_read_b128 v[44:47], v221 offset:2048
    s_waitcnt lgkmcnt(4)
    v_mfma_f32_32x32x16_bf16 v[96:111], v[56:59], v[212:215], 0
    v_mfma_f32_32x32x16_bf16 v[80:95], v[52:55], v[216:219], v[80:95]
    ds_read_b128 v[48:51], v220 offset:2560
    ds_read_b128 v[52:55], v221 offset:2560
    s_waitcnt lgkmcnt(4)
    v_mfma_f32_32x32x16_bf16 v[112:127], v[32:35], v[212:215], 0
    v_cndmask_b32 v64, v64, v192, s[32:33]
    v_cndmask_b32 v65, v65, v193, s[34:35]
    v_cndmask_b32 v66, v66, v194, s[36:37]
    v_cndmask_b32 v67, v67, v195, s[38:39]
    v_cndmask_b32 v68, v68, v196, s[40:41]
    v_cndmask_b32 v69, v69, v197, s[42:43]
    v_mfma_f32_32x32x16_bf16 v[96:111], v[60:63], v[216:219], v[96:111]
    ds_read_b128 v[56:59], v220 offset:3072
    ds_read_b128 v[60:63], v221 offset:3072
    v_cndmask_b32 v70, v70, v198, s[44:45]
    v_cndmask_b32 v71, v71, v199, s[46:47]
    v_cndmask_b32 v72, v72, v200, s[48:49]
    v_cndmask_b32 v73, v73, v201, s[50:51]
    s_waitcnt lgkmcnt(4)
    v_mfma_f32_32x32x16_bf16 v[128:143], v[40:43], v[212:215], 0
    v_cndmask_b32 v74, v74, v202, s[52:53]
    v_cndmask_b32 v75, v75, v203, s[54:55]
    v_cndmask_b32 v76, v76, v204, s[56:57]
    v_cndmask_b32 v77, v77, v205, s[58:59]
    v_cndmask_b32 v78, v78, v206, s[60:61]
    v_cndmask_b32 v79, v79, v207, s[62:63]
    v_mfma_f32_32x32x16_bf16 v[112:127], v[36:39], v[216:219], v[112:127]
    ds_read_b128 v[32:35], v220 offset:3584
    ds_read_b128 v[36:39], v221 offset:3584
    v_max_f32 v208, v64, v65
    v_max_f32 v209, v66, v67
    v_max_f32 v210, v68, v69
    v_max_f32 v211, v70, v71
    v_max3_f32 v208, v208, v72, v73
    v_max3_f32 v209, v209, v74, v75
    s_waitcnt lgkmcnt(4)
    v_mfma_f32_32x32x16_bf16 v[144:159], v[48:51], v[212:215], 0
    v_max3_f32 v210, v210, v76, v77
    v_max3_f32 v211, v211, v78, v79
    v_max3_f32 v208, v208, v80, v81
    v_max3_f32 v209, v209, v82, v83
    v_max3_f32 v210, v210, v84, v85
    v_max3_f32 v211, v211, v86, v87
    v_mfma_f32_32x32x16_bf16 v[128:143], v[44:47], v[216:219], v[128:143]
    v_max3_f32 v208, v208, v88, v89
    v_max3_f32 v209, v209, v90, v91
    v_max3_f32 v210, v210, v92, v93
    v_max3_f32 v211, v211, v94, v95
    v_max3_f32 v208, v208, v96, v97
    v_max3_f32 v209, v209, v98, v99
    s_waitcnt lgkmcnt(2)
    v_mfma_f32_32x32x16_bf16 v[160:175], v[56:59], v[212:215], 0
    v_max3_f32 v210, v210, v100, v101
    v_max3_f32 v211, v211, v102, v103
    v_max3_f32 v208, v208, v104, v105
    v_max3_f32 v209, v209, v106, v107
    v_max3_f32 v210, v210, v108, v109
    v_max3_f32 v211, v211, v110, v111
    v_mfma_f32_32x32x16_bf16 v[144:159], v[52:55], v[216:219], v[144:159]
    v_max3_f32 v208, v208, v112, v113
    v_max3_f32 v209, v209, v114, v115
    v_max3_f32 v210, v210, v116, v117
    v_max3_f32 v211, v211, v118, v119
    v_max3_f32 v208, v208, v120, v121
    v_max3_f32 v209, v209, v122, v123
    s_waitcnt lgkmcnt(0)
    v_mfma_f32_32x32x16_bf16 v[176:191], v[32:35], v[212:215], 0
    v_max3_f32 v210, v210, v124, v125
    v_max3_f32 v211, v211, v126, v127
    v_max3_f32 v208, v208, v128, v129
    v_max3_f32 v209, v209, v130, v131
    v_max3_f32 v210, v210, v132, v133
    v_max3_f32 v211, v211, v134, v135
    v_mfma_f32_32x32x16_bf16 v[160:175], v[60:63], v[216:219], v[160:175]
    v_max3_f32 v208, v208, v136, v137
    v_max3_f32 v209, v209, v138, v139
    v_max3_f32 v210, v210, v140, v141
    v_max3_f32 v211, v211, v142, v143
    v_max3_f32 v208, v208, v144, v145
    v_max3_f32 v209, v209, v146, v147
    v_max3_f32 v210, v210, v148, v149
    v_max3_f32 v211, v211, v150, v151
    v_max3_f32 v208, v208, v152, v153
    v_max3_f32 v209, v209, v154, v155
    v_mfma_f32_32x32x16_bf16 v[176:191], v[36:39], v[216:219], v[176:191]
    v_max3_f32 v210, v210, v156, v157
    v_max3_f32 v211, v211, v158, v159
    v_max3_f32 v208, v208, v160, v161
    v_max3_f32 v209, v209, v162, v163
    v_max3_f32 v210, v210, v164, v165
    v_max3_f32 v211, v211, v166, v167
    v_max3_f32 v208, v208, v168, v169
    v_max3_f32 v209, v209, v170, v171
    v_max3_f32 v210, v210, v172, v173
    v_max3_f32 v211, v211, v174, v175
    s_nop 1
    v_max3_f32 v208, v208, v176, v177
    v_max3_f32 v209, v209, v178, v179
    v_max3_f32 v210, v210, v180, v181
    v_max3_f32 v211, v211, v182, v183
    v_max3_f32 v208, v208, v184, v185
    v_max3_f32 v209, v209, v186, v187
    v_max3_f32 v210, v210, v188, v189
    v_max3_f32 v211, v211, v190, v191
k2_back:
    v_max3_f32 v208, v208, v209, v210
    v_max_f32 v208, v208, v211
    v_mov_b32 v209, v208
    s_nop 1
    v_permlane32_swap_b32 v208, v209
    v_max_f32 v208, v208, v209
    v_cvt_pk_bf16_f32 v209, v208, v208
    v_lshlrev_b32 v209, 16, v209
    v_sub_f32 v208, v209, v208
    v_cvt_pk_bf16_f32 v232, -v209, v208
    s_nop 1
    v_mfma_f32_32x32x16_bf16 v[64:79], v[228:231], v[232:235], v[64:79]
    v_mfma_f32_32x32x16_bf16 v[80:95], v[228:231], v[232:235], v[80:95]
    v_mov_b32 v208, s84
    v_mov_b32 v209, s85
    v_mov_b32 v9, 0
    s_getreg_b32 s30, hwreg(HW_REG_XCC_ID, 0, 4)
    v_exp_f32 v64, v64
    v_exp_f32 v65, v65
    v_exp_f32 v66, v66
    v_exp_f32 v67, v67
    v_cvt_pk_bf16_f32 v64, v64, v65
    v_exp_f32 v68, v68
    v_exp_f32 v69, v69
    v_cvt_pk_bf16_f32 v65, v66, v67
    v_exp_f32 v70, v70
    v_exp_f32 v71, v71
    v_mfma_f32_32x32x16_bf16 v[96:111], v[228:231], v[232:235], v[96:111]
    v_cvt_pk_bf16_f32 v66, v68, v69
    v_exp_f32 v72, v72
    v_exp_f32 v73, v73
    v_cvt_pk_bf16_f32 v67, v70, v71
    v_exp_f32 v74, v74
    v_exp_f32 v75, v75
    v_cvt_pk_bf16_f32 v68, v72, v73
    v_exp_f32 v76, v76
    v_exp_f32 v77, v77
    v_cvt_pk_bf16_f32 v69, v74, v75
    buffer_load_dwordx4 v4, s[16:19], s20 offen offset:0 sc1 lds
    v_exp_f32 v78, v78
    v_exp_f32 v79, v79
    v_cvt_pk_bf16_f32 v70, v76, v77
    v_cvt_pk_bf16_f32 v71, v78, v79
    v_and_b32 v192, v24, v64
    v_xor_b32 v64, v192, v64
    v_and_b32 v193, v25, v65
    v_xor_b32 v65, v193, v65
    v_and_b32 v194, v26, v66
    v_xor_b32 v66, v194, v66
    buffer_load_dwordx4 v4, s[16:19], s20 offen offset:1024 sc1 lds
    v_and_b32 v195, v27, v67
    v_xor_b32 v67, v195, v67
    v_and_b32 v196, v28, v68
    v_xor_b32 v68, v196, v68
    v_and_b32 v197, v29, v69
    v_xor_b32 v69, v197, v69
    v_and_b32 v198, v30, v70
    v_xor_b32 v70, v198, v70
    v_and_b32 v199, v31, v71
    v_xor_b32 v71, v199, v71
    buffer_load_dwordx4 v4, s[16:19], s20 offen offset:2048 sc1 lds
    v_exp_f32 v80, v80
    v_exp_f32 v81, v81
    v_exp_f32 v82, v82
    v_exp_f32 v83, v83
    v_cvt_pk_bf16_f32 v80, v80, v81
    v_exp_f32 v84, v84
    v_mfma_f32_32x32x16_bf16 v[112:127], v[228:231], v[232:235], v[112:127]
    v_exp_f32 v85, v85
    v_cvt_pk_bf16_f32 v81, v82, v83
    v_exp_f32 v86, v86
    v_exp_f32 v87, v87
    v_cvt_pk_bf16_f32 v82, v84, v85
    v_exp_f32 v88, v88
    buffer_load_dwordx4 v4, s[16:19], s20 offen offset:3072 sc1 lds
    s_add_u32 m0, m0, 4096
    s_add_u32 s20, s20, 4096
    v_exp_f32 v89, v89
    v_cvt_pk_bf16_f32 v83, v86, v87
    v_exp_f32 v90, v90
    v_exp_f32 v91, v91
    v_cvt_pk_bf16_f32 v84, v88, v89
    v_exp_f32 v92, v92
    buffer_load_dwordx4 v4, s[16:19], s20 offen offset:0 sc1 lds
    v_exp_f32 v93, v93
    v_cvt_pk_bf16_f32 v85, v90, v91
    v_exp_f32 v94, v94
    v_exp_f32 v95, v95
    v_cvt_pk_bf16_f32 v86, v92, v93
    v_cvt_pk_bf16_f32 v87, v94, v95
    buffer_load_dwordx4 v4, s[16:19], s20 offen offset:1024 sc1 lds
    s_setprio 3
    s_waitcnt vmcnt(6)
    v_cmp_ne_u64 s[88:89], s[84:85], v[238:239]
    v_cmp_ne_u64 vcc, s[84:85], v[236:237]
    s_nop 0
    s_lshr_b64 s[88:89], s[88:89], 32
    s_or_b64 vcc, vcc, s[88:89]
    s_cbranch_scc1 k2_xw
k2_xb:
    v_cmp_ne_u32 vcc, s30, v238
    s_barrier
    ds_read_b64_tr_b16 v[32:33], v20 offset:0
    ds_read_b64_tr_b16 v[34:35], v20 offset:64
    ds_read_b64_tr_b16 v[36:37], v20 offset:256
    ds_read_b64_tr_b16 v[38:39], v20 offset:320
    ds_read_b64_tr_b16 v[40:41], v20 offset:4096
    ds_read_b64_tr_b16 v[42:43], v20 offset:4160
    ds_read_b64_tr_b16 v[44:45], v20 offset:4352
    ds_read_b64_tr_b16 v[46:47], v20 offset:4416
    ds_read_b64_tr_b16 v[48:49], v20 offset:512
    ds_read_b64_tr_b16 v[50:51], v20 offset:576
    ds_read_b64_tr_b16 v[52:53], v20 offset:768
    ds_read_b64_tr_b16 v[54:55], v20 offset:832
    s_mov_b32 s86, vcc_lo
    v_exp_f32 v96, v96
    v_exp_f32 v97, v97
    v_mfma_f32_32x32x16_bf16 v[128:143], v[228:231], v[232:235], v[128:143]
    v_exp_f32 v98, v98
    v_exp_f32 v99, v99
    buffer_load_dwordx4 v4, s[16:19], s20 offen offset:2048 sc1 lds
    v_cvt_pk_bf16_f32 v96, v96, v97
    v_exp_f32 v100, v100
    s_waitcnt lgkmcnt(8)
    v_mfma_f32_32x32x16_bf16 v[212:227], v[32:35], v[64:67], 0
    v_exp_f32 v101, v101
    v_cvt_pk_bf16_f32 v97, v98, v99
    buffer_load_dwordx4 v4, s[16:19], s20 offen offset:3072 sc1 lds
    s_add_u32 m0, m0, 4096
    s_add_u32 s20, s20, 4096
    v_exp_f32 v102, v102
    v_exp_f32 v103, v103
    v_mfma_f32_32x32x16_bf16 v[212:227], v[36:39], v[68:71], v[212:227]
    ds_read_b64_tr_b16 v[56:57], v20 offset:1024
    ds_read_b64_tr_b16 v[58:59], v20 offset:1088
    ds_read_b64_tr_b16 v[60:61], v20 offset:1280
    ds_read_b64_tr_b16 v[62:63], v20 offset:1344
    v_cvt_pk_bf16_f32 v98, v100, v101
    v_exp_f32 v104, v104
    buffer_load_dwordx4 v4, s[16:19], s20 offen offset:0 sc1 lds
    v_exp_f32 v105, v105
    v_cvt_pk_bf16_f32 v99, v102, v103
    s_waitcnt lgkmcnt(8)
    v_mfma_f32_32x32x16_bf16 v[212:227], v[40:43], v[192:195], v[212:227]
    v_exp_f32 v106, v106
    v_exp_f32 v107, v107
    v_mfma_f32_32x32x16_bf16 v[212:227], v[44:47], v[196:199], v[212:227]
    ds_read_b64_tr_b16 v[32:33], v20 offset:1536
    ds_read_b64_tr_b16 v[34:35], v20 offset:1600
    ds_read_b64_tr_b16 v[36:37], v20 offset:1792
    ds_read_b64_tr_b16 v[38:39], v20 offset:1856
    v_cvt_pk_bf16_f32 v100, v104, v105
    v_exp_f32 v108, v108
    s_waitcnt lgkmcnt(8)
    v_mfma_f32_32x32x16_bf16 v[212:227], v[48:51], v[80:83], v[212:227]
    v_exp_f32 v109, v109
    v_cvt_pk_bf16_f32 v101, v106, v107
    v_mfma_f32_32x32x16_bf16 v[212:227], v[52:55], v[84:87], v[212:227]
    ds_read_b64_tr_b16 v[40:41], v20 offset:2048
    ds_read_b64_tr_b16 v[42:43], v20 offset:2112
    ds_read_b64_tr_b16 v[44:45], v20 offset:2304
    ds_read_b64_tr_b16 v[46:47], v20 offset:2368
    v_exp_f32 v110, v110
    v_exp_f32 v111, v111
    v_cvt_pk_bf16_f32 v102, v108, v109
    v_cvt_pk_bf16_f32 v103, v110, v111
    v_exp_f32 v112, v112
    v_exp_f32 v113, v113
    v_exp_f32 v114, v114
    v_exp_f32 v115, v115
    v_mfma_f32_32x32x16_bf16 v[144:159], v[228:231], v[232:235], v[144:159]
    v_cvt_pk_bf16_f32 v112, v112, v113
    v_exp_f32 v116, v116
    v_exp_f32 v117, v117
    v_cvt_pk_bf16_f32 v113, v114, v115
    buffer_load_dwordx4 v4, s[16:19], s20 offen offset:1024 sc1 lds
    v_exp_f32 v118, v118
    v_exp_f32 v119, v119
    v_cvt_pk_bf16_f32 v114, v116, v117
    v_exp_f32 v120, v120
    s_waitcnt lgkmcnt(8)
    v_mfma_f32_32x32x16_bf16 v[212:227], v[56:59], v[96:99], v[212:227]
    v_exp_f32 v121, v121
    v_cvt_pk_bf16_f32 v115, v118, v119
    v_exp_f32 v122, v122
    v_exp_f32 v123, v123
    buffer_load_dwordx4 v4, s[16:19], s20 offen offset:2048 sc1 lds
    v_cvt_pk_bf16_f32 v116, v120, v121
    v_exp_f32 v124, v124
    v_exp_f32 v125, v125
    v_cvt_pk_bf16_f32 v117, v122, v123
    v_mfma_f32_32x32x16_bf16 v[212:227], v[60:63], v[100:103], v[212:227]
    ds_read_b64_tr_b16 v[48:49], v20 offset:2560
    ds_read_b64_tr_b16 v[50:51], v20 offset:2624
    ds_read_b64_tr_b16 v[52:53], v20 offset:2816
    ds_read_b64_tr_b16 v[54:55], v20 offset:2880
    v_exp_f32 v126, v126
    v_exp_f32 v127, v127
    v_cvt_pk_bf16_f32 v118, v124, v125
    v_cvt_pk_bf16_f32 v119, v126, v127
    buffer_load_dwordx4 v4, s[16:19], s20 offen offset:3072 sc1 lds
    s_mov_b32 m0, s21
    s_setprio 2
    v_exp_f32 v128, v128
    v_exp_f32 v129, v129
    v_exp_f32 v130, v130
    v_exp_f32 v131, v131
    v_mfma_f32_32x32x16_bf16 v[160:175], v[228:231], v[232:235], v[160:175]
    v_cvt_pk_bf16_f32 v128, v128, v129
    v_exp_f32 v132, v132
    v_exp_f32 v133, v133
    v_cvt_pk_bf16_f32 v129, v130, v131
    buffer_load_dwordx4 v4, s[16:19], s31 offen sc1 lds
    s_mov_b32 m0, s70
    v_exp_f32 v134, v134
    v_exp_f32 v135, v135
    v_cvt_pk_bf16_f32 v130, v132, v133
    v_exp_f32 v136, v136
    s_waitcnt lgkmcnt(8)
    v_mfma_f32_32x32x16_bf16 v[212:227], v[32:35], v[112:115], v[212:227]
    v_exp_f32 v137, v137
    v_cvt_pk_bf16_f32 v131, v134, v135
    v_exp_f32 v138, v138
    v_exp_f32 v139, v139
    buffer_load_dwordx4 v4, s[16:19], s69 offen offset:0 sc1 lds
    v_cvt_pk_bf16_f32 v132, v136, v137
    v_exp_f32 v140, v140
    v_exp_f32 v141, v141
    v_cvt_pk_bf16_f32 v133, v138, v139
    v_mfma_f32_32x32x16_bf16 v[212:227], v[36:39], v[116:119], v[212:227]
    ds_read_b64_tr_b16 v[56:57], v20 offset:3072
    ds_read_b64_tr_b16 v[58:59], v20 offset:3136
    ds_read_b64_tr_b16 v[60:61], v20 offset:3328
    ds_read_b64_tr_b16 v[62:63], v20 offset:3392
    v_exp_f32 v142, v142
    v_exp_f32 v143, v143
    v_cvt_pk_bf16_f32 v134, v140, v141
    v_cvt_pk_bf16_f32 v135, v142, v143
    buffer_load_dwordx4 v4, s[16:19], s69 offen offset:1024 sc1 lds
    s_lshl_b32 s38, s4, 3
    s_add_u32 s38, s38, s3
    s_mul_i32 s38, s38, 1408
    s_add_u32 s38, s38, s25
    v_min_u32 v247, 10, v1
    v_lshlrev_b32 v247, 7, v247
    v_exp_f32 v144, v144
    v_exp_f32 v145, v145
    v_exp_f32 v146, v146
    v_exp_f32 v147, v147
    v_mfma_f32_32x32x16_bf16 v[176:191], v[228:231], v[232:235], v[176:191]
    v_cvt_pk_bf16_f32 v144, v144, v145
    v_exp_f32 v148, v148
    v_exp_f32 v149, v149
    v_cvt_pk_bf16_f32 v145, v146, v147
    buffer_load_dwordx4 v4, s[16:19], s69 offen offset:2048 sc1 lds
    v_exp_f32 v150, v150
    v_exp_f32 v151, v151
    v_cvt_pk_bf16_f32 v146, v148, v149
    v_exp_f32 v152, v152
    s_waitcnt lgkmcnt(8)
    v_mfma_f32_32x32x16_bf16 v[212:227], v[40:43], v[128:131], v[212:227]
    v_exp_f32 v153, v153
    v_cvt_pk_bf16_f32 v147, v150, v151
    v_exp_f32 v154, v154
    v_exp_f32 v155, v155
    buffer_load_dword v240, v247, s[16:19], s38 offen
    v_cvt_pk_bf16_f32 v148, v152, v153
    v_exp_f32 v156, v156
    v_exp_f32 v157, v157
    v_cvt_pk_bf16_f32 v149, v154, v155
    v_mfma_f32_32x32x16_bf16 v[212:227], v[44:47], v[132:135], v[212:227]
    ds_read_b64_tr_b16 v[32:33], v20 offset:3584
    ds_read_b64_tr_b16 v[34:35], v20 offset:3648
    ds_read_b64_tr_b16 v[36:37], v20 offset:3840
    ds_read_b64_tr_b16 v[38:39], v20 offset:3904
    v_exp_f32 v158, v158
    v_exp_f32 v159, v159
    v_cvt_pk_bf16_f32 v150, v156, v157
    v_cvt_pk_bf16_f32 v151, v158, v159
    s_setprio 1
    v_exp_f32 v160, v160
    v_exp_f32 v161, v161
    v_exp_f32 v162, v162
    v_exp_f32 v163, v163
    v_cvt_pk_bf16_f32 v160, v160, v161
    v_exp_f32 v164, v164
    v_exp_f32 v165, v165
    v_cvt_pk_bf16_f32 v161, v162, v163
    v_exp_f32 v166, v166
    v_exp_f32 v167, v167
    v_cvt_pk_bf16_f32 v162, v164, v165
    v_exp_f32 v168, v168
    s_waitcnt lgkmcnt(8)
    v_mfma_f32_32x32x16_bf16 v[212:227], v[48:51], v[144:147], v[212:227]
    v_exp_f32 v169, v169
    v_cvt_pk_bf16_f32 v163, v166, v167
    v_exp_f32 v170, v170
    v_exp_f32 v171, v171
    v_cvt_pk_bf16_f32 v164, v168, v169
    v_exp_f32 v172, v172
    v_exp_f32 v173, v173
    v_cvt_pk_bf16_f32 v165, v170, v171
    v_exp_f32 v174, v174
    v_exp_f32 v175, v175
    v_cvt_pk_bf16_f32 v166, v172, v173
    v_cvt_pk_bf16_f32 v167, v174, v175
    v_mfma_f32_32x32x16_bf16 v[212:227], v[52:55], v[148:151], v[212:227]
    v_exp_f32 v176, v176
    v_exp_f32 v177, v177
    s_waitcnt lgkmcnt(4)
    v_mfma_f32_32x32x16_bf16 v[212:227], v[56:59], v[160:163], v[212:227]
    v_exp_f32 v178, v178
    v_exp_f32 v179, v179
    v_cvt_pk_bf16_f32 v176, v176, v177
    v_exp_f32 v180, v180
    v_exp_f32 v181, v181
    v_cvt_pk_bf16_f32 v177, v178, v179
    v_mfma_f32_32x32x16_bf16 v[212:227], v[60:63], v[164:167], v[212:227]
    v_exp_f32 v182, v182
    v_exp_f32 v183, v183
    v_cvt_pk_bf16_f32 v178, v180, v181
    v_exp_f32 v184, v184
    v_exp_f32 v185, v185
    v_cvt_pk_bf16_f32 v179, v182, v183
    v_exp_f32 v186, v186
    v_exp_f32 v187, v187
    s_waitcnt lgkmcnt(0)
    v_mfma_f32_32x32x16_bf16 v[212:227], v[32:35], v[176:179], v[212:227]
    v_cvt_pk_bf16_f32 v180, v184, v185
    v_exp_f32 v188, v188
    v_exp_f32 v189, v189
    v_cvt_pk_bf16_f32 v181, v186, v187
    v_exp_f32 v190, v190
    v_exp_f32 v191, v191
    v_cvt_pk_bf16_f32 v182, v188, v189
    v_cvt_pk_bf16_f32 v183, v190, v191
    s_setprio 0
    s_nop 0
    v_mfma_f32_32x32x16_bf16 v[212:227], v[36:39], v[180:183], v[212:227]
    s_setprio 0
    s_lshl_b32 s28, s24, 3
    s_add_u32 s23, s23, s28
    s_lshl_b32 s28, s3, 5
    s_add_u32 s28, s28, s4
    s_lshl_b32 s28, s28, 3
    s_add_u32 s28, s28, s25
    s_add_u32 s28, s28, 360448
    s_nop 3
    v_rcp_f32 v210, v224
    s_nop 0
    v_pk_mul_f32 v[212:213], v[212:213], v[210:211] op_sel_hi:[1,0]
    v_pk_mul_f32 v[214:215], v[214:215], v[210:211] op_sel_hi:[1,0]
    v_pk_mul_f32 v[216:217], v[216:217], v[210:211] op_sel_hi:[1,0]
    v_pk_mul_f32 v[218:219], v[218:219], v[210:211] op_sel_hi:[1,0]
    v_pk_mul_f32 v[220:221], v[220:221], v[210:211] op_sel_hi:[1,0]
    v_pk_mul_f32 v[222:223], v[222:223], v[210:211] op_sel_hi:[1,0]
    v_cvt_pk_bf16_f32 v212, v212, v213
    v_cvt_pk_bf16_f32 v213, v214, v215
    v_cvt_pk_bf16_f32 v214, v216, v217
    v_cvt_pk_bf16_f32 v215, v218, v219
    v_cvt_pk_bf16_f32 v216, v220, v221
    v_cvt_pk_bf16_f32 v217, v222, v223
    s_cmp_lg_u32 s86, 0
    s_cbranch_scc1 sequentia_s25
    buffer_store_dwordx4 v[212:215], v5, s[16:19], s22 offen
    s_mov_b32 exec_hi, 0
    buffer_store_dwordx2 v[216:217], v6, s[16:19], s23 offen
    s_mov_b32 exec_hi, -1
sequentia_b26:
    s_cmp_ge_u32 s3, 4
    s_cbranch_scc1 k3_loader
    v_mov_b32 v24, v4
    v_add_u32 v25, 0x10000, v4
    v_add_u32 v26, 0x20000, v4
    v_mov_b32 v2, v4
    v_mov_b32 v7, v22
    v_mov_b32 v8, v23
    v_mov_b32 v248, v24
    v_mov_b32 v249, v25
    v_mov_b32 v250, v26
    v_lshrrev_b32 v251, 4, v1
    v_lshlrev_b32 v251, 5, v251
    v_and_b32 v3, 1, v1
    v_lshl_add_u32 v251, v3, 4, v251
    v_add_u32 v251, 159744, v251
    v_mov_b32 v252, v208
    v_mov_b32 v253, v209
    v_and_b32 v3, 15, v1
    v_lshrrev_b32 v4, 4, v1
    v_lshlrev_b32 v5, 12, v4
    v_lshl_add_u32 v243, v3, 4, v5
    s_lshr_b32 s30, s4, 3
    s_lshl_b32 s30, s30, 2
    s_add_u32 s30, s30, s3
    s_mul_i32 s31, s5, 983040
    s_lshl_b32 s32, s30, 8
    s_add_u32 s31, s31, s32
    s_lshr_b32 s32, s30, 1
    s_lshl_b32 s33, s32, 8
    s_add_u32 s33, s33, s25
    s_add_u32 s33, s33, 360448
    v_lshlrev_b32 v6, 3, v1
    s_waitcnt vmcnt(0)
    s_cmp_lg_u32 s86, 0
    s_cbranch_scc1 sequentia_s27
    s_mov_b64 exec, 1
    buffer_store_dwordx2 v[252:253], v9, s[16:19], s28 offen
    s_mov_b64 exec, -1
sequentia_b28:
    v_mul_f32 v244, 0x3acccccd, v254
    v_mov_b32 v245, 0
    v_mov_b32 v246, 0
    v_mov_b32 v247, 0
    s_barrier
    ds_read_b128 v[120:123], v248 offset:0
    ds_read_b128 v[124:127], v248 offset:1024
    ds_read_b128 v[128:131], v248 offset:2048
    ds_read_b128 v[132:135], v248 offset:3072
    ds_read_b128 v[136:139], v248 offset:4096
    ds_read_b128 v[140:143], v251 offset:0
    ds_read_b128 v[144:147], v248 offset:5120
    ds_read_b128 v[148:151], v248 offset:6144
    ds_read_b128 v[152:155], v248 offset:7168
    ds_read_b128 v[156:159], v248 offset:8192
    ds_read_b128 v[160:163], v248 offset:9216
    ds_read_b128 v[164:167], v251 offset:128
    ds_read_b128 v[168:171], v248 offset:10240
    ds_read_b128 v[172:175], v248 offset:11264
    ds_read_b128 v[176:179], v248 offset:12288
    ds_read_b128 v[180:183], v248 offset:13312
    ds_read_b128 v[184:187], v248 offset:14336
    ds_read_b128 v[188:191], v251 offset:256
    ds_read_b128 v[192:195], v248 offset:15360
    ds_read_b128 v[196:199], v248 offset:16384
    ds_read_b128 v[200:203], v248 offset:17408
    ds_read_b128 v[204:207], v248 offset:18432
    ds_read_b128 v[208:211], v248 offset:19456
    ds_read_b128 v[212:215], v251 offset:384
    v_lshlrev_b32 v20, 16, v10
    v_and_b32 v21, 0xffff0000, v10
    v_lshlrev_b32 v22, 16, v11
    v_and_b32 v23, 0xffff0000, v11
    v_lshlrev_b32 v24, 16, v12
    v_and_b32 v25, 0xffff0000, v12
    v_lshlrev_b32 v26, 16, v13
    v_and_b32 v27, 0xffff0000, v13
    v_lshlrev_b32 v28, 16, v14
    v_and_b32 v29, 0xffff0000, v14
    v_lshlrev_b32 v30, 16, v15
    v_and_b32 v31, 0xffff0000, v15
    v_lshlrev_b32 v32, 16, v16
    v_and_b32 v33, 0xffff0000, v16
    v_lshlrev_b32 v34, 16, v17
    v_and_b32 v35, 0xffff0000, v17
    v_lshlrev_b32 v36, 16, v18
    v_and_b32 v37, 0xffff0000, v18
    v_lshlrev_b32 v38, 16, v19
    v_and_b32 v39, 0xffff0000, v19
    s_mov_b32 exec_lo, 0xffffffff
    s_mov_b32 exec_hi, 0x0
    s_max_i32 s87, s87, 100
sequentia_p29:
    buffer_load_dwordx2 v[240:241], v6, s[16:19], s33 offen sc1
sequentia_t31:
    s_waitcnt vmcnt(0)
    v_cmp_ne_u64 vcc, s[84:85], v[240:241]
    s_sub_u32 s87, s87, 1
    s_cbranch_scc1 sequentia_d30
    s_cbranch_vccnz sequentia_p29
sequentia_d30:
    s_mov_b64 exec, -1
    buffer_load_dwordx4 v[40:43], v243, s[16:19], s31 offen sc1
    s_add_u32 s31, s31, 16384
    buffer_load_dwordx4 v[44:47], v243, s[16:19], s31 offen sc1
    s_add_u32 s31, s31, 16384
    buffer_load_dwordx4 v[48:51], v243, s[16:19], s31 offen sc1
    s_add_u32 s31, s31, 16384
    buffer_load_dwordx4 v[52:55], v243, s[16:19], s31 offen sc1
    s_add_u32 s31, s31, 16384
    buffer_load_dwordx4 v[56:59], v243, s[16:19], s31 offen sc1
    s_add_u32 s31, s31, 16384
    buffer_load_dwordx4 v[60:63], v243, s[16:19], s31 offen sc1
    s_add_u32 s31, s31, 16384
    buffer_load_dwordx4 v[64:67], v243, s[16:19], s31 offen sc1
    s_add_u32 s31, s31, 16384
    buffer_load_dwordx4 v[68:71], v243, s[16:19], s31 offen sc1
    s_add_u32 s31, s31, 16384
    buffer_load_dwordx4 v[72:75], v243, s[16:19], s31 offen sc1
    s_add_u32 s31, s31, 16384
    buffer_load_dwordx4 v[76:79], v243, s[16:19], s31 offen sc1
    s_add_u32 s31, s31, 16384
    s_and_b32 s34, s3, 1
    s_lshl_b32 s34, s34, 8
    v_lshl_add_u32 v6, v3, 4, s34
    v_lshl_add_u32 v5, v4, 9, v6
    v_lshrrev_b32 v9, 1, v4
    v_lshl_add_u32 v9, v9, 9, v6
    v_and_b32 v4, 1, v4
    v_lshl_add_u32 v9, v4, 3, v9
    s_mul_i32 s34, s32, 40960
    s_and_b32 s35, s4, 7
    s_mul_i32 s36, s35, 5120
pg_1:
    s_cbranch_execz pg_ret
    s_add_u32 s34, s34, s36
    s_add_u32 s34, s34, s25
    s_add_u32 s36, s34, 4096
    s_lshl_b32 s37, s32, 3
    s_add_u32 s37, s37, s35
    s_lshl_b32 s37, s37, 9
    s_add_u32 s37, s37, s25
    s_add_u32 s37, s37, 327680
    s_waitcnt vmcnt(9) lgkmcnt(15)
    v_mfma_f32_16x16x32_bf16 v[244:247], v[140:143], v[40:43], v[244:247]
    ds_read_b128 v[216:219], v248 offset:20480
    v_mfma_f32_16x16x32_bf16 v[20:23], v[120:123], v[40:43], v[20:23]
    ds_read_b128 v[220:223], v248 offset:21504
    v_mfma_f32_16x16x32_bf16 v[24:27], v[124:127], v[40:43], v[24:27]
    ds_read_b128 v[224:227], v248 offset:22528
    v_mfma_f32_16x16x32_bf16 v[28:31], v[128:131], v[40:43], v[28:31]
    ds_read_b128 v[228:231], v248 offset:23552
    v_mfma_f32_16x16x32_bf16 v[32:35], v[132:135], v[40:43], v[32:35]
    ds_read_b128 v[232:235], v248 offset:24576
    v_mfma_f32_16x16x32_bf16 v[36:39], v[136:139], v[40:43], v[36:39]
    ds_read_b128 v[236:239], v251 offset:512
    buffer_load_dwordx4 v[80:83], v243, s[16:19], s31 offen sc1
    s_add_u32 s31, s31, 16384
    buffer_load_dwordx4 v[84:87], v243, s[16:19], s31 offen sc1
    s_add_u32 s31, s31, 16384
    s_waitcnt vmcnt(10) lgkmcnt(15)
    v_mfma_f32_16x16x32_bf16 v[244:247], v[164:167], v[44:47], v[244:247]
    ds_read_b128 v[120:123], v248 offset:25600
    v_mfma_f32_16x16x32_bf16 v[20:23], v[144:147], v[44:47], v[20:23]
    ds_read_b128 v[124:127], v248 offset:26624
    v_mfma_f32_16x16x32_bf16 v[24:27], v[148:151], v[44:47], v[24:27]
    ds_read_b128 v[128:131], v248 offset:27648
    v_mfma_f32_16x16x32_bf16 v[28:31], v[152:155], v[44:47], v[28:31]
    ds_read_b128 v[132:135], v248 offset:28672
    v_mfma_f32_16x16x32_bf16 v[32:35], v[156:159], v[44:47], v[32:35]
    ds_read_b128 v[136:139], v248 offset:29696
    v_mfma_f32_16x16x32_bf16 v[36:39], v[160:163], v[44:47], v[36:39]
    ds_read_b128 v[140:143], v251 offset:640
    buffer_load_dwordx4 v[88:91], v243, s[16:19], s31 offen sc1
    s_add_u32 s31, s31, 16384
    buffer_load_dwordx4 v[92:95], v243, s[16:19], s31 offen sc1
    s_add_u32 s31, s31, 16384
    s_waitcnt vmcnt(11) lgkmcnt(15)
    v_mfma_f32_16x16x32_bf16 v[244:247], v[188:191], v[48:51], v[244:247]
    ds_read_b128 v[144:147], v248 offset:30720
    v_mfma_f32_16x16x32_bf16 v[20:23], v[168:171], v[48:51], v[20:23]
    ds_read_b128 v[148:151], v248 offset:31744
    v_mfma_f32_16x16x32_bf16 v[24:27], v[172:175], v[48:51], v[24:27]
    ds_read_b128 v[152:155], v248 offset:32768
    v_mfma_f32_16x16x32_bf16 v[28:31], v[176:179], v[48:51], v[28:31]
    ds_read_b128 v[156:159], v248 offset:33792
    v_mfma_f32_16x16x32_bf16 v[32:35], v[180:183], v[48:51], v[32:35]
    ds_read_b128 v[160:163], v248 offset:34816
    v_mfma_f32_16x16x32_bf16 v[36:39], v[184:187], v[48:51], v[36:39]
    ds_read_b128 v[164:167], v251 offset:768
    buffer_load_dwordx4 v[96:99], v243, s[16:19], s31 offen sc1
    s_add_u32 s31, s31, 16384
    buffer_load_dwordx4 v[100:103], v243, s[16:19], s31 offen sc1
    s_add_u32 s31, s31, 16384
    s_waitcnt vmcnt(12) lgkmcnt(15)
    v_mfma_f32_16x16x32_bf16 v[244:247], v[212:215], v[52:55], v[244:247]
    ds_read_b128 v[168:171], v248 offset:35840
    v_mfma_f32_16x16x32_bf16 v[20:23], v[192:195], v[52:55], v[20:23]
    ds_read_b128 v[172:175], v248 offset:36864
    v_mfma_f32_16x16x32_bf16 v[24:27], v[196:199], v[52:55], v[24:27]
    ds_read_b128 v[176:179], v248 offset:37888
    v_mfma_f32_16x16x32_bf16 v[28:31], v[200:203], v[52:55], v[28:31]
    ds_read_b128 v[180:183], v248 offset:38912
    v_mfma_f32_16x16x32_bf16 v[32:35], v[204:207], v[52:55], v[32:35]
    ds_read_b128 v[184:187], v248 offset:39936
    v_mfma_f32_16x16x32_bf16 v[36:39], v[208:211], v[52:55], v[36:39]
    ds_read_b128 v[188:191], v251 offset:896
    buffer_load_dwordx4 v[104:107], v243, s[16:19], s31 offen sc1
    s_add_u32 s31, s31, 16384
    buffer_load_dwordx4 v[108:111], v243, s[16:19], s31 offen sc1
    s_add_u32 s31, s31, 16384
    s_waitcnt vmcnt(13) lgkmcnt(15)
    v_mfma_f32_16x16x32_bf16 v[244:247], v[236:239], v[56:59], v[244:247]
    ds_read_b128 v[192:195], v248 offset:40960
    v_mfma_f32_16x16x32_bf16 v[20:23], v[216:219], v[56:59], v[20:23]
    ds_read_b128 v[196:199], v248 offset:41984
    v_mfma_f32_16x16x32_bf16 v[24:27], v[220:223], v[56:59], v[24:27]
    ds_read_b128 v[200:203], v248 offset:43008
    v_mfma_f32_16x16x32_bf16 v[28:31], v[224:227], v[56:59], v[28:31]
    ds_read_b128 v[204:207], v248 offset:44032
    v_mfma_f32_16x16x32_bf16 v[32:35], v[228:231], v[56:59], v[32:35]
    ds_read_b128 v[208:211], v248 offset:45056
    v_mfma_f32_16x16x32_bf16 v[36:39], v[232:235], v[56:59], v[36:39]
    ds_read_b128 v[212:215], v251 offset:1024
    buffer_load_dwordx4 v[112:115], v243, s[16:19], s31 offen sc1
    s_add_u32 s31, s31, 16384
    buffer_load_dwordx4 v[116:119], v243, s[16:19], s31 offen sc1
    s_barrier
    s_waitcnt vmcnt(14) lgkmcnt(15)
    s_barrier
    v_mfma_f32_16x16x32_bf16 v[244:247], v[140:143], v[60:63], v[244:247]
    ds_read_b128 v[216:219], v248 offset:46080
    v_mfma_f32_16x16x32_bf16 v[20:23], v[120:123], v[60:63], v[20:23]
    ds_read_b128 v[220:223], v248 offset:47104
    v_mfma_f32_16x16x32_bf16 v[24:27], v[124:127], v[60:63], v[24:27]
    ds_read_b128 v[224:227], v248 offset:48128
    v_mfma_f32_16x16x32_bf16 v[28:31], v[128:131], v[60:63], v[28:31]
    ds_read_b128 v[228:231], v248 offset:49152
    v_mfma_f32_16x16x32_bf16 v[32:35], v[132:135], v[60:63], v[32:35]
    ds_read_b128 v[232:235], v248 offset:50176
    v_mfma_f32_16x16x32_bf16 v[36:39], v[136:139], v[60:63], v[36:39]
    ds_read_b128 v[236:239], v251 offset:1152
    s_waitcnt vmcnt(13) lgkmcnt(15)
    v_mfma_f32_16x16x32_bf16 v[244:247], v[164:167], v[64:67], v[244:247]
    ds_read_b128 v[120:123], v248 offset:51200
    v_mfma_f32_16x16x32_bf16 v[20:23], v[144:147], v[64:67], v[20:23]
    ds_read_b128 v[124:127], v248 offset:52224
    v_mfma_f32_16x16x32_bf16 v[24:27], v[148:151], v[64:67], v[24:27]
    ds_read_b128 v[128:131], v248 offset:53248
    v_mfma_f32_16x16x32_bf16 v[28:31], v[152:155], v[64:67], v[28:31]
    ds_read_b128 v[132:135], v248 offset:54272
    v_mfma_f32_16x16x32_bf16 v[32:35], v[156:159], v[64:67], v[32:35]
    ds_read_b128 v[136:139], v248 offset:55296
    v_mfma_f32_16x16x32_bf16 v[36:39], v[160:163], v[64:67], v[36:39]
    ds_read_b128 v[140:143], v251 offset:1280
    s_waitcnt vmcnt(12) lgkmcnt(15)
    v_mfma_f32_16x16x32_bf16 v[244:247], v[188:191], v[68:71], v[244:247]
    ds_read_b128 v[144:147], v248 offset:56320
    v_mfma_f32_16x16x32_bf16 v[20:23], v[168:171], v[68:71], v[20:23]
    ds_read_b128 v[148:151], v248 offset:57344
    v_mfma_f32_16x16x32_bf16 v[24:27], v[172:175], v[68:71], v[24:27]
    ds_read_b128 v[152:155], v248 offset:58368
    v_mfma_f32_16x16x32_bf16 v[28:31], v[176:179], v[68:71], v[28:31]
    ds_read_b128 v[156:159], v248 offset:59392
    v_mfma_f32_16x16x32_bf16 v[32:35], v[180:183], v[68:71], v[32:35]
    ds_read_b128 v[160:163], v248 offset:60416
    v_mfma_f32_16x16x32_bf16 v[36:39], v[184:187], v[68:71], v[36:39]
    ds_read_b128 v[164:167], v251 offset:1408
    s_waitcnt vmcnt(11) lgkmcnt(15)
    v_mfma_f32_16x16x32_bf16 v[244:247], v[212:215], v[72:75], v[244:247]
    ds_read_b128 v[168:171], v248 offset:61440
    v_mfma_f32_16x16x32_bf16 v[20:23], v[192:195], v[72:75], v[20:23]
    ds_read_b128 v[172:175], v248 offset:62464
    v_mfma_f32_16x16x32_bf16 v[24:27], v[196:199], v[72:75], v[24:27]
    ds_read_b128 v[176:179], v248 offset:63488
    v_mfma_f32_16x16x32_bf16 v[28:31], v[200:203], v[72:75], v[28:31]
    ds_read_b128 v[180:183], v248 offset:64512
    v_mfma_f32_16x16x32_bf16 v[32:35], v[204:207], v[72:75], v[32:35]
    ds_read_b128 v[184:187], v249 offset:0
    v_mfma_f32_16x16x32_bf16 v[36:39], v[208:211], v[72:75], v[36:39]
    ds_read_b128 v[188:191], v251 offset:1536
    s_waitcnt vmcnt(10) lgkmcnt(15)
    v_mfma_f32_16x16x32_bf16 v[244:247], v[236:239], v[76:79], v[244:247]
    ds_read_b128 v[192:195], v249 offset:1024
    v_mfma_f32_16x16x32_bf16 v[20:23], v[216:219], v[76:79], v[20:23]
    ds_read_b128 v[196:199], v249 offset:2048
    v_mfma_f32_16x16x32_bf16 v[24:27], v[220:223], v[76:79], v[24:27]
    ds_read_b128 v[200:203], v249 offset:3072
    v_mfma_f32_16x16x32_bf16 v[28:31], v[224:227], v[76:79], v[28:31]
    ds_read_b128 v[204:207], v249 offset:4096
    v_mfma_f32_16x16x32_bf16 v[32:35], v[228:231], v[76:79], v[32:35]
    ds_read_b128 v[208:211], v249 offset:5120
    v_mfma_f32_16x16x32_bf16 v[36:39], v[232:235], v[76:79], v[36:39]
    ds_read_b128 v[212:215], v251 offset:1664
    s_waitcnt vmcnt(9) lgkmcnt(15)
    s_barrier
    v_mfma_f32_16x16x32_bf16 v[244:247], v[140:143], v[80:83], v[244:247]
    ds_read_b128 v[216:219], v249 offset:6144
    v_mfma_f32_16x16x32_bf16 v[20:23], v[120:123], v[80:83], v[20:23]
    ds_read_b128 v[220:223], v249 offset:7168
    v_mfma_f32_16x16x32_bf16 v[24:27], v[124:127], v[80:83], v[24:27]
    ds_read_b128 v[224:227], v249 offset:8192
    v_mfma_f32_16x16x32_bf16 v[28:31], v[128:131], v[80:83], v[28:31]
    ds_read_b128 v[228:231], v249 offset:9216
    v_mfma_f32_16x16x32_bf16 v[32:35], v[132:135], v[80:83], v[32:35]
    ds_read_b128 v[232:235], v249 offset:10240
    v_mfma_f32_16x16x32_bf16 v[36:39], v[136:139], v[80:83], v[36:39]
    ds_read_b128 v[236:239], v251 offset:1792
    s_waitcnt vmcnt(8) lgkmcnt(15)
    v_mfma_f32_16x16x32_bf16 v[244:247], v[164:167], v[84:87], v[244:247]
    ds_read_b128 v[120:123], v249 offset:11264
    v_mfma_f32_16x16x32_bf16 v[20:23], v[144:147], v[84:87], v[20:23]
    ds_read_b128 v[124:127], v249 offset:12288
    v_mfma_f32_16x16x32_bf16 v[24:27], v[148:151], v[84:87], v[24:27]
    ds_read_b128 v[128:131], v249 offset:13312
    v_mfma_f32_16x16x32_bf16 v[28:31], v[152:155], v[84:87], v[28:31]
    ds_read_b128 v[132:135], v249 offset:14336
    v_mfma_f32_16x16x32_bf16 v[32:35], v[156:159], v[84:87], v[32:35]
    ds_read_b128 v[136:139], v249 offset:15360
    v_mfma_f32_16x16x32_bf16 v[36:39], v[160:163], v[84:87], v[36:39]
    ds_read_b128 v[140:143], v251 offset:1920
    s_waitcnt vmcnt(7) lgkmcnt(15)
    v_mfma_f32_16x16x32_bf16 v[244:247], v[188:191], v[88:91], v[244:247]
    ds_read_b128 v[144:147], v249 offset:16384
    v_mfma_f32_16x16x32_bf16 v[20:23], v[168:171], v[88:91], v[20:23]
    ds_read_b128 v[148:151], v249 offset:17408
    v_mfma_f32_16x16x32_bf16 v[24:27], v[172:175], v[88:91], v[24:27]
    ds_read_b128 v[152:155], v249 offset:18432
    v_mfma_f32_16x16x32_bf16 v[28:31], v[176:179], v[88:91], v[28:31]
    ds_read_b128 v[156:159], v249 offset:19456
    v_mfma_f32_16x16x32_bf16 v[32:35], v[180:183], v[88:91], v[32:35]
    ds_read_b128 v[160:163], v249 offset:20480
    v_mfma_f32_16x16x32_bf16 v[36:39], v[184:187], v[88:91], v[36:39]
    ds_read_b128 v[164:167], v251 offset:2048
    s_waitcnt vmcnt(6) lgkmcnt(15)
    v_mfma_f32_16x16x32_bf16 v[244:247], v[212:215], v[92:95], v[244:247]
    ds_read_b128 v[168:171], v249 offset:21504
    v_mfma_f32_16x16x32_bf16 v[20:23], v[192:195], v[92:95], v[20:23]
    ds_read_b128 v[172:175], v249 offset:22528
    v_mfma_f32_16x16x32_bf16 v[24:27], v[196:199], v[92:95], v[24:27]
    ds_read_b128 v[176:179], v249 offset:23552
    v_mfma_f32_16x16x32_bf16 v[28:31], v[200:203], v[92:95], v[28:31]
    ds_read_b128 v[180:183], v249 offset:24576
    v_mfma_f32_16x16x32_bf16 v[32:35], v[204:207], v[92:95], v[32:35]
    ds_read_b128 v[184:187], v249 offset:25600
    v_mfma_f32_16x16x32_bf16 v[36:39], v[208:211], v[92:95], v[36:39]
    ds_read_b128 v[188:191], v251 offset:2176
    s_waitcnt vmcnt(5) lgkmcnt(15)
    v_mfma_f32_16x16x32_bf16 v[244:247], v[236:239], v[96:99], v[244:247]
    ds_read_b128 v[192:195], v249 offset:26624
    v_mfma_f32_16x16x32_bf16 v[20:23], v[216:219], v[96:99], v[20:23]
    ds_read_b128 v[196:199], v249 offset:27648
    v_mfma_f32_16x16x32_bf16 v[24:27], v[220:223], v[96:99], v[24:27]
    ds_read_b128 v[200:203], v249 offset:28672
    v_mfma_f32_16x16x32_bf16 v[28:31], v[224:227], v[96:99], v[28:31]
    ds_read_b128 v[204:207], v249 offset:29696
    v_mfma_f32_16x16x32_bf16 v[32:35], v[228:231], v[96:99], v[32:35]
    ds_read_b128 v[208:211], v249 offset:30720
    v_mfma_f32_16x16x32_bf16 v[36:39], v[232:235], v[96:99], v[36:39]
    ds_read_b128 v[212:215], v251 offset:2304
    s_waitcnt vmcnt(4) lgkmcnt(15)
    v_mfma_f32_16x16x32_bf16 v[244:247], v[140:143], v[100:103], v[244:247]
    ds_read_b128 v[216:219], v249 offset:31744
    v_mfma_f32_16x16x32_bf16 v[20:23], v[120:123], v[100:103], v[20:23]
    ds_read_b128 v[220:223], v249 offset:32768
    v_mfma_f32_16x16x32_bf16 v[24:27], v[124:127], v[100:103], v[24:27]
    ds_read_b128 v[224:227], v249 offset:33792
    v_mfma_f32_16x16x32_bf16 v[28:31], v[128:131], v[100:103], v[28:31]
    ds_read_b128 v[228:231], v249 offset:34816
    v_mfma_f32_16x16x32_bf16 v[32:35], v[132:135], v[100:103], v[32:35]
    ds_read_b128 v[232:235], v249 offset:35840
    v_mfma_f32_16x16x32_bf16 v[36:39], v[136:139], v[100:103], v[36:39]
    ds_read_b128 v[236:239], v251 offset:2432
    s_waitcnt vmcnt(3) lgkmcnt(15)
    v_mfma_f32_16x16x32_bf16 v[244:247], v[164:167], v[104:107], v[244:247]
    v_mfma_f32_16x16x32_bf16 v[20:23], v[144:147], v[104:107], v[20:23]
    v_mfma_f32_16x16x32_bf16 v[24:27], v[148:151], v[104:107], v[24:27]
    v_mfma_f32_16x16x32_bf16 v[28:31], v[152:155], v[104:107], v[28:31]
    v_mfma_f32_16x16x32_bf16 v[32:35], v[156:159], v[104:107], v[32:35]
    v_mfma_f32_16x16x32_bf16 v[36:39], v[160:163], v[104:107], v[36:39]
    s_waitcnt vmcnt(2) lgkmcnt(12)
    v_mfma_f32_16x16x32_bf16 v[244:247], v[188:191], v[108:111], v[244:247]
    v_mfma_f32_16x16x32_bf16 v[20:23], v[168:171], v[108:111], v[20:23]
    v_mfma_f32_16x16x32_bf16 v[24:27], v[172:175], v[108:111], v[24:27]
    v_mfma_f32_16x16x32_bf16 v[28:31], v[176:179], v[108:111], v[28:31]
    v_mfma_f32_16x16x32_bf16 v[32:35], v[180:183], v[108:111], v[32:35]
    v_mfma_f32_16x16x32_bf16 v[36:39], v[184:187], v[108:111], v[36:39]
    s_waitcnt vmcnt(1) lgkmcnt(6)
    v_mfma_f32_16x16x32_bf16 v[244:247], v[212:215], v[112:115], v[244:247]
    v_mfma_f32_16x16x32_bf16 v[20:23], v[192:195], v[112:115], v[20:23]
    v_mfma_f32_16x16x32_bf16 v[24:27], v[196:199], v[112:115], v[24:27]
    v_mfma_f32_16x16x32_bf16 v[28:31], v[200:203], v[112:115], v[28:31]
    v_mfma_f32_16x16x32_bf16 v[32:35], v[204:207], v[112:115], v[32:35]
    v_mfma_f32_16x16x32_bf16 v[36:39], v[208:211], v[112:115], v[36:39]
    s_waitcnt vmcnt(0) lgkmcnt(0)
    v_mfma_f32_16x16x32_bf16 v[244:247], v[236:239], v[116:119], v[244:247]
    v_mfma_f32_16x16x32_bf16 v[20:23], v[216:219], v[116:119], v[20:23]
    v_mfma_f32_16x16x32_bf16 v[24:27], v[220:223], v[116:119], v[24:27]
    v_mfma_f32_16x16x32_bf16 v[28:31], v[224:227], v[116:119], v[28:31]
    v_mfma_f32_16x16x32_bf16 v[32:35], v[228:231], v[116:119], v[32:35]
    v_mfma_f32_16x16x32_bf16 v[36:39], v[232:235], v[116:119], v[36:39]
    v_add_f32 v244, v244, v245
    v_sub_f32 v40, v20, v244
    v_sub_f32 v41, v21, v244
    v_sub_f32 v42, v22, v244
    v_sub_f32 v43, v23, v244
    v_cvt_pk_bf16_f32 v64, v40, v41
    v_sub_f32 v44, v24, v244
    v_sub_f32 v45, v25, v244
    v_cvt_pk_bf16_f32 v65, v42, v43
    v_sub_f32 v46, v26, v244
    v_sub_f32 v47, v27, v244
    v_cvt_pk_bf16_f32 v66, v44, v45
    v_sub_f32 v48, v28, v244
    v_sub_f32 v49, v29, v244
    v_cvt_pk_bf16_f32 v67, v46, v47
    v_sub_f32 v50, v30, v244
    v_sub_f32 v51, v31, v244
    v_cvt_pk_bf16_f32 v68, v48, v49
    v_sub_f32 v52, v32, v244
    v_sub_f32 v53, v33, v244
    v_cvt_pk_bf16_f32 v69, v50, v51
    v_sub_f32 v54, v34, v244
    v_sub_f32 v55, v35, v244
    v_cvt_pk_bf16_f32 v70, v52, v53
    v_sub_f32 v56, v36, v244
    v_sub_f32 v57, v37, v244
    v_cvt_pk_bf16_f32 v71, v54, v55
    v_sub_f32 v58, v38, v244
    v_sub_f32 v59, v39, v244
    v_cvt_pk_bf16_f32 v72, v56, v57
    v_cvt_pk_bf16_f32 v73, v58, v59
    s_cmp_lg_u32 s86, 0
    s_cbranch_scc1 sequentia_s32
    buffer_store_dwordx4 v[64:67], v5, s[16:19], s34 offen
    buffer_store_dwordx4 v[68:71], v5, s[16:19], s34 offen offset:2048
    buffer_store_dwordx2 v[72:73], v9, s[16:19], s36 offen
sequentia_b33:
    v_cvt_pk_bf16_f32 v10, v20, v21
    v_cvt_pk_bf16_f32 v11, v22, v23
    v_cvt_pk_bf16_f32 v12, v24, v25
    v_cvt_pk_bf16_f32 v13, v26, v27
    v_cvt_pk_bf16_f32 v14, v28, v29
    v_cvt_pk_bf16_f32 v15, v30, v31
    v_cvt_pk_bf16_f32 v16, v32, v33
    v_cvt_pk_bf16_f32 v17, v34, v35
    v_cvt_pk_bf16_f32 v18, v36, v37
    v_cvt_pk_bf16_f32 v19, v38, v39
    v_add_f32 v240, v40, v41
    v_mul_f32 v241, v40, v40
    v_add_f32 v242, v42, v43
    v_mul_f32 v243, v41, v41
    v_fmac_f32 v241, v42, v42
    v_fmac_f32 v243, v43, v43
    v_add_f32 v240, v240, v44
    v_fmac_f32 v241, v44, v44
    v_add_f32 v242, v242, v45
    v_fmac_f32 v243, v45, v45
    v_add_f32 v240, v240, v46
    v_fmac_f32 v241, v46, v46
    v_add_f32 v242, v242, v47
    v_fmac_f32 v243, v47, v47
    v_add_f32 v240, v240, v48
    v_fmac_f32 v241, v48, v48
    v_add_f32 v242, v242, v49
    v_fmac_f32 v243, v49, v49
    v_add_f32 v240, v240, v50
    v_fmac_f32 v241, v50, v50
    v_add_f32 v242, v242, v51
    v_fmac_f32 v243, v51, v51
    v_add_f32 v240, v240, v52
    v_fmac_f32 v241, v52, v52
    v_add_f32 v242, v242, v53
    v_fmac_f32 v243, v53, v53
    v_add_f32 v240, v240, v54
    v_fmac_f32 v241, v54, v54
    v_add_f32 v242, v242, v55
    v_fmac_f32 v243, v55, v55
    v_add_f32 v240, v240, v56
    v_fmac_f32 v241, v56, v56
    v_add_f32 v242, v242, v57
    v_fmac_f32 v243, v57, v57
    v_add_f32 v240, v240, v58
    v_fmac_f32 v241, v58, v58
    v_add_f32 v242, v242, v59
    v_fmac_f32 v243, v59, v59
    v_add_f32 v240, v240, v242
    v_add_f32 v241, v241, v243
    s_nop 1
    v_permlane32_swap_b32 v240, v241
    v_add_f32 v240, v240, v241
    v_mov_b32 v241, v240
    s_nop 1
    v_permlane16_swap_b32 v240, v241
    v_add_f32 v240, v240, v241
    v_mov_b32 v241, v240
    s_nop 1
    v_permlane32_swap_b32 v240, v241
    v_mov_b32 v242, v252
    v_mov_b32 v243, v253
    ds_read_b128 v[80:83], v249 offset:36864
    ds_read_b128 v[84:87], v249 offset:37888
    ds_read_b128 v[88:91], v249 offset:38912
    ds_read_b128 v[92:95], v249 offset:39936
    ds_read_b128 v[96:99], v249 offset:40960
    ds_read_b128 v[100:103], v249 offset:41984
    ds_read_b128 v[104:107], v249 offset:43008
    s_lshr_b32 s32, s4, 4
    s_lshl_b32 s32, s32, 2
    s_add_u32 s32, s32, s3
    s_mul_i32 s31, s32, 40960
    s_add_u32 s31, s31, s25
    s_lshl_b32 s33, s32, 12
    s_add_u32 s33, s33, s25
    s_add_u32 s33, s33, 327680
    v_and_b32 v3, 31, v1
    v_lshrrev_b32 v4, 5, v1
    v_lshlrev_b32 v5, 4, v3
    v_lshl_add_u32 v5, v4, 11, v5
    s_waitcnt vmcnt(0)
    s_cmp_lg_u32 s86, 0
    s_cbranch_scc1 sequentia_s34
    s_mov_b64 exec, 0xffff
    buffer_store_dwordx4 v[240:243], v6, s[16:19], s37 offen
    s_mov_b64 exec, -1
sequentia_b35:
    s_barrier
    v_lshrrev_b32 v6, 4, v3
    v_mul_u32_u24 v6, 55296, v6
    v_and_b32 v9, 15, v3
    v_lshl_add_u32 v6, v9, 4, v6
    v_lshl_add_u32 v6, v4, 8, v6
    s_and_b32 s34, s4, 15
    s_mul_i32 s35, s32, 110592
    s_mul_i32 s36, s34, 3584
    s_add_u32 s35, s35, s36
    s_add_u32 s35, s35, s25
    s_add_u32 s35, s35, 393216
    s_cmp_eq_u32 s34, 15
    s_cselect_b32 s36, 2146435072, s35
    s_lshl_b32 s37, s32, 4
    s_add_u32 s37, s37, s34
    s_lshl_b32 s37, s37, 3
    s_add_u32 s37, s37, s25
    s_add_u32 s37, s37, 362496
    v_lshrrev_b32 v23, 4, v1
    v_lshlrev_b32 v23, 9, v23
    v_lshl_add_u32 v23, v9, 4, v23
    v_mov_b32 v9, 0
    v_mov_b32 v22, 0xffff0000
    s_max_i32 s87, s87, 100
sequentia_p36:
    buffer_load_dwordx4 v[64:67], v5, s[16:19], s33 offen offset:0 sc1
    buffer_load_dwordx4 v[68:71], v5, s[16:19], s33 offen offset:512 sc1
    buffer_load_dwordx4 v[72:75], v5, s[16:19], s33 offen offset:1024 sc1
    buffer_load_dwordx4 v[76:79], v5, s[16:19], s33 offen offset:1536 sc1
sequentia_t38:
    s_waitcnt vmcnt(0)
    v_cmp_ne_u64 vcc, s[84:85], v[66:67]
    v_cmp_ne_u64 s[88:89], s[84:85], v[70:71]
    s_nop 1
    s_or_b64 vcc, vcc, s[88:89]
    v_cmp_ne_u64 s[88:89], s[84:85], v[74:75]
    s_nop 1
    s_or_b64 vcc, vcc, s[88:89]
    v_cmp_ne_u64 s[88:89], s[84:85], v[78:79]
    s_nop 1
    s_or_b64 vcc, vcc, s[88:89]
    s_sub_u32 s87, s87, 1
    s_cbranch_scc1 sequentia_d37
    s_cbranch_vccnz sequentia_p36
sequentia_d37:
    buffer_load_dwordx4 v[32:35], v23, s[16:19], s31 offen offset:0 sc1
    buffer_load_dwordx4 v[36:39], v23, s[16:19], s31 offen offset:256 sc1
    buffer_load_dwordx4 v[40:43], v23, s[16:19], s31 offen offset:2048 sc1
    buffer_load_dwordx4 v[44:47], v23, s[16:19], s31 offen offset:2304 sc1
    s_add_u32 s31, s31, 4096
    buffer_load_dwordx4 v[48:51], v23, s[16:19], s31 offen offset:0 sc1
    buffer_load_dwordx4 v[52:55], v23, s[16:19], s31 offen offset:256 sc1
    s_barrier
    s_waitcnt vmcnt(5)
    s_nop 0
    s_waitcnt lgkmcnt(0)
    v_mfma_f32_16x16x32_bf16 v[136:139], v[80:83], v[32:35], 0
    ds_read_b128 v[108:111], v249 offset:44032
    v_add_f32 v64, v64, v68
    s_waitcnt vmcnt(4)
    v_mfma_f32_16x16x32_bf16 v[140:143], v[80:83], v[36:39], 0
    ds_read_b128 v[112:115], v249 offset:45056
    v_add_f32 v65, v65, v69
    v_mfma_f32_16x16x32_bf16 v[152:155], v[84:87], v[32:35], 0
    ds_read_b128 v[116:119], v249 offset:46080
    v_add_f32 v72, v72, v76
    v_mfma_f32_16x16x32_bf16 v[156:159], v[84:87], v[36:39], 0
    ds_read_b128 v[120:123], v249 offset:47104
    v_add_f32 v73, v73, v77
    v_mfma_f32_16x16x32_bf16 v[168:171], v[88:91], v[32:35], 0
    ds_read_b128 v[124:127], v249 offset:48128
    v_add_f32 v64, v64, v72
    v_mfma_f32_16x16x32_bf16 v[172:175], v[88:91], v[36:39], 0
    ds_read_b128 v[128:131], v249 offset:49152
    v_add_f32 v65, v65, v73
    v_mfma_f32_16x16x32_bf16 v[184:187], v[92:95], v[32:35], 0
    ds_read_b128 v[132:135], v249 offset:50176
    v_mov_b32 v66, v64
    v_mfma_f32_16x16x32_bf16 v[188:191], v[92:95], v[36:39], 0
    v_mov_b32 v67, v65
    v_permlane32_swap_b32 v64, v66
    v_mfma_f32_16x16x32_bf16 v[200:203], v[96:99], v[32:35], 0
    v_permlane32_swap_b32 v65, v67
    v_add_f32 v64, v64, v66
    v_mfma_f32_16x16x32_bf16 v[204:207], v[96:99], v[36:39], 0
    v_add_f32 v65, v65, v67
    v_mul_f32 v64, 0xbacccccd, v64
    v_mfma_f32_16x16x32_bf16 v[216:219], v[100:103], v[32:35], 0
    v_mul_f32 v65, 0x3acccccd, v65
    v_fma_f32 v65, -v64, v64, v65
    v_mfma_f32_16x16x32_bf16 v[220:223], v[100:103], v[36:39], 0
    v_max_f32 v65, 0, v65
    v_cvt_pk_bf16_f32 v65, v65, v65
    v_mfma_f32_16x16x32_bf16 v[232:235], v[104:107], v[32:35], 0
    v_lshlrev_b32 v65, 16, v65
    v_add_f32 v65, 0x3727c5ac, v65
    v_mfma_f32_16x16x32_bf16 v[236:239], v[104:107], v[36:39], 0
    v_cvt_pk_bf16_f32 v65, v65, v65
    v_lshlrev_b32 v65, 16, v65
    buffer_load_dwordx4 v[56:59], v23, s[16:19], s31 offen offset:2048 sc1
    buffer_load_dwordx4 v[60:63], v23, s[16:19], s31 offen offset:2304 sc1
    s_add_u32 s31, s31, 4096
    s_waitcnt lgkmcnt(0)
    v_mfma_f32_16x16x32_bf16 v[144:147], v[108:111], v[32:35], 0
    ds_read_b128 v[80:83], v249 offset:51200
    v_sqrt_f32 v65, v65
    v_mfma_f32_16x16x32_bf16 v[148:151], v[108:111], v[36:39], 0
    ds_read_b128 v[84:87], v249 offset:52224
    v_cvt_pk_bf16_f32 v65, v65, v65
    v_mfma_f32_16x16x32_bf16 v[160:163], v[112:115], v[32:35], 0
    ds_read_b128 v[88:91], v249 offset:53248
    v_lshlrev_b32 v65, 16, v65
    v_mfma_f32_16x16x32_bf16 v[164:167], v[112:115], v[36:39], 0
    ds_read_b128 v[92:95], v249 offset:54272
    v_rcp_f32 v20, v65
    v_mfma_f32_16x16x32_bf16 v[176:179], v[116:119], v[32:35], 0
    ds_read_b128 v[96:99], v249 offset:55296
    v_mul_f32 v21, v20, v20
    v_mfma_f32_16x16x32_bf16 v[180:183], v[116:119], v[36:39], 0
    ds_read_b128 v[100:103], v249 offset:56320
    v_mov_b32 v22, v21
    v_mfma_f32_16x16x32_bf16 v[192:195], v[120:123], v[32:35], 0
    ds_read_b128 v[104:107], v249 offset:57344
    v_permlane16_swap_b32 v21, v22
    v_mfma_f32_16x16x32_bf16 v[196:199], v[120:123], v[36:39], 0
    v_mfma_f32_16x16x32_bf16 v[208:211], v[124:127], v[32:35], 0
    v_mfma_f32_16x16x32_bf16 v[212:215], v[124:127], v[36:39], 0
    v_mfma_f32_16x16x32_bf16 v[224:227], v[128:131], v[32:35], 0
    v_mfma_f32_16x16x32_bf16 v[228:231], v[128:131], v[36:39], 0
    v_mfma_f32_16x16x32_bf16 v[240:243], v[132:135], v[32:35], 0
    v_mfma_f32_16x16x32_bf16 v[244:247], v[132:135], v[36:39], 0
    buffer_load_dwordx4 v[64:67], v23, s[16:19], s31 offen offset:0 sc1
    buffer_load_dwordx4 v[68:71], v23, s[16:19], s31 offen offset:256 sc1
    s_waitcnt lgkmcnt(0)
    s_waitcnt vmcnt(7)
    v_mfma_f32_16x16x32_bf16 v[136:139], v[80:83], v[40:43], v[136:139]
    ds_read_b128 v[108:111], v249 offset:58368
    s_waitcnt vmcnt(6)
    v_mfma_f32_16x16x32_bf16 v[140:143], v[80:83], v[44:47], v[140:143]
    ds_read_b128 v[112:115], v249 offset:59392
    v_mfma_f32_16x16x32_bf16 v[152:155], v[84:87], v[40:43], v[152:155]
    ds_read_b128 v[116:119], v249 offset:60416
    v_mfma_f32_16x16x32_bf16 v[156:159], v[84:87], v[44:47], v[156:159]
    ds_read_b128 v[120:123], v249 offset:61440
    v_mfma_f32_16x16x32_bf16 v[168:171], v[88:91], v[40:43], v[168:171]
    ds_read_b128 v[124:127], v249 offset:62464
    v_mfma_f32_16x16x32_bf16 v[172:175], v[88:91], v[44:47], v[172:175]
    ds_read_b128 v[128:131], v249 offset:63488
    v_mfma_f32_16x16x32_bf16 v[184:187], v[92:95], v[40:43], v[184:187]
    ds_read_b128 v[132:135], v249 offset:64512
    v_mfma_f32_16x16x32_bf16 v[188:191], v[92:95], v[44:47], v[188:191]
    v_mfma_f32_16x16x32_bf16 v[200:203], v[96:99], v[40:43], v[200:203]
    v_mfma_f32_16x16x32_bf16 v[204:207], v[96:99], v[44:47], v[204:207]
    v_mfma_f32_16x16x32_bf16 v[216:219], v[100:103], v[40:43], v[216:219]
    v_mfma_f32_16x16x32_bf16 v[220:223], v[100:103], v[44:47], v[220:223]
    v_mfma_f32_16x16x32_bf16 v[232:235], v[104:107], v[40:43], v[232:235]
    v_mfma_f32_16x16x32_bf16 v[236:239], v[104:107], v[44:47], v[236:239]
    buffer_load_dwordx4 v[72:75], v23, s[16:19], s31 offen offset:2048 sc1
    buffer_load_dwordx4 v[76:79], v23, s[16:19], s31 offen offset:2304 sc1
    s_add_u32 s31, s31, 4096
    s_waitcnt lgkmcnt(0)
    v_mfma_f32_16x16x32_bf16 v[144:147], v[108:111], v[40:43], v[144:147]
    ds_read_b128 v[80:83], v250 offset:0
    v_mfma_f32_16x16x32_bf16 v[148:151], v[108:111], v[44:47], v[148:151]
    ds_read_b128 v[84:87], v250 offset:1024
    v_mfma_f32_16x16x32_bf16 v[160:163], v[112:115], v[40:43], v[160:163]
    ds_read_b128 v[88:91], v250 offset:2048
    v_mfma_f32_16x16x32_bf16 v[164:167], v[112:115], v[44:47], v[164:167]
    ds_read_b128 v[92:95], v250 offset:3072
    v_mfma_f32_16x16x32_bf16 v[176:179], v[116:119], v[40:43], v[176:179]
    ds_read_b128 v[96:99], v250 offset:4096
    v_mfma_f32_16x16x32_bf16 v[180:183], v[116:119], v[44:47], v[180:183]
    ds_read_b128 v[100:103], v250 offset:5120
    v_mfma_f32_16x16x32_bf16 v[192:195], v[120:123], v[40:43], v[192:195]
    ds_read_b128 v[104:107], v250 offset:6144
    v_mfma_f32_16x16x32_bf16 v[196:199], v[120:123], v[44:47], v[196:199]
    v_mfma_f32_16x16x32_bf16 v[208:211], v[124:127], v[40:43], v[208:211]
    v_mfma_f32_16x16x32_bf16 v[212:215], v[124:127], v[44:47], v[212:215]
    v_mfma_f32_16x16x32_bf16 v[224:227], v[128:131], v[40:43], v[224:227]
    v_mfma_f32_16x16x32_bf16 v[228:231], v[128:131], v[44:47], v[228:231]
    v_mfma_f32_16x16x32_bf16 v[240:243], v[132:135], v[40:43], v[240:243]
    v_mfma_f32_16x16x32_bf16 v[244:247], v[132:135], v[44:47], v[244:247]
    s_waitcnt lgkmcnt(0)
    s_waitcnt vmcnt(7)
    v_mfma_f32_16x16x32_bf16 v[136:139], v[80:83], v[48:51], v[136:139]
    ds_read_b128 v[108:111], v250 offset:7168
    s_waitcnt vmcnt(6)
    v_mfma_f32_16x16x32_bf16 v[140:143], v[80:83], v[52:55], v[140:143]
    ds_read_b128 v[112:115], v250 offset:8192
    v_mfma_f32_16x16x32_bf16 v[152:155], v[84:87], v[48:51], v[152:155]
    ds_read_b128 v[116:119], v250 offset:9216
    v_mfma_f32_16x16x32_bf16 v[156:159], v[84:87], v[52:55], v[156:159]
    ds_read_b128 v[120:123], v250 offset:10240
    v_mfma_f32_16x16x32_bf16 v[168:171], v[88:91], v[48:51], v[168:171]
    ds_read_b128 v[124:127], v250 offset:11264
    v_mfma_f32_16x16x32_bf16 v[172:175], v[88:91], v[52:55], v[172:175]
    ds_read_b128 v[128:131], v250 offset:12288
    v_mfma_f32_16x16x32_bf16 v[184:187], v[92:95], v[48:51], v[184:187]
    ds_read_b128 v[132:135], v250 offset:13312
    v_mfma_f32_16x16x32_bf16 v[188:191], v[92:95], v[52:55], v[188:191]
    buffer_load_dwordx4 v[32:35], v23, s[16:19], s31 offen offset:0 sc1
    v_mfma_f32_16x16x32_bf16 v[200:203], v[96:99], v[48:51], v[200:203]
    v_mfma_f32_16x16x32_bf16 v[204:207], v[96:99], v[52:55], v[204:207]
    v_mfma_f32_16x16x32_bf16 v[216:219], v[100:103], v[48:51], v[216:219]
    buffer_load_dwordx4 v[36:39], v23, s[16:19], s31 offen offset:256 sc1
    v_mfma_f32_16x16x32_bf16 v[220:223], v[100:103], v[52:55], v[220:223]
    v_mfma_f32_16x16x32_bf16 v[232:235], v[104:107], v[48:51], v[232:235]
    v_mfma_f32_16x16x32_bf16 v[236:239], v[104:107], v[52:55], v[236:239]
    s_waitcnt lgkmcnt(0)
    v_mfma_f32_16x16x32_bf16 v[144:147], v[108:111], v[48:51], v[144:147]
    ds_read_b128 v[80:83], v250 offset:14336
    v_mfma_f32_16x16x32_bf16 v[148:151], v[108:111], v[52:55], v[148:151]
    ds_read_b128 v[84:87], v250 offset:15360
pg_2:
    s_cbranch_execz pg_ret
    v_mfma_f32_16x16x32_bf16 v[160:163], v[112:115], v[48:51], v[160:163]
    ds_read_b128 v[88:91], v250 offset:16384
    v_mfma_f32_16x16x32_bf16 v[164:167], v[112:115], v[52:55], v[164:167]
    ds_read_b128 v[92:95], v250 offset:17408
    v_mfma_f32_16x16x32_bf16 v[176:179], v[116:119], v[48:51], v[176:179]
    ds_read_b128 v[96:99], v250 offset:18432
    v_mfma_f32_16x16x32_bf16 v[180:183], v[116:119], v[52:55], v[180:183]
    ds_read_b128 v[100:103], v250 offset:19456
    v_mfma_f32_16x16x32_bf16 v[192:195], v[120:123], v[48:51], v[192:195]
    ds_read_b128 v[104:107], v250 offset:20480
    v_mfma_f32_16x16x32_bf16 v[196:199], v[120:123], v[52:55], v[196:199]
    buffer_load_dwordx4 v[40:43], v23, s[16:19], s31 offen offset:2048 sc1
    v_mfma_f32_16x16x32_bf16 v[208:211], v[124:127], v[48:51], v[208:211]
    v_mfma_f32_16x16x32_bf16 v[212:215], v[124:127], v[52:55], v[212:215]
    v_mfma_f32_16x16x32_bf16 v[224:227], v[128:131], v[48:51], v[224:227]
    buffer_load_dwordx4 v[44:47], v23, s[16:19], s31 offen offset:2304 sc1
    s_add_u32 s31, s31, 4096
    v_mfma_f32_16x16x32_bf16 v[228:231], v[128:131], v[52:55], v[228:231]
    v_mfma_f32_16x16x32_bf16 v[240:243], v[132:135], v[48:51], v[240:243]
    v_mfma_f32_16x16x32_bf16 v[244:247], v[132:135], v[52:55], v[244:247]
    s_waitcnt lgkmcnt(0)
    s_waitcnt vmcnt(9)
    v_mfma_f32_16x16x32_bf16 v[136:139], v[80:83], v[56:59], v[136:139]
    ds_read_b128 v[108:111], v250 offset:21504
    s_waitcnt vmcnt(8)
    v_mfma_f32_16x16x32_bf16 v[140:143], v[80:83], v[60:63], v[140:143]
    ds_read_b128 v[112:115], v250 offset:22528
    v_mfma_f32_16x16x32_bf16 v[152:155], v[84:87], v[56:59], v[152:155]
    ds_read_b128 v[116:119], v250 offset:23552
    v_mfma_f32_16x16x32_bf16 v[156:159], v[84:87], v[60:63], v[156:159]
    ds_read_b128 v[120:123], v250 offset:24576
    v_mfma_f32_16x16x32_bf16 v[168:171], v[88:91], v[56:59], v[168:171]
    ds_read_b128 v[124:127], v250 offset:25600
    v_mfma_f32_16x16x32_bf16 v[172:175], v[88:91], v[60:63], v[172:175]
    ds_read_b128 v[128:131], v250 offset:26624
    v_mfma_f32_16x16x32_bf16 v[184:187], v[92:95], v[56:59], v[184:187]
    ds_read_b128 v[132:135], v250 offset:27648
    v_mfma_f32_16x16x32_bf16 v[188:191], v[92:95], v[60:63], v[188:191]
    buffer_load_dwordx4 v[48:51], v23, s[16:19], s31 offen offset:0 sc1
    v_mfma_f32_16x16x32_bf16 v[200:203], v[96:99], v[56:59], v[200:203]
    v_mfma_f32_16x16x32_bf16 v[204:207], v[96:99], v[60:63], v[204:207]
    v_mfma_f32_16x16x32_bf16 v[216:219], v[100:103], v[56:59], v[216:219]
    buffer_load_dwordx4 v[52:55], v23, s[16:19], s31 offen offset:256 sc1
    v_mfma_f32_16x16x32_bf16 v[220:223], v[100:103], v[60:63], v[220:223]
    v_mfma_f32_16x16x32_bf16 v[232:235], v[104:107], v[56:59], v[232:235]
    v_mfma_f32_16x16x32_bf16 v[236:239], v[104:107], v[60:63], v[236:239]
    s_waitcnt lgkmcnt(0)
    s_barrier
    v_mfma_f32_16x16x32_bf16 v[144:147], v[108:111], v[56:59], v[144:147]
    ds_read_b128 v[80:83], v248 offset:0
    v_mfma_f32_16x16x32_bf16 v[148:151], v[108:111], v[60:63], v[148:151]
    ds_read_b128 v[84:87], v248 offset:1024
    v_mfma_f32_16x16x32_bf16 v[160:163], v[112:115], v[56:59], v[160:163]
    ds_read_b128 v[88:91], v248 offset:2048
    v_mfma_f32_16x16x32_bf16 v[164:167], v[112:115], v[60:63], v[164:167]
    ds_read_b128 v[92:95], v248 offset:3072
    v_mfma_f32_16x16x32_bf16 v[176:179], v[116:119], v[56:59], v[176:179]
    ds_read_b128 v[96:99], v248 offset:4096
    v_mfma_f32_16x16x32_bf16 v[180:183], v[116:119], v[60:63], v[180:183]
    ds_read_b128 v[100:103], v248 offset:5120
    v_mfma_f32_16x16x32_bf16 v[192:195], v[120:123], v[56:59], v[192:195]
    ds_read_b128 v[104:107], v248 offset:6144
    v_mfma_f32_16x16x32_bf16 v[196:199], v[120:123], v[60:63], v[196:199]
    v_mfma_f32_16x16x32_bf16 v[208:211], v[124:127], v[56:59], v[208:211]
    v_mfma_f32_16x16x32_bf16 v[212:215], v[124:127], v[60:63], v[212:215]
    v_mfma_f32_16x16x32_bf16 v[224:227], v[128:131], v[56:59], v[224:227]
    v_mfma_f32_16x16x32_bf16 v[228:231], v[128:131], v[60:63], v[228:231]
    v_mfma_f32_16x16x32_bf16 v[240:243], v[132:135], v[56:59], v[240:243]
    v_mfma_f32_16x16x32_bf16 v[244:247], v[132:135], v[60:63], v[244:247]
    s_waitcnt lgkmcnt(0)
    s_waitcnt vmcnt(9)
    v_mfma_f32_16x16x32_bf16 v[136:139], v[80:83], v[64:67], v[136:139]
    ds_read_b128 v[108:111], v248 offset:7168
    s_waitcnt vmcnt(8)
    v_mfma_f32_16x16x32_bf16 v[140:143], v[80:83], v[68:71], v[140:143]
    ds_read_b128 v[112:115], v248 offset:8192
    v_mfma_f32_16x16x32_bf16 v[152:155], v[84:87], v[64:67], v[152:155]
    ds_read_b128 v[116:119], v248 offset:9216
    v_mfma_f32_16x16x32_bf16 v[156:159], v[84:87], v[68:71], v[156:159]
    ds_read_b128 v[120:123], v248 offset:10240
    v_mfma_f32_16x16x32_bf16 v[168:171], v[88:91], v[64:67], v[168:171]
    ds_read_b128 v[124:127], v248 offset:11264
    v_mfma_f32_16x16x32_bf16 v[172:175], v[88:91], v[68:71], v[172:175]
    ds_read_b128 v[128:131], v248 offset:12288
    v_mfma_f32_16x16x32_bf16 v[184:187], v[92:95], v[64:67], v[184:187]
    ds_read_b128 v[132:135], v248 offset:13312
    v_mfma_f32_16x16x32_bf16 v[188:191], v[92:95], v[68:71], v[188:191]
    buffer_load_dwordx4 v[56:59], v23, s[16:19], s31 offen offset:2048 sc1
    v_mfma_f32_16x16x32_bf16 v[200:203], v[96:99], v[64:67], v[200:203]
    v_mfma_f32_16x16x32_bf16 v[204:207], v[96:99], v[68:71], v[204:207]
    v_mfma_f32_16x16x32_bf16 v[216:219], v[100:103], v[64:67], v[216:219]
    buffer_load_dwordx4 v[60:63], v23, s[16:19], s31 offen offset:2304 sc1
    s_add_u32 s31, s31, 4096
    v_mfma_f32_16x16x32_bf16 v[220:223], v[100:103], v[68:71], v[220:223]
    v_mfma_f32_16x16x32_bf16 v[232:235], v[104:107], v[64:67], v[232:235]
    v_mfma_f32_16x16x32_bf16 v[236:239], v[104:107], v[68:71], v[236:239]
    s_waitcnt lgkmcnt(0)
    v_mfma_f32_16x16x32_bf16 v[144:147], v[108:111], v[64:67], v[144:147]
    ds_read_b128 v[80:83], v248 offset:14336
    v_mfma_f32_16x16x32_bf16 v[148:151], v[108:111], v[68:71], v[148:151]
    ds_read_b128 v[84:87], v248 offset:15360
    v_mfma_f32_16x16x32_bf16 v[160:163], v[112:115], v[64:67], v[160:163]
    ds_read_b128 v[88:91], v248 offset:16384
    v_mfma_f32_16x16x32_bf16 v[164:167], v[112:115], v[68:71], v[164:167]
    ds_read_b128 v[92:95], v248 offset:17408
    v_mfma_f32_16x16x32_bf16 v[176:179], v[116:119], v[64:67], v[176:179]
    ds_read_b128 v[96:99], v248 offset:18432
    v_mfma_f32_16x16x32_bf16 v[180:183], v[116:119], v[68:71], v[180:183]
    ds_read_b128 v[100:103], v248 offset:19456
    v_mfma_f32_16x16x32_bf16 v[192:195], v[120:123], v[64:67], v[192:195]
    ds_read_b128 v[104:107], v248 offset:20480
    v_mfma_f32_16x16x32_bf16 v[196:199], v[120:123], v[68:71], v[196:199]
    v_mfma_f32_16x16x32_bf16 v[208:211], v[124:127], v[64:67], v[208:211]
    v_mfma_f32_16x16x32_bf16 v[212:215], v[124:127], v[68:71], v[212:215]
    v_mfma_f32_16x16x32_bf16 v[224:227], v[128:131], v[64:67], v[224:227]
    v_mfma_f32_16x16x32_bf16 v[228:231], v[128:131], v[68:71], v[228:231]
    v_mfma_f32_16x16x32_bf16 v[240:243], v[132:135], v[64:67], v[240:243]
    v_mfma_f32_16x16x32_bf16 v[244:247], v[132:135], v[68:71], v[244:247]
    s_waitcnt lgkmcnt(0)
    s_waitcnt vmcnt(9)
    v_mfma_f32_16x16x32_bf16 v[136:139], v[80:83], v[72:75], v[136:139]
    ds_read_b128 v[108:111], v248 offset:21504
    s_waitcnt vmcnt(8)
    v_mfma_f32_16x16x32_bf16 v[140:143], v[80:83], v[76:79], v[140:143]
    ds_read_b128 v[112:115], v248 offset:22528
    v_mfma_f32_16x16x32_bf16 v[152:155], v[84:87], v[72:75], v[152:155]
    ds_read_b128 v[116:119], v248 offset:23552
    v_mfma_f32_16x16x32_bf16 v[156:159], v[84:87], v[76:79], v[156:159]
    ds_read_b128 v[120:123], v248 offset:24576
    v_mfma_f32_16x16x32_bf16 v[168:171], v[88:91], v[72:75], v[168:171]
    ds_read_b128 v[124:127], v248 offset:25600
    v_mfma_f32_16x16x32_bf16 v[172:175], v[88:91], v[76:79], v[172:175]
    ds_read_b128 v[128:131], v248 offset:26624
    v_mfma_f32_16x16x32_bf16 v[184:187], v[92:95], v[72:75], v[184:187]
    ds_read_b128 v[132:135], v248 offset:27648
    v_mfma_f32_16x16x32_bf16 v[188:191], v[92:95], v[76:79], v[188:191]
    buffer_load_dwordx4 v[64:67], v23, s[16:19], s31 offen offset:0 sc1
    v_mfma_f32_16x16x32_bf16 v[200:203], v[96:99], v[72:75], v[200:203]
    v_mfma_f32_16x16x32_bf16 v[204:207], v[96:99], v[76:79], v[204:207]
    v_mfma_f32_16x16x32_bf16 v[216:219], v[100:103], v[72:75], v[216:219]
    buffer_load_dwordx4 v[68:71], v23, s[16:19], s31 offen offset:256 sc1
    v_mfma_f32_16x16x32_bf16 v[220:223], v[100:103], v[76:79], v[220:223]
    v_mfma_f32_16x16x32_bf16 v[232:235], v[104:107], v[72:75], v[232:235]
    v_mfma_f32_16x16x32_bf16 v[236:239], v[104:107], v[76:79], v[236:239]
    s_waitcnt lgkmcnt(0)
    s_barrier
    v_mfma_f32_16x16x32_bf16 v[144:147], v[108:111], v[72:75], v[144:147]
    ds_read_b128 v[80:83], v248 offset:28672
    v_mfma_f32_16x16x32_bf16 v[148:151], v[108:111], v[76:79], v[148:151]
    ds_read_b128 v[84:87], v248 offset:29696
    v_mfma_f32_16x16x32_bf16 v[160:163], v[112:115], v[72:75], v[160:163]
    ds_read_b128 v[88:91], v248 offset:30720
    v_mfma_f32_16x16x32_bf16 v[164:167], v[112:115], v[76:79], v[164:167]
    ds_read_b128 v[92:95], v248 offset:31744
    v_mfma_f32_16x16x32_bf16 v[176:179], v[116:119], v[72:75], v[176:179]
    ds_read_b128 v[96:99], v248 offset:32768
    v_mfma_f32_16x16x32_bf16 v[180:183], v[116:119], v[76:79], v[180:183]
    ds_read_b128 v[100:103], v248 offset:33792
    v_mfma_f32_16x16x32_bf16 v[192:195], v[120:123], v[72:75], v[192:195]
    ds_read_b128 v[104:107], v248 offset:34816
    v_mfma_f32_16x16x32_bf16 v[196:199], v[120:123], v[76:79], v[196:199]
    v_mfma_f32_16x16x32_bf16 v[208:211], v[124:127], v[72:75], v[208:211]
    v_mfma_f32_16x16x32_bf16 v[212:215], v[124:127], v[76:79], v[212:215]
    v_mfma_f32_16x16x32_bf16 v[224:227], v[128:131], v[72:75], v[224:227]
    v_mfma_f32_16x16x32_bf16 v[228:231], v[128:131], v[76:79], v[228:231]
    v_mfma_f32_16x16x32_bf16 v[240:243], v[132:135], v[72:75], v[240:243]
    v_mfma_f32_16x16x32_bf16 v[244:247], v[132:135], v[76:79], v[244:247]
    s_waitcnt lgkmcnt(0)
    s_waitcnt vmcnt(9)
    v_mfma_f32_16x16x32_bf16 v[136:139], v[80:83], v[32:35], v[136:139]
    ds_read_b128 v[108:111], v248 offset:35840
    s_waitcnt vmcnt(8)
    v_mfma_f32_16x16x32_bf16 v[140:143], v[80:83], v[36:39], v[140:143]
    ds_read_b128 v[112:115], v248 offset:36864
    v_mfma_f32_16x16x32_bf16 v[152:155], v[84:87], v[32:35], v[152:155]
    ds_read_b128 v[116:119], v248 offset:37888
    v_mfma_f32_16x16x32_bf16 v[156:159], v[84:87], v[36:39], v[156:159]
    ds_read_b128 v[120:123], v248 offset:38912
    v_mfma_f32_16x16x32_bf16 v[168:171], v[88:91], v[32:35], v[168:171]
    ds_read_b128 v[124:127], v248 offset:39936
    v_mfma_f32_16x16x32_bf16 v[172:175], v[88:91], v[36:39], v[172:175]
    ds_read_b128 v[128:131], v248 offset:40960
    v_mfma_f32_16x16x32_bf16 v[184:187], v[92:95], v[32:35], v[184:187]
    ds_read_b128 v[132:135], v248 offset:41984
    v_mfma_f32_16x16x32_bf16 v[188:191], v[92:95], v[36:39], v[188:191]
    buffer_load_dwordx4 v[72:75], v23, s[16:19], s31 offen offset:2048 sc1
    v_mfma_f32_16x16x32_bf16 v[200:203], v[96:99], v[32:35], v[200:203]
    v_mfma_f32_16x16x32_bf16 v[204:207], v[96:99], v[36:39], v[204:207]
    v_mfma_f32_16x16x32_bf16 v[216:219], v[100:103], v[32:35], v[216:219]
    buffer_load_dwordx4 v[76:79], v23, s[16:19], s31 offen offset:2304 sc1
    s_add_u32 s31, s31, 4096
    v_mfma_f32_16x16x32_bf16 v[220:223], v[100:103], v[36:39], v[220:223]
    v_mfma_f32_16x16x32_bf16 v[232:235], v[104:107], v[32:35], v[232:235]
    v_mfma_f32_16x16x32_bf16 v[236:239], v[104:107], v[36:39], v[236:239]
    s_waitcnt lgkmcnt(0)
    v_mfma_f32_16x16x32_bf16 v[144:147], v[108:111], v[32:35], v[144:147]
    ds_read_b128 v[80:83], v248 offset:43008
    v_mfma_f32_16x16x32_bf16 v[148:151], v[108:111], v[36:39], v[148:151]
    ds_read_b128 v[84:87], v248 offset:44032
    v_mfma_f32_16x16x32_bf16 v[160:163], v[112:115], v[32:35], v[160:163]
    ds_read_b128 v[88:91], v248 offset:45056
    v_mfma_f32_16x16x32_bf16 v[164:167], v[112:115], v[36:39], v[164:167]
    ds_read_b128 v[92:95], v248 offset:46080
    v_mfma_f32_16x16x32_bf16 v[176:179], v[116:119], v[32:35], v[176:179]
    ds_read_b128 v[96:99], v248 offset:47104
    v_mfma_f32_16x16x32_bf16 v[180:183], v[116:119], v[36:39], v[180:183]
    ds_read_b128 v[100:103], v248 offset:48128
    v_mfma_f32_16x16x32_bf16 v[192:195], v[120:123], v[32:35], v[192:195]
    ds_read_b128 v[104:107], v248 offset:49152
    v_mfma_f32_16x16x32_bf16 v[196:199], v[120:123], v[36:39], v[196:199]
    v_mfma_f32_16x16x32_bf16 v[208:211], v[124:127], v[32:35], v[208:211]
    v_mfma_f32_16x16x32_bf16 v[212:215], v[124:127], v[36:39], v[212:215]
    v_mfma_f32_16x16x32_bf16 v[224:227], v[128:131], v[32:35], v[224:227]
    v_mfma_f32_16x16x32_bf16 v[228:231], v[128:131], v[36:39], v[228:231]
    v_mfma_f32_16x16x32_bf16 v[240:243], v[132:135], v[32:35], v[240:243]
    v_mfma_f32_16x16x32_bf16 v[244:247], v[132:135], v[36:39], v[244:247]
    s_waitcnt lgkmcnt(0)
    s_waitcnt vmcnt(9)
    v_mfma_f32_16x16x32_bf16 v[136:139], v[80:83], v[40:43], v[136:139]
    ds_read_b128 v[108:111], v248 offset:50176
    s_waitcnt vmcnt(8)
    v_mfma_f32_16x16x32_bf16 v[140:143], v[80:83], v[44:47], v[140:143]
    ds_read_b128 v[112:115], v248 offset:51200
    v_mfma_f32_16x16x32_bf16 v[152:155], v[84:87], v[40:43], v[152:155]
    ds_read_b128 v[116:119], v248 offset:52224
    v_mfma_f32_16x16x32_bf16 v[156:159], v[84:87], v[44:47], v[156:159]
    ds_read_b128 v[120:123], v248 offset:53248
    v_mfma_f32_16x16x32_bf16 v[168:171], v[88:91], v[40:43], v[168:171]
    ds_read_b128 v[124:127], v248 offset:54272
    v_mfma_f32_16x16x32_bf16 v[172:175], v[88:91], v[44:47], v[172:175]
    ds_read_b128 v[128:131], v248 offset:55296
    v_mfma_f32_16x16x32_bf16 v[184:187], v[92:95], v[40:43], v[184:187]
    ds_read_b128 v[132:135], v248 offset:56320
    v_mfma_f32_16x16x32_bf16 v[188:191], v[92:95], v[44:47], v[188:191]
    buffer_load_dwordx4 v[32:35], v23, s[16:19], s31 offen offset:0 sc1
    v_mfma_f32_16x16x32_bf16 v[200:203], v[96:99], v[40:43], v[200:203]
    v_mfma_f32_16x16x32_bf16 v[204:207], v[96:99], v[44:47], v[204:207]
    v_mfma_f32_16x16x32_bf16 v[216:219], v[100:103], v[40:43], v[216:219]
    buffer_load_dwordx4 v[36:39], v23, s[16:19], s31 offen offset:256 sc1
    v_mfma_f32_16x16x32_bf16 v[220:223], v[100:103], v[44:47], v[220:223]
    v_mfma_f32_16x16x32_bf16 v[232:235], v[104:107], v[40:43], v[232:235]
    v_mfma_f32_16x16x32_bf16 v[236:239], v[104:107], v[44:47], v[236:239]
    s_waitcnt lgkmcnt(0)
    s_barrier
    v_mfma_f32_16x16x32_bf16 v[144:147], v[108:111], v[40:43], v[144:147]
    ds_read_b128 v[80:83], v248 offset:57344
    v_mfma_f32_16x16x32_bf16 v[148:151], v[108:111], v[44:47], v[148:151]
    ds_read_b128 v[84:87], v248 offset:58368
    v_mfma_f32_16x16x32_bf16 v[160:163], v[112:115], v[40:43], v[160:163]
    ds_read_b128 v[88:91], v248 offset:59392
    v_mfma_f32_16x16x32_bf16 v[164:167], v[112:115], v[44:47], v[164:167]
    ds_read_b128 v[92:95], v248 offset:60416
    v_mfma_f32_16x16x32_bf16 v[176:179], v[116:119], v[40:43], v[176:179]
    ds_read_b128 v[96:99], v248 offset:61440
    v_mfma_f32_16x16x32_bf16 v[180:183], v[116:119], v[44:47], v[180:183]
    ds_read_b128 v[100:103], v248 offset:62464
    v_mfma_f32_16x16x32_bf16 v[192:195], v[120:123], v[40:43], v[192:195]
    ds_read_b128 v[104:107], v248 offset:63488
    v_mfma_f32_16x16x32_bf16 v[196:199], v[120:123], v[44:47], v[196:199]
    v_mfma_f32_16x16x32_bf16 v[208:211], v[124:127], v[40:43], v[208:211]
    v_mfma_f32_16x16x32_bf16 v[212:215], v[124:127], v[44:47], v[212:215]
    v_mfma_f32_16x16x32_bf16 v[224:227], v[128:131], v[40:43], v[224:227]
    v_mfma_f32_16x16x32_bf16 v[228:231], v[128:131], v[44:47], v[228:231]
    v_mfma_f32_16x16x32_bf16 v[240:243], v[132:135], v[40:43], v[240:243]
    v_mfma_f32_16x16x32_bf16 v[244:247], v[132:135], v[44:47], v[244:247]
    s_waitcnt lgkmcnt(0)
    s_waitcnt vmcnt(9)
    v_mfma_f32_16x16x32_bf16 v[136:139], v[80:83], v[48:51], v[136:139]
    ds_read_b128 v[108:111], v248 offset:64512
    s_waitcnt vmcnt(8)
    v_mfma_f32_16x16x32_bf16 v[140:143], v[80:83], v[52:55], v[140:143]
    ds_read_b128 v[112:115], v249 offset:0
    v_mfma_f32_16x16x32_bf16 v[152:155], v[84:87], v[48:51], v[152:155]
    ds_read_b128 v[116:119], v249 offset:1024
    v_mfma_f32_16x16x32_bf16 v[156:159], v[84:87], v[52:55], v[156:159]
    ds_read_b128 v[120:123], v249 offset:2048
    v_mfma_f32_16x16x32_bf16 v[168:171], v[88:91], v[48:51], v[168:171]
    ds_read_b128 v[124:127], v249 offset:3072
    v_mfma_f32_16x16x32_bf16 v[172:175], v[88:91], v[52:55], v[172:175]
    ds_read_b128 v[128:131], v249 offset:4096
    v_mfma_f32_16x16x32_bf16 v[184:187], v[92:95], v[48:51], v[184:187]
    ds_read_b128 v[132:135], v249 offset:5120
    v_mfma_f32_16x16x32_bf16 v[188:191], v[92:95], v[52:55], v[188:191]
    buffer_load_dwordx4 v[40:43], v23, s[16:19], s31 offen offset:2048 sc1
    v_mfma_f32_16x16x32_bf16 v[200:203], v[96:99], v[48:51], v[200:203]
    v_mfma_f32_16x16x32_bf16 v[204:207], v[96:99], v[52:55], v[204:207]
    v_mfma_f32_16x16x32_bf16 v[216:219], v[100:103], v[48:51], v[216:219]
    buffer_load_dwordx4 v[44:47], v23, s[16:19], s31 offen offset:2304 sc1
    s_add_u32 s31, s31, 4096
    v_mfma_f32_16x16x32_bf16 v[220:223], v[100:103], v[52:55], v[220:223]
    v_mfma_f32_16x16x32_bf16 v[232:235], v[104:107], v[48:51], v[232:235]
    v_mfma_f32_16x16x32_bf16 v[236:239], v[104:107], v[52:55], v[236:239]
    s_waitcnt lgkmcnt(0)
    v_mfma_f32_16x16x32_bf16 v[144:147], v[108:111], v[48:51], v[144:147]
    ds_read_b128 v[80:83], v249 offset:6144
    v_mfma_f32_16x16x32_bf16 v[148:151], v[108:111], v[52:55], v[148:151]
    ds_read_b128 v[84:87], v249 offset:7168
    v_mfma_f32_16x16x32_bf16 v[160:163], v[112:115], v[48:51], v[160:163]
    ds_read_b128 v[88:91], v249 offset:8192
    v_mfma_f32_16x16x32_bf16 v[164:167], v[112:115], v[52:55], v[164:167]
    ds_read_b128 v[92:95], v249 offset:9216
    v_mfma_f32_16x16x32_bf16 v[176:179], v[116:119], v[48:51], v[176:179]
    ds_read_b128 v[96:99], v249 offset:10240
    v_mfma_f32_16x16x32_bf16 v[180:183], v[116:119], v[52:55], v[180:183]
    ds_read_b128 v[100:103], v249 offset:11264
    v_mfma_f32_16x16x32_bf16 v[192:195], v[120:123], v[48:51], v[192:195]
    ds_read_b128 v[104:107], v249 offset:12288
    v_mfma_f32_16x16x32_bf16 v[196:199], v[120:123], v[52:55], v[196:199]
    v_mfma_f32_16x16x32_bf16 v[208:211], v[124:127], v[48:51], v[208:211]
    v_mfma_f32_16x16x32_bf16 v[212:215], v[124:127], v[52:55], v[212:215]
    v_mfma_f32_16x16x32_bf16 v[224:227], v[128:131], v[48:51], v[224:227]
    v_mfma_f32_16x16x32_bf16 v[228:231], v[128:131], v[52:55], v[228:231]
    v_mfma_f32_16x16x32_bf16 v[240:243], v[132:135], v[48:51], v[240:243]
    v_mfma_f32_16x16x32_bf16 v[244:247], v[132:135], v[52:55], v[244:247]
    s_waitcnt lgkmcnt(0)
    s_waitcnt vmcnt(9)
    v_mfma_f32_16x16x32_bf16 v[136:139], v[80:83], v[56:59], v[136:139]
    ds_read_b128 v[108:111], v249 offset:13312
    s_waitcnt vmcnt(8)
    v_mfma_f32_16x16x32_bf16 v[140:143], v[80:83], v[60:63], v[140:143]
    ds_read_b128 v[112:115], v249 offset:14336
    v_mfma_f32_16x16x32_bf16 v[152:155], v[84:87], v[56:59], v[152:155]
    ds_read_b128 v[116:119], v249 offset:15360
    v_mfma_f32_16x16x32_bf16 v[156:159], v[84:87], v[60:63], v[156:159]
    ds_read_b128 v[120:123], v249 offset:16384
    v_mfma_f32_16x16x32_bf16 v[168:171], v[88:91], v[56:59], v[168:171]
    ds_read_b128 v[124:127], v249 offset:17408
    v_mfma_f32_16x16x32_bf16 v[172:175], v[88:91], v[60:63], v[172:175]
    ds_read_b128 v[128:131], v249 offset:18432
    v_mfma_f32_16x16x32_bf16 v[184:187], v[92:95], v[56:59], v[184:187]
    ds_read_b128 v[132:135], v249 offset:19456
    v_mfma_f32_16x16x32_bf16 v[188:191], v[92:95], v[60:63], v[188:191]
    buffer_load_dwordx4 v[48:51], v23, s[16:19], s31 offen offset:0 sc1
    v_mfma_f32_16x16x32_bf16 v[200:203], v[96:99], v[56:59], v[200:203]
    v_mfma_f32_16x16x32_bf16 v[204:207], v[96:99], v[60:63], v[204:207]
    v_mfma_f32_16x16x32_bf16 v[216:219], v[100:103], v[56:59], v[216:219]
    buffer_load_dwordx4 v[52:55], v23, s[16:19], s31 offen offset:256 sc1
    v_mfma_f32_16x16x32_bf16 v[220:223], v[100:103], v[60:63], v[220:223]
    v_mfma_f32_16x16x32_bf16 v[232:235], v[104:107], v[56:59], v[232:235]
    v_mfma_f32_16x16x32_bf16 v[236:239], v[104:107], v[60:63], v[236:239]
    s_waitcnt lgkmcnt(0)
    s_barrier
    v_mfma_f32_16x16x32_bf16 v[144:147], v[108:111], v[56:59], v[144:147]
    ds_read_b128 v[80:83], v249 offset:20480
    v_mfma_f32_16x16x32_bf16 v[148:151], v[108:111], v[60:63], v[148:151]
    ds_read_b128 v[84:87], v249 offset:21504
    v_mfma_f32_16x16x32_bf16 v[160:163], v[112:115], v[56:59], v[160:163]
    ds_read_b128 v[88:91], v249 offset:22528
    v_mfma_f32_16x16x32_bf16 v[164:167], v[112:115], v[60:63], v[164:167]
    ds_read_b128 v[92:95], v249 offset:23552
    v_mfma_f32_16x16x32_bf16 v[176:179], v[116:119], v[56:59], v[176:179]
    ds_read_b128 v[96:99], v249 offset:24576
    v_mfma_f32_16x16x32_bf16 v[180:183], v[116:119], v[60:63], v[180:183]
    ds_read_b128 v[100:103], v249 offset:25600
    v_mfma_f32_16x16x32_bf16 v[192:195], v[120:123], v[56:59], v[192:195]
    ds_read_b128 v[104:107], v249 offset:26624
    v_mfma_f32_16x16x32_bf16 v[196:199], v[120:123], v[60:63], v[196:199]
    v_mfma_f32_16x16x32_bf16 v[208:211], v[124:127], v[56:59], v[208:211]
    v_mfma_f32_16x16x32_bf16 v[212:215], v[124:127], v[60:63], v[212:215]
    v_mfma_f32_16x16x32_bf16 v[224:227], v[128:131], v[56:59], v[224:227]
    v_mfma_f32_16x16x32_bf16 v[228:231], v[128:131], v[60:63], v[228:231]
    v_mfma_f32_16x16x32_bf16 v[240:243], v[132:135], v[56:59], v[240:243]
    v_mfma_f32_16x16x32_bf16 v[244:247], v[132:135], v[60:63], v[244:247]
    s_waitcnt lgkmcnt(0)
    s_waitcnt vmcnt(9)
    v_mfma_f32_16x16x32_bf16 v[136:139], v[80:83], v[64:67], v[136:139]
    ds_read_b128 v[108:111], v249 offset:27648
    s_waitcnt vmcnt(8)
    v_mfma_f32_16x16x32_bf16 v[140:143], v[80:83], v[68:71], v[140:143]
    ds_read_b128 v[112:115], v249 offset:28672
    v_mfma_f32_16x16x32_bf16 v[152:155], v[84:87], v[64:67], v[152:155]
    ds_read_b128 v[116:119], v249 offset:29696
    v_mfma_f32_16x16x32_bf16 v[156:159], v[84:87], v[68:71], v[156:159]
    ds_read_b128 v[120:123], v249 offset:30720
    v_mfma_f32_16x16x32_bf16 v[168:171], v[88:91], v[64:67], v[168:171]
    ds_read_b128 v[124:127], v249 offset:31744
    v_mfma_f32_16x16x32_bf16 v[172:175], v[88:91], v[68:71], v[172:175]
    ds_read_b128 v[128:131], v249 offset:32768
    v_mfma_f32_16x16x32_bf16 v[184:187], v[92:95], v[64:67], v[184:187]
    ds_read_b128 v[132:135], v249 offset:33792
    v_mfma_f32_16x16x32_bf16 v[188:191], v[92:95], v[68:71], v[188:191]
    buffer_load_dwordx4 v[56:59], v23, s[16:19], s31 offen offset:2048 sc1
    v_mfma_f32_16x16x32_bf16 v[200:203], v[96:99], v[64:67], v[200:203]
    v_mfma_f32_16x16x32_bf16 v[204:207], v[96:99], v[68:71], v[204:207]
    v_mfma_f32_16x16x32_bf16 v[216:219], v[100:103], v[64:67], v[216:219]
    buffer_load_dwordx4 v[60:63], v23, s[16:19], s31 offen offset:2304 sc1
    s_add_u32 s31, s31, 4096
    v_mfma_f32_16x16x32_bf16 v[220:223], v[100:103], v[68:71], v[220:223]
    v_mfma_f32_16x16x32_bf16 v[232:235], v[104:107], v[64:67], v[232:235]
    v_mfma_f32_16x16x32_bf16 v[236:239], v[104:107], v[68:71], v[236:239]
    s_waitcnt lgkmcnt(0)
    v_mfma_f32_16x16x32_bf16 v[144:147], v[108:111], v[64:67], v[144:147]
    ds_read_b128 v[80:83], v249 offset:34816
    v_mfma_f32_16x16x32_bf16 v[148:151], v[108:111], v[68:71], v[148:151]
    ds_read_b128 v[84:87], v249 offset:35840
    v_mfma_f32_16x16x32_bf16 v[160:163], v[112:115], v[64:67], v[160:163]
    ds_read_b128 v[88:91], v249 offset:36864
    v_mfma_f32_16x16x32_bf16 v[164:167], v[112:115], v[68:71], v[164:167]
    ds_read_b128 v[92:95], v249 offset:37888
    v_mfma_f32_16x16x32_bf16 v[176:179], v[116:119], v[64:67], v[176:179]
    ds_read_b128 v[96:99], v249 offset:38912
    v_mfma_f32_16x16x32_bf16 v[180:183], v[116:119], v[68:71], v[180:183]
    ds_read_b128 v[100:103], v249 offset:39936
    v_mfma_f32_16x16x32_bf16 v[192:195], v[120:123], v[64:67], v[192:195]
    ds_read_b128 v[104:107], v249 offset:40960
    v_mfma_f32_16x16x32_bf16 v[196:199], v[120:123], v[68:71], v[196:199]
    v_mfma_f32_16x16x32_bf16 v[208:211], v[124:127], v[64:67], v[208:211]
    v_mfma_f32_16x16x32_bf16 v[212:215], v[124:127], v[68:71], v[212:215]
    v_mfma_f32_16x16x32_bf16 v[224:227], v[128:131], v[64:67], v[224:227]
    v_mfma_f32_16x16x32_bf16 v[228:231], v[128:131], v[68:71], v[228:231]
    v_mfma_f32_16x16x32_bf16 v[240:243], v[132:135], v[64:67], v[240:243]
    v_mfma_f32_16x16x32_bf16 v[244:247], v[132:135], v[68:71], v[244:247]
    s_waitcnt lgkmcnt(0)
    s_waitcnt vmcnt(9)
    v_mfma_f32_16x16x32_bf16 v[136:139], v[80:83], v[72:75], v[136:139]
    ds_read_b128 v[108:111], v249 offset:41984
    s_waitcnt vmcnt(8)
    v_mfma_f32_16x16x32_bf16 v[140:143], v[80:83], v[76:79], v[140:143]
    ds_read_b128 v[112:115], v249 offset:43008
    v_mfma_f32_16x16x32_bf16 v[152:155], v[84:87], v[72:75], v[152:155]
    ds_read_b128 v[116:119], v249 offset:44032
    v_mfma_f32_16x16x32_bf16 v[156:159], v[84:87], v[76:79], v[156:159]
    ds_read_b128 v[120:123], v249 offset:45056
    v_mfma_f32_16x16x32_bf16 v[168:171], v[88:91], v[72:75], v[168:171]
    ds_read_b128 v[124:127], v249 offset:46080
    v_mfma_f32_16x16x32_bf16 v[172:175], v[88:91], v[76:79], v[172:175]
    ds_read_b128 v[128:131], v249 offset:47104
    v_mfma_f32_16x16x32_bf16 v[184:187], v[92:95], v[72:75], v[184:187]
    ds_read_b128 v[132:135], v249 offset:48128
    v_mfma_f32_16x16x32_bf16 v[188:191], v[92:95], v[76:79], v[188:191]
    buffer_load_dwordx4 v[64:67], v23, s[16:19], s31 offen offset:0 sc1
    v_mfma_f32_16x16x32_bf16 v[200:203], v[96:99], v[72:75], v[200:203]
    v_mfma_f32_16x16x32_bf16 v[204:207], v[96:99], v[76:79], v[204:207]
    v_mfma_f32_16x16x32_bf16 v[216:219], v[100:103], v[72:75], v[216:219]
    buffer_load_dwordx4 v[68:71], v23, s[16:19], s31 offen offset:256 sc1
    v_mfma_f32_16x16x32_bf16 v[220:223], v[100:103], v[76:79], v[220:223]
    v_mfma_f32_16x16x32_bf16 v[232:235], v[104:107], v[72:75], v[232:235]
    v_mfma_f32_16x16x32_bf16 v[236:239], v[104:107], v[76:79], v[236:239]
    s_waitcnt lgkmcnt(0)
    s_barrier
    v_mfma_f32_16x16x32_bf16 v[144:147], v[108:111], v[72:75], v[144:147]
    ds_read_b128 v[80:83], v249 offset:49152
    v_mfma_f32_16x16x32_bf16 v[148:151], v[108:111], v[76:79], v[148:151]
    ds_read_b128 v[84:87], v249 offset:50176
    v_mfma_f32_16x16x32_bf16 v[160:163], v[112:115], v[72:75], v[160:163]
    ds_read_b128 v[88:91], v249 offset:51200
    v_mfma_f32_16x16x32_bf16 v[164:167], v[112:115], v[76:79], v[164:167]
    ds_read_b128 v[92:95], v249 offset:52224
    v_mfma_f32_16x16x32_bf16 v[176:179], v[116:119], v[72:75], v[176:179]
    ds_read_b128 v[96:99], v249 offset:53248
    v_mfma_f32_16x16x32_bf16 v[180:183], v[116:119], v[76:79], v[180:183]
    ds_read_b128 v[100:103], v249 offset:54272
    v_mfma_f32_16x16x32_bf16 v[192:195], v[120:123], v[72:75], v[192:195]
    ds_read_b128 v[104:107], v249 offset:55296
    v_mfma_f32_16x16x32_bf16 v[196:199], v[120:123], v[76:79], v[196:199]
    v_mfma_f32_16x16x32_bf16 v[208:211], v[124:127], v[72:75], v[208:211]
    v_mfma_f32_16x16x32_bf16 v[212:215], v[124:127], v[76:79], v[212:215]
    v_mfma_f32_16x16x32_bf16 v[224:227], v[128:131], v[72:75], v[224:227]
    v_mfma_f32_16x16x32_bf16 v[228:231], v[128:131], v[76:79], v[228:231]
    v_mfma_f32_16x16x32_bf16 v[240:243], v[132:135], v[72:75], v[240:243]
    v_mfma_f32_16x16x32_bf16 v[244:247], v[132:135], v[76:79], v[244:247]
    s_waitcnt lgkmcnt(0)
    s_waitcnt vmcnt(9)
    v_mfma_f32_16x16x32_bf16 v[136:139], v[80:83], v[32:35], v[136:139]
    ds_read_b128 v[108:111], v249 offset:56320
    s_waitcnt vmcnt(8)
    v_mfma_f32_16x16x32_bf16 v[140:143], v[80:83], v[36:39], v[140:143]
    ds_read_b128 v[112:115], v249 offset:57344
    v_mfma_f32_16x16x32_bf16 v[152:155], v[84:87], v[32:35], v[152:155]
    ds_read_b128 v[116:119], v249 offset:58368
    v_mfma_f32_16x16x32_bf16 v[156:159], v[84:87], v[36:39], v[156:159]
    ds_read_b128 v[120:123], v249 offset:59392
    v_mfma_f32_16x16x32_bf16 v[168:171], v[88:91], v[32:35], v[168:171]
    ds_read_b128 v[124:127], v249 offset:60416
    v_mfma_f32_16x16x32_bf16 v[172:175], v[88:91], v[36:39], v[172:175]
    ds_read_b128 v[128:131], v249 offset:61440
    v_mfma_f32_16x16x32_bf16 v[184:187], v[92:95], v[32:35], v[184:187]
    ds_read_b128 v[132:135], v249 offset:62464
    v_mfma_f32_16x16x32_bf16 v[188:191], v[92:95], v[36:39], v[188:191]
    buffer_load_dwordx4 v[72:75], v23, s[16:19], s31 offen offset:2048 sc1
    v_mfma_f32_16x16x32_bf16 v[200:203], v[96:99], v[32:35], v[200:203]
    v_mfma_f32_16x16x32_bf16 v[204:207], v[96:99], v[36:39], v[204:207]
    v_mfma_f32_16x16x32_bf16 v[216:219], v[100:103], v[32:35], v[216:219]
    buffer_load_dwordx4 v[76:79], v23, s[16:19], s31 offen offset:2304 sc1
    s_add_u32 s31, s31, 4096
    v_mfma_f32_16x16x32_bf16 v[220:223], v[100:103], v[36:39], v[220:223]
    v_mfma_f32_16x16x32_bf16 v[232:235], v[104:107], v[32:35], v[232:235]
    v_mfma_f32_16x16x32_bf16 v[236:239], v[104:107], v[36:39], v[236:239]
    s_waitcnt lgkmcnt(0)
    v_mfma_f32_16x16x32_bf16 v[144:147], v[108:111], v[32:35], v[144:147]
    ds_read_b128 v[80:83], v249 offset:63488
    v_mfma_f32_16x16x32_bf16 v[148:151], v[108:111], v[36:39], v[148:151]
    ds_read_b128 v[84:87], v249 offset:64512
    v_mfma_f32_16x16x32_bf16 v[160:163], v[112:115], v[32:35], v[160:163]
    ds_read_b128 v[88:91], v250 offset:0
    v_mfma_f32_16x16x32_bf16 v[164:167], v[112:115], v[36:39], v[164:167]
    ds_read_b128 v[92:95], v250 offset:1024
    v_mfma_f32_16x16x32_bf16 v[176:179], v[116:119], v[32:35], v[176:179]
    ds_read_b128 v[96:99], v250 offset:2048
    v_mfma_f32_16x16x32_bf16 v[180:183], v[116:119], v[36:39], v[180:183]
    ds_read_b128 v[100:103], v250 offset:3072
    v_mfma_f32_16x16x32_bf16 v[192:195], v[120:123], v[32:35], v[192:195]
    ds_read_b128 v[104:107], v250 offset:4096
    v_mfma_f32_16x16x32_bf16 v[196:199], v[120:123], v[36:39], v[196:199]
    v_mfma_f32_16x16x32_bf16 v[208:211], v[124:127], v[32:35], v[208:211]
    v_mfma_f32_16x16x32_bf16 v[212:215], v[124:127], v[36:39], v[212:215]
    v_mfma_f32_16x16x32_bf16 v[224:227], v[128:131], v[32:35], v[224:227]
    v_mfma_f32_16x16x32_bf16 v[228:231], v[128:131], v[36:39], v[228:231]
    v_mfma_f32_16x16x32_bf16 v[240:243], v[132:135], v[32:35], v[240:243]
    v_mfma_f32_16x16x32_bf16 v[244:247], v[132:135], v[36:39], v[244:247]
    s_waitcnt lgkmcnt(0)
    s_waitcnt vmcnt(9)
    v_mfma_f32_16x16x32_bf16 v[136:139], v[80:83], v[40:43], v[136:139]
    ds_read_b128 v[108:111], v250 offset:5120
    s_waitcnt vmcnt(8)
    v_mfma_f32_16x16x32_bf16 v[140:143], v[80:83], v[44:47], v[140:143]
    ds_read_b128 v[112:115], v250 offset:6144
    v_mfma_f32_16x16x32_bf16 v[152:155], v[84:87], v[40:43], v[152:155]
    ds_read_b128 v[116:119], v250 offset:7168
    v_mfma_f32_16x16x32_bf16 v[156:159], v[84:87], v[44:47], v[156:159]
    ds_read_b128 v[120:123], v250 offset:8192
    v_mfma_f32_16x16x32_bf16 v[168:171], v[88:91], v[40:43], v[168:171]
    ds_read_b128 v[124:127], v250 offset:9216
    v_mfma_f32_16x16x32_bf16 v[172:175], v[88:91], v[44:47], v[172:175]
    ds_read_b128 v[128:131], v250 offset:10240
    v_mfma_f32_16x16x32_bf16 v[184:187], v[92:95], v[40:43], v[184:187]
    ds_read_b128 v[132:135], v250 offset:11264
    v_mfma_f32_16x16x32_bf16 v[188:191], v[92:95], v[44:47], v[188:191]
    buffer_load_dwordx4 v[32:35], v23, s[16:19], s31 offen offset:0 sc1
    v_mfma_f32_16x16x32_bf16 v[200:203], v[96:99], v[40:43], v[200:203]
    v_mfma_f32_16x16x32_bf16 v[204:207], v[96:99], v[44:47], v[204:207]
    v_mfma_f32_16x16x32_bf16 v[216:219], v[100:103], v[40:43], v[216:219]
    buffer_load_dwordx4 v[36:39], v23, s[16:19], s31 offen offset:256 sc1
    v_mfma_f32_16x16x32_bf16 v[220:223], v[100:103], v[44:47], v[220:223]
    v_mfma_f32_16x16x32_bf16 v[232:235], v[104:107], v[40:43], v[232:235]
    v_mfma_f32_16x16x32_bf16 v[236:239], v[104:107], v[44:47], v[236:239]
pg_3:
    s_cbranch_execz pg_ret
    s_waitcnt lgkmcnt(0)
    s_barrier
    v_mfma_f32_16x16x32_bf16 v[144:147], v[108:111], v[40:43], v[144:147]
    ds_read_b128 v[80:83], v250 offset:12288
    v_mfma_f32_16x16x32_bf16 v[148:151], v[108:111], v[44:47], v[148:151]
    ds_read_b128 v[84:87], v250 offset:13312
    v_mfma_f32_16x16x32_bf16 v[160:163], v[112:115], v[40:43], v[160:163]
    ds_read_b128 v[88:91], v250 offset:14336
    v_mfma_f32_16x16x32_bf16 v[164:167], v[112:115], v[44:47], v[164:167]
    ds_read_b128 v[92:95], v250 offset:15360
    v_mfma_f32_16x16x32_bf16 v[176:179], v[116:119], v[40:43], v[176:179]
    ds_read_b128 v[96:99], v250 offset:16384
    v_mfma_f32_16x16x32_bf16 v[180:183], v[116:119], v[44:47], v[180:183]
    ds_read_b128 v[100:103], v250 offset:17408
    v_mfma_f32_16x16x32_bf16 v[192:195], v[120:123], v[40:43], v[192:195]
    ds_read_b128 v[104:107], v250 offset:18432
    v_mfma_f32_16x16x32_bf16 v[196:199], v[120:123], v[44:47], v[196:199]
    v_mfma_f32_16x16x32_bf16 v[208:211], v[124:127], v[40:43], v[208:211]
    v_mfma_f32_16x16x32_bf16 v[212:215], v[124:127], v[44:47], v[212:215]
    v_mfma_f32_16x16x32_bf16 v[224:227], v[128:131], v[40:43], v[224:227]
    v_mfma_f32_16x16x32_bf16 v[228:231], v[128:131], v[44:47], v[228:231]
    v_mfma_f32_16x16x32_bf16 v[240:243], v[132:135], v[40:43], v[240:243]
    v_mfma_f32_16x16x32_bf16 v[244:247], v[132:135], v[44:47], v[244:247]
    s_waitcnt lgkmcnt(0)
    s_waitcnt vmcnt(9)
    v_mfma_f32_16x16x32_bf16 v[136:139], v[80:83], v[48:51], v[136:139]
    ds_read_b128 v[108:111], v250 offset:19456
    s_waitcnt vmcnt(8)
    v_mfma_f32_16x16x32_bf16 v[140:143], v[80:83], v[52:55], v[140:143]
    ds_read_b128 v[112:115], v250 offset:20480
    v_mfma_f32_16x16x32_bf16 v[152:155], v[84:87], v[48:51], v[152:155]
    ds_read_b128 v[116:119], v250 offset:21504
    v_mfma_f32_16x16x32_bf16 v[156:159], v[84:87], v[52:55], v[156:159]
    ds_read_b128 v[120:123], v250 offset:22528
    v_mfma_f32_16x16x32_bf16 v[168:171], v[88:91], v[48:51], v[168:171]
    ds_read_b128 v[124:127], v250 offset:23552
    v_mfma_f32_16x16x32_bf16 v[172:175], v[88:91], v[52:55], v[172:175]
    ds_read_b128 v[128:131], v250 offset:24576
    v_mfma_f32_16x16x32_bf16 v[184:187], v[92:95], v[48:51], v[184:187]
    ds_read_b128 v[132:135], v250 offset:25600
    v_mfma_f32_16x16x32_bf16 v[188:191], v[92:95], v[52:55], v[188:191]
    buffer_load_dwordx4 v[40:43], v23, s[16:19], s31 offen offset:2048 sc1
    v_mfma_f32_16x16x32_bf16 v[200:203], v[96:99], v[48:51], v[200:203]
    v_mfma_f32_16x16x32_bf16 v[204:207], v[96:99], v[52:55], v[204:207]
    v_mfma_f32_16x16x32_bf16 v[216:219], v[100:103], v[48:51], v[216:219]
    buffer_load_dwordx4 v[44:47], v23, s[16:19], s31 offen offset:2304 sc1
    s_add_u32 s31, s31, 4096
    v_mfma_f32_16x16x32_bf16 v[220:223], v[100:103], v[52:55], v[220:223]
    v_mfma_f32_16x16x32_bf16 v[232:235], v[104:107], v[48:51], v[232:235]
    v_mfma_f32_16x16x32_bf16 v[236:239], v[104:107], v[52:55], v[236:239]
    s_waitcnt lgkmcnt(0)
    v_mfma_f32_16x16x32_bf16 v[144:147], v[108:111], v[48:51], v[144:147]
    ds_read_b128 v[80:83], v250 offset:26624
    v_mfma_f32_16x16x32_bf16 v[148:151], v[108:111], v[52:55], v[148:151]
    ds_read_b128 v[84:87], v250 offset:27648
    v_mfma_f32_16x16x32_bf16 v[160:163], v[112:115], v[48:51], v[160:163]
    ds_read_b128 v[88:91], v248 offset:0
    v_mfma_f32_16x16x32_bf16 v[164:167], v[112:115], v[52:55], v[164:167]
    ds_read_b128 v[92:95], v248 offset:1024
    v_mfma_f32_16x16x32_bf16 v[176:179], v[116:119], v[48:51], v[176:179]
    ds_read_b128 v[96:99], v248 offset:2048
    v_mfma_f32_16x16x32_bf16 v[180:183], v[116:119], v[52:55], v[180:183]
    ds_read_b128 v[100:103], v248 offset:3072
    v_mfma_f32_16x16x32_bf16 v[192:195], v[120:123], v[48:51], v[192:195]
    ds_read_b128 v[104:107], v248 offset:4096
    v_mfma_f32_16x16x32_bf16 v[196:199], v[120:123], v[52:55], v[196:199]
    v_mfma_f32_16x16x32_bf16 v[208:211], v[124:127], v[48:51], v[208:211]
    v_mfma_f32_16x16x32_bf16 v[212:215], v[124:127], v[52:55], v[212:215]
    v_mfma_f32_16x16x32_bf16 v[224:227], v[128:131], v[48:51], v[224:227]
    v_mfma_f32_16x16x32_bf16 v[228:231], v[128:131], v[52:55], v[228:231]
    v_mfma_f32_16x16x32_bf16 v[240:243], v[132:135], v[48:51], v[240:243]
    v_mfma_f32_16x16x32_bf16 v[244:247], v[132:135], v[52:55], v[244:247]
    s_waitcnt lgkmcnt(0)
    s_waitcnt vmcnt(9)
    v_mfma_f32_16x16x32_bf16 v[136:139], v[80:83], v[56:59], v[136:139]
    ds_read_b128 v[108:111], v248 offset:5120
    s_waitcnt vmcnt(8)
    v_mfma_f32_16x16x32_bf16 v[140:143], v[80:83], v[60:63], v[140:143]
    ds_read_b128 v[112:115], v248 offset:6144
    v_mfma_f32_16x16x32_bf16 v[144:147], v[84:87], v[56:59], v[144:147]
    ds_read_b128 v[116:119], v248 offset:7168
    v_mfma_f32_16x16x32_bf16 v[148:151], v[84:87], v[60:63], v[148:151]
    ds_read_b128 v[120:123], v248 offset:8192
    s_waitcnt vmcnt(7)
    v_mfma_f32_16x16x32_bf16 v[136:139], v[88:91], v[64:67], v[136:139]
    ds_read_b128 v[124:127], v248 offset:9216
    s_waitcnt vmcnt(6)
    v_mfma_f32_16x16x32_bf16 v[140:143], v[88:91], v[68:71], v[140:143]
    ds_read_b128 v[128:131], v248 offset:10240
    v_mfma_f32_16x16x32_bf16 v[144:147], v[92:95], v[64:67], v[144:147]
    ds_read_b128 v[132:135], v248 offset:11264
    v_mfma_f32_16x16x32_bf16 v[148:151], v[92:95], v[68:71], v[148:151]
    s_waitcnt vmcnt(5)
    v_mfma_f32_16x16x32_bf16 v[136:139], v[96:99], v[72:75], v[136:139]
    s_waitcnt vmcnt(4)
    v_mfma_f32_16x16x32_bf16 v[140:143], v[96:99], v[76:79], v[140:143]
    v_mfma_f32_16x16x32_bf16 v[144:147], v[100:103], v[72:75], v[144:147]
    v_mfma_f32_16x16x32_bf16 v[148:151], v[100:103], v[76:79], v[148:151]
    s_waitcnt vmcnt(3)
    v_mfma_f32_16x16x32_bf16 v[136:139], v[104:107], v[32:35], v[136:139]
    s_waitcnt vmcnt(2)
    v_mfma_f32_16x16x32_bf16 v[140:143], v[104:107], v[36:39], v[140:143]
    s_waitcnt lgkmcnt(0)
    s_barrier
    v_mfma_f32_16x16x32_bf16 v[144:147], v[108:111], v[32:35], v[144:147]
    ds_read_b128 v[80:83], v248 offset:12288
    v_mfma_f32_16x16x32_bf16 v[148:151], v[108:111], v[36:39], v[148:151]
    ds_read_b128 v[84:87], v248 offset:13312
    s_waitcnt vmcnt(1)
    v_mfma_f32_16x16x32_bf16 v[136:139], v[112:115], v[40:43], v[136:139]
    ds_read_b128 v[88:91], v248 offset:14336
    s_waitcnt vmcnt(0)
    v_mfma_f32_16x16x32_bf16 v[140:143], v[112:115], v[44:47], v[140:143]
    ds_read_b128 v[92:95], v248 offset:15360
    v_mfma_f32_16x16x32_bf16 v[144:147], v[116:119], v[40:43], v[144:147]
    ds_read_b128 v[96:99], v248 offset:16384
    v_mfma_f32_16x16x32_bf16 v[148:151], v[116:119], v[44:47], v[148:151]
    ds_read_b128 v[100:103], v248 offset:17408
    v_mfma_f32_16x16x32_bf16 v[152:155], v[120:123], v[56:59], v[152:155]
    ds_read_b128 v[104:107], v248 offset:18432
    v_max_f32 v136, 0, v136
    v_mfma_f32_16x16x32_bf16 v[156:159], v[120:123], v[60:63], v[156:159]
    v_max_f32 v137, 0, v137
    v_max_f32 v138, 0, v138
    v_mfma_f32_16x16x32_bf16 v[160:163], v[124:127], v[56:59], v[160:163]
    v_max_f32 v139, 0, v139
    v_max_f32 v140, 0, v140
    v_mfma_f32_16x16x32_bf16 v[164:167], v[124:127], v[60:63], v[164:167]
    v_max_f32 v141, 0, v141
    v_max_f32 v142, 0, v142
    v_mfma_f32_16x16x32_bf16 v[152:155], v[128:131], v[64:67], v[152:155]
    v_max_f32 v143, 0, v143
    v_mul_f32 v144, v144, v21
    v_mfma_f32_16x16x32_bf16 v[156:159], v[128:131], v[68:71], v[156:159]
    v_mul_f32 v145, v145, v21
    v_mul_f32 v146, v146, v21
    v_mfma_f32_16x16x32_bf16 v[160:163], v[132:135], v[64:67], v[160:163]
    v_mul_f32 v147, v147, v21
    v_mul_f32 v148, v148, v22
    v_mfma_f32_16x16x32_bf16 v[164:167], v[132:135], v[68:71], v[164:167]
    v_mul_f32 v149, v149, v22
    v_mul_f32 v150, v150, v22
    s_waitcnt lgkmcnt(0)
    v_mfma_f32_16x16x32_bf16 v[152:155], v[80:83], v[72:75], v[152:155]
    ds_read_b128 v[108:111], v248 offset:19456
    v_mul_f32 v151, v151, v22
    v_mfma_f32_16x16x32_bf16 v[156:159], v[80:83], v[76:79], v[156:159]
    ds_read_b128 v[112:115], v248 offset:20480
    v_mul_f32 v136, v136, v144
    v_mfma_f32_16x16x32_bf16 v[160:163], v[84:87], v[72:75], v[160:163]
    ds_read_b128 v[116:119], v248 offset:21504
    v_mul_f32 v137, v137, v145
    v_mfma_f32_16x16x32_bf16 v[164:167], v[84:87], v[76:79], v[164:167]
    ds_read_b128 v[120:123], v248 offset:22528
    v_mul_f32 v138, v138, v146
    v_mfma_f32_16x16x32_bf16 v[152:155], v[88:91], v[32:35], v[152:155]
    ds_read_b128 v[124:127], v248 offset:23552
    v_mul_f32 v139, v139, v147
    v_mfma_f32_16x16x32_bf16 v[156:159], v[88:91], v[36:39], v[156:159]
    ds_read_b128 v[128:131], v248 offset:24576
    v_mul_f32 v140, v140, v148
    v_mfma_f32_16x16x32_bf16 v[160:163], v[92:95], v[32:35], v[160:163]
    ds_read_b128 v[132:135], v248 offset:25600
    v_mul_f32 v141, v141, v149
    v_mfma_f32_16x16x32_bf16 v[164:167], v[92:95], v[36:39], v[164:167]
    v_mul_f32 v142, v142, v150
    v_mul_f32 v143, v143, v151
    v_mfma_f32_16x16x32_bf16 v[152:155], v[96:99], v[40:43], v[152:155]
    v_cvt_pk_bf16_f32 v144, v136, v137
    v_cvt_pk_bf16_f32 v146, v140, v141
    v_mfma_f32_16x16x32_bf16 v[156:159], v[96:99], v[44:47], v[156:159]
    v_cvt_pk_bf16_f32 v145, v138, v139
    v_cvt_pk_bf16_f32 v147, v142, v143
    v_mfma_f32_16x16x32_bf16 v[160:163], v[100:103], v[40:43], v[160:163]
    v_permlane16_swap_b32 v144, v146
    v_permlane16_swap_b32 v145, v147
    v_mfma_f32_16x16x32_bf16 v[164:167], v[100:103], v[44:47], v[164:167]
    buffer_store_dwordx4 v[144:147], v6, s[16:19], s35 offen offset:0 sc1
    v_mfma_f32_16x16x32_bf16 v[168:171], v[104:107], v[56:59], v[168:171]
    v_max_f32 v152, 0, v152
    v_max_f32 v153, 0, v153
    v_mfma_f32_16x16x32_bf16 v[172:175], v[104:107], v[60:63], v[172:175]
    v_max_f32 v154, 0, v154
    v_max_f32 v155, 0, v155
    s_waitcnt lgkmcnt(0)
    v_mfma_f32_16x16x32_bf16 v[176:179], v[108:111], v[56:59], v[176:179]
    ds_read_b128 v[80:83], v248 offset:26624
    v_max_f32 v156, 0, v156
    v_mfma_f32_16x16x32_bf16 v[180:183], v[108:111], v[60:63], v[180:183]
    ds_read_b128 v[84:87], v248 offset:27648
    v_max_f32 v157, 0, v157
    v_mfma_f32_16x16x32_bf16 v[168:171], v[112:115], v[64:67], v[168:171]
    ds_read_b128 v[88:91], v248 offset:28672
    v_max_f32 v158, 0, v158
    v_mfma_f32_16x16x32_bf16 v[172:175], v[112:115], v[68:71], v[172:175]
    ds_read_b128 v[92:95], v248 offset:29696
    v_max_f32 v159, 0, v159
    v_mfma_f32_16x16x32_bf16 v[176:179], v[116:119], v[64:67], v[176:179]
    ds_read_b128 v[96:99], v248 offset:30720
    v_mul_f32 v160, v160, v21
    v_mfma_f32_16x16x32_bf16 v[180:183], v[116:119], v[68:71], v[180:183]
    ds_read_b128 v[100:103], v248 offset:31744
    v_mul_f32 v161, v161, v21
    v_mfma_f32_16x16x32_bf16 v[168:171], v[120:123], v[72:75], v[168:171]
    ds_read_b128 v[104:107], v248 offset:32768
    v_mul_f32 v162, v162, v21
    v_mfma_f32_16x16x32_bf16 v[172:175], v[120:123], v[76:79], v[172:175]
    v_mul_f32 v163, v163, v21
    v_mul_f32 v164, v164, v22
    v_mfma_f32_16x16x32_bf16 v[176:179], v[124:127], v[72:75], v[176:179]
    v_mul_f32 v165, v165, v22
    v_mul_f32 v166, v166, v22
    v_mfma_f32_16x16x32_bf16 v[180:183], v[124:127], v[76:79], v[180:183]
    v_mul_f32 v167, v167, v22
    v_mul_f32 v152, v152, v160
    v_mfma_f32_16x16x32_bf16 v[168:171], v[128:131], v[32:35], v[168:171]
    v_mul_f32 v153, v153, v161
    v_mul_f32 v154, v154, v162
    v_mfma_f32_16x16x32_bf16 v[172:175], v[128:131], v[36:39], v[172:175]
    v_mul_f32 v155, v155, v163
    v_mul_f32 v156, v156, v164
    v_mfma_f32_16x16x32_bf16 v[176:179], v[132:135], v[32:35], v[176:179]
    v_mul_f32 v157, v157, v165
    v_mul_f32 v158, v158, v166
    v_mfma_f32_16x16x32_bf16 v[180:183], v[132:135], v[36:39], v[180:183]
    v_mul_f32 v159, v159, v167
    v_cvt_pk_bf16_f32 v160, v152, v153
    s_waitcnt lgkmcnt(0)
    v_mfma_f32_16x16x32_bf16 v[168:171], v[80:83], v[40:43], v[168:171]
    ds_read_b128 v[108:111], v248 offset:33792
    v_cvt_pk_bf16_f32 v162, v156, v157
    v_mfma_f32_16x16x32_bf16 v[172:175], v[80:83], v[44:47], v[172:175]
    ds_read_b128 v[112:115], v248 offset:34816
    v_cvt_pk_bf16_f32 v161, v154, v155
    v_mfma_f32_16x16x32_bf16 v[176:179], v[84:87], v[40:43], v[176:179]
    ds_read_b128 v[116:119], v248 offset:35840
    v_cvt_pk_bf16_f32 v163, v158, v159
    v_mfma_f32_16x16x32_bf16 v[180:183], v[84:87], v[44:47], v[180:183]
    ds_read_b128 v[120:123], v248 offset:36864
    v_permlane16_swap_b32 v160, v162
    v_mfma_f32_16x16x32_bf16 v[184:187], v[88:91], v[56:59], v[184:187]
    ds_read_b128 v[124:127], v248 offset:37888
    v_permlane16_swap_b32 v161, v163
    v_mfma_f32_16x16x32_bf16 v[188:191], v[88:91], v[60:63], v[188:191]
    ds_read_b128 v[128:131], v248 offset:38912
    buffer_store_dwordx4 v[160:163], v6, s[16:19], s35 offen offset:512 sc1
    v_mfma_f32_16x16x32_bf16 v[192:195], v[92:95], v[56:59], v[192:195]
    ds_read_b128 v[132:135], v248 offset:39936
    v_max_f32 v168, 0, v168
    v_mfma_f32_16x16x32_bf16 v[196:199], v[92:95], v[60:63], v[196:199]
    v_max_f32 v169, 0, v169
    v_max_f32 v170, 0, v170
    v_mfma_f32_16x16x32_bf16 v[184:187], v[96:99], v[64:67], v[184:187]
    v_max_f32 v171, 0, v171
    v_max_f32 v172, 0, v172
    v_mfma_f32_16x16x32_bf16 v[188:191], v[96:99], v[68:71], v[188:191]
    v_max_f32 v173, 0, v173
    v_max_f32 v174, 0, v174
    v_mfma_f32_16x16x32_bf16 v[192:195], v[100:103], v[64:67], v[192:195]
    v_max_f32 v175, 0, v175
    v_mul_f32 v176, v176, v21
    v_mfma_f32_16x16x32_bf16 v[196:199], v[100:103], v[68:71], v[196:199]
    v_mul_f32 v177, v177, v21
    v_mul_f32 v178, v178, v21
    v_mfma_f32_16x16x32_bf16 v[184:187], v[104:107], v[72:75], v[184:187]
    v_mul_f32 v179, v179, v21
    v_mul_f32 v180, v180, v22
    v_mfma_f32_16x16x32_bf16 v[188:191], v[104:107], v[76:79], v[188:191]
    v_mul_f32 v181, v181, v22
    v_mul_f32 v182, v182, v22
    s_waitcnt lgkmcnt(0)
    s_barrier
    v_mfma_f32_16x16x32_bf16 v[192:195], v[108:111], v[72:75], v[192:195]
    ds_read_b128 v[80:83], v248 offset:40960
    v_mul_f32 v183, v183, v22
    v_mfma_f32_16x16x32_bf16 v[196:199], v[108:111], v[76:79], v[196:199]
    ds_read_b128 v[84:87], v248 offset:41984
    v_mul_f32 v168, v168, v176
    v_mfma_f32_16x16x32_bf16 v[184:187], v[112:115], v[32:35], v[184:187]
    ds_read_b128 v[88:91], v248 offset:43008
    v_mul_f32 v169, v169, v177
    v_mfma_f32_16x16x32_bf16 v[188:191], v[112:115], v[36:39], v[188:191]
    ds_read_b128 v[92:95], v248 offset:44032
    v_mul_f32 v170, v170, v178
    v_mfma_f32_16x16x32_bf16 v[192:195], v[116:119], v[32:35], v[192:195]
    ds_read_b128 v[96:99], v248 offset:45056
    v_mul_f32 v171, v171, v179
    v_mfma_f32_16x16x32_bf16 v[196:199], v[116:119], v[36:39], v[196:199]
    ds_read_b128 v[100:103], v248 offset:46080
    v_mul_f32 v172, v172, v180
    v_mfma_f32_16x16x32_bf16 v[184:187], v[120:123], v[40:43], v[184:187]
    ds_read_b128 v[104:107], v248 offset:47104
    v_mul_f32 v173, v173, v181
    v_mfma_f32_16x16x32_bf16 v[188:191], v[120:123], v[44:47], v[188:191]
    v_mul_f32 v174, v174, v182
    v_mul_f32 v175, v175, v183
    v_mfma_f32_16x16x32_bf16 v[192:195], v[124:127], v[40:43], v[192:195]
    v_cvt_pk_bf16_f32 v176, v168, v169
    v_cvt_pk_bf16_f32 v178, v172, v173
    v_mfma_f32_16x16x32_bf16 v[196:199], v[124:127], v[44:47], v[196:199]
    v_cvt_pk_bf16_f32 v177, v170, v171
    v_cvt_pk_bf16_f32 v179, v174, v175
    v_mfma_f32_16x16x32_bf16 v[200:203], v[128:131], v[56:59], v[200:203]
    v_permlane16_swap_b32 v176, v178
    v_permlane16_swap_b32 v177, v179
    v_mfma_f32_16x16x32_bf16 v[204:207], v[128:131], v[60:63], v[204:207]
    buffer_store_dwordx4 v[176:179], v6, s[16:19], s35 offen offset:1024 sc1
    v_mfma_f32_16x16x32_bf16 v[208:211], v[132:135], v[56:59], v[208:211]
    v_max_f32 v184, 0, v184
    v_max_f32 v185, 0, v185
    v_mfma_f32_16x16x32_bf16 v[212:215], v[132:135], v[60:63], v[212:215]
    v_max_f32 v186, 0, v186
    v_max_f32 v187, 0, v187
    s_waitcnt lgkmcnt(0)
    v_mfma_f32_16x16x32_bf16 v[200:203], v[80:83], v[64:67], v[200:203]
    ds_read_b128 v[108:111], v248 offset:48128
    v_max_f32 v188, 0, v188
    v_mfma_f32_16x16x32_bf16 v[204:207], v[80:83], v[68:71], v[204:207]
    ds_read_b128 v[112:115], v248 offset:49152
    v_max_f32 v189, 0, v189
    v_mfma_f32_16x16x32_bf16 v[208:211], v[84:87], v[64:67], v[208:211]
    ds_read_b128 v[116:119], v248 offset:50176
    v_max_f32 v190, 0, v190
    v_mfma_f32_16x16x32_bf16 v[212:215], v[84:87], v[68:71], v[212:215]
    ds_read_b128 v[120:123], v248 offset:51200
    v_max_f32 v191, 0, v191
    v_mfma_f32_16x16x32_bf16 v[200:203], v[88:91], v[72:75], v[200:203]
    ds_read_b128 v[124:127], v248 offset:52224
    v_mul_f32 v192, v192, v21
    v_mfma_f32_16x16x32_bf16 v[204:207], v[88:91], v[76:79], v[204:207]
    ds_read_b128 v[128:131], v248 offset:53248
    v_mul_f32 v193, v193, v21
    v_mfma_f32_16x16x32_bf16 v[208:211], v[92:95], v[72:75], v[208:211]
    ds_read_b128 v[132:135], v248 offset:54272
    v_mul_f32 v194, v194, v21
    v_mfma_f32_16x16x32_bf16 v[212:215], v[92:95], v[76:79], v[212:215]
    v_mul_f32 v195, v195, v21
    v_mul_f32 v196, v196, v22
    v_mfma_f32_16x16x32_bf16 v[200:203], v[96:99], v[32:35], v[200:203]
    v_mul_f32 v197, v197, v22
    v_mul_f32 v198, v198, v22
    v_mfma_f32_16x16x32_bf16 v[204:207], v[96:99], v[36:39], v[204:207]
    v_mul_f32 v199, v199, v22
    v_mul_f32 v184, v184, v192
    v_mfma_f32_16x16x32_bf16 v[208:211], v[100:103], v[32:35], v[208:211]
    v_mul_f32 v185, v185, v193
    v_mul_f32 v186, v186, v194
    v_mfma_f32_16x16x32_bf16 v[212:215], v[100:103], v[36:39], v[212:215]
    v_mul_f32 v187, v187, v195
    v_mul_f32 v188, v188, v196
    v_mfma_f32_16x16x32_bf16 v[200:203], v[104:107], v[40:43], v[200:203]
    v_mul_f32 v189, v189, v197
    v_mul_f32 v190, v190, v198
    v_mfma_f32_16x16x32_bf16 v[204:207], v[104:107], v[44:47], v[204:207]
    v_mul_f32 v191, v191, v199
    v_cvt_pk_bf16_f32 v192, v184, v185
    s_waitcnt lgkmcnt(0)
    v_mfma_f32_16x16x32_bf16 v[208:211], v[108:111], v[40:43], v[208:211]
    ds_read_b128 v[80:83], v248 offset:55296
    v_cvt_pk_bf16_f32 v194, v188, v189
    v_mfma_f32_16x16x32_bf16 v[212:215], v[108:111], v[44:47], v[212:215]
    ds_read_b128 v[84:87], v248 offset:56320
    v_cvt_pk_bf16_f32 v193, v186, v187
    v_mfma_f32_16x16x32_bf16 v[216:219], v[112:115], v[56:59], v[216:219]
    ds_read_b128 v[88:91], v248 offset:57344
    v_cvt_pk_bf16_f32 v195, v190, v191
    v_mfma_f32_16x16x32_bf16 v[220:223], v[112:115], v[60:63], v[220:223]
    ds_read_b128 v[92:95], v248 offset:58368
    v_permlane16_swap_b32 v192, v194
    v_mfma_f32_16x16x32_bf16 v[224:227], v[116:119], v[56:59], v[224:227]
    ds_read_b128 v[96:99], v248 offset:59392
    v_permlane16_swap_b32 v193, v195
    v_mfma_f32_16x16x32_bf16 v[228:231], v[116:119], v[60:63], v[228:231]
    ds_read_b128 v[100:103], v248 offset:60416
    buffer_store_dwordx4 v[192:195], v6, s[16:19], s36 offen offset:1536 sc1
    v_mfma_f32_16x16x32_bf16 v[216:219], v[120:123], v[64:67], v[216:219]
    ds_read_b128 v[104:107], v248 offset:61440
    v_max_f32 v200, 0, v200
    v_mfma_f32_16x16x32_bf16 v[220:223], v[120:123], v[68:71], v[220:223]
    v_max_f32 v201, 0, v201
    v_max_f32 v202, 0, v202
    v_mfma_f32_16x16x32_bf16 v[224:227], v[124:127], v[64:67], v[224:227]
    v_max_f32 v203, 0, v203
    v_max_f32 v204, 0, v204
    v_mfma_f32_16x16x32_bf16 v[228:231], v[124:127], v[68:71], v[228:231]
    v_max_f32 v205, 0, v205
    v_max_f32 v206, 0, v206
    v_mfma_f32_16x16x32_bf16 v[216:219], v[128:131], v[72:75], v[216:219]
    v_max_f32 v207, 0, v207
    v_mul_f32 v208, v208, v21
    v_mfma_f32_16x16x32_bf16 v[220:223], v[128:131], v[76:79], v[220:223]
    v_mul_f32 v209, v209, v21
    v_mul_f32 v210, v210, v21
    v_mfma_f32_16x16x32_bf16 v[224:227], v[132:135], v[72:75], v[224:227]
    v_mul_f32 v211, v211, v21
    v_mul_f32 v212, v212, v22
    v_mfma_f32_16x16x32_bf16 v[228:231], v[132:135], v[76:79], v[228:231]
    v_mul_f32 v213, v213, v22
    v_mul_f32 v214, v214, v22
    s_waitcnt lgkmcnt(0)
    v_mfma_f32_16x16x32_bf16 v[216:219], v[80:83], v[32:35], v[216:219]
    ds_read_b128 v[108:111], v248 offset:62464
    v_mul_f32 v215, v215, v22
    v_mfma_f32_16x16x32_bf16 v[220:223], v[80:83], v[36:39], v[220:223]
    ds_read_b128 v[112:115], v248 offset:63488
    v_mul_f32 v200, v200, v208
    v_mfma_f32_16x16x32_bf16 v[224:227], v[84:87], v[32:35], v[224:227]
    ds_read_b128 v[116:119], v248 offset:64512
    v_mul_f32 v201, v201, v209
    v_mfma_f32_16x16x32_bf16 v[228:231], v[84:87], v[36:39], v[228:231]
    ds_read_b128 v[120:123], v249 offset:0
    v_mul_f32 v202, v202, v210
    v_mfma_f32_16x16x32_bf16 v[216:219], v[88:91], v[40:43], v[216:219]
    ds_read_b128 v[124:127], v249 offset:1024
    v_mul_f32 v203, v203, v211
    v_mfma_f32_16x16x32_bf16 v[220:223], v[88:91], v[44:47], v[220:223]
    ds_read_b128 v[128:131], v249 offset:2048
    v_mul_f32 v204, v204, v212
    v_mfma_f32_16x16x32_bf16 v[224:227], v[92:95], v[40:43], v[224:227]
    ds_read_b128 v[132:135], v249 offset:3072
    v_mul_f32 v205, v205, v213
    v_mfma_f32_16x16x32_bf16 v[228:231], v[92:95], v[44:47], v[228:231]
    v_mul_f32 v206, v206, v214
    v_mul_f32 v207, v207, v215
    v_mfma_f32_16x16x32_bf16 v[232:235], v[96:99], v[56:59], v[232:235]
    v_cvt_pk_bf16_f32 v208, v200, v201
    v_cvt_pk_bf16_f32 v210, v204, v205
    v_mfma_f32_16x16x32_bf16 v[236:239], v[96:99], v[60:63], v[236:239]
    v_cvt_pk_bf16_f32 v209, v202, v203
    v_cvt_pk_bf16_f32 v211, v206, v207
    v_mfma_f32_16x16x32_bf16 v[240:243], v[100:103], v[56:59], v[240:243]
    v_permlane16_swap_b32 v208, v210
    v_permlane16_swap_b32 v209, v211
    v_mfma_f32_16x16x32_bf16 v[244:247], v[100:103], v[60:63], v[244:247]
    buffer_store_dwordx4 v[208:211], v6, s[16:19], s36 offen offset:2048 sc1
    v_mfma_f32_16x16x32_bf16 v[232:235], v[104:107], v[64:67], v[232:235]
    v_max_f32 v216, 0, v216
    v_max_f32 v217, 0, v217
    v_mfma_f32_16x16x32_bf16 v[236:239], v[104:107], v[68:71], v[236:239]
    v_max_f32 v218, 0, v218
    v_max_f32 v219, 0, v219
    s_waitcnt lgkmcnt(0)
    s_barrier
    v_mfma_f32_16x16x32_bf16 v[240:243], v[108:111], v[64:67], v[240:243]
    v_max_f32 v220, 0, v220
    v_max_f32 v221, 0, v221
    v_mfma_f32_16x16x32_bf16 v[244:247], v[108:111], v[68:71], v[244:247]
    v_max_f32 v222, 0, v222
    v_max_f32 v223, 0, v223
    v_mfma_f32_16x16x32_bf16 v[232:235], v[112:115], v[72:75], v[232:235]
    v_mul_f32 v224, v224, v21
    v_mul_f32 v225, v225, v21
    v_mfma_f32_16x16x32_bf16 v[236:239], v[112:115], v[76:79], v[236:239]
    v_mul_f32 v226, v226, v21
    v_mul_f32 v227, v227, v21
    s_waitcnt vmcnt(2)
    s_cmp_lg_u32 s86, 0
    s_cbranch_scc1 sequentia_s39
    s_mov_b64 exec, 1
    buffer_store_dwordx2 v[252:253], v9, s[16:19], s37 offen offset:1024
    s_mov_b64 exec, -1
sequentia_b40:
    v_mfma_f32_16x16x32_bf16 v[240:243], v[116:119], v[72:75], v[240:243]
    v_mul_f32 v228, v228, v22
    v_mul_f32 v229, v229, v22
    v_mfma_f32_16x16x32_bf16 v[244:247], v[116:119], v[76:79], v[244:247]
    v_mul_f32 v230, v230, v22
    v_mul_f32 v231, v231, v22
    v_mfma_f32_16x16x32_bf16 v[232:235], v[120:123], v[32:35], v[232:235]
    v_mul_f32 v216, v216, v224
    v_mul_f32 v217, v217, v225
    v_mfma_f32_16x16x32_bf16 v[236:239], v[120:123], v[36:39], v[236:239]
    v_mul_f32 v218, v218, v226
    v_mul_f32 v219, v219, v227
    v_mfma_f32_16x16x32_bf16 v[240:243], v[124:127], v[32:35], v[240:243]
    v_mul_f32 v220, v220, v228
    v_mul_f32 v221, v221, v229
    v_mfma_f32_16x16x32_bf16 v[244:247], v[124:127], v[36:39], v[244:247]
    v_mul_f32 v222, v222, v230
    v_mul_f32 v223, v223, v231
    v_mfma_f32_16x16x32_bf16 v[232:235], v[128:131], v[40:43], v[232:235]
    v_cvt_pk_bf16_f32 v224, v216, v217
    v_cvt_pk_bf16_f32 v226, v220, v221
    v_mfma_f32_16x16x32_bf16 v[236:239], v[128:131], v[44:47], v[236:239]
    v_cvt_pk_bf16_f32 v225, v218, v219
    v_cvt_pk_bf16_f32 v227, v222, v223
    v_mfma_f32_16x16x32_bf16 v[240:243], v[132:135], v[40:43], v[240:243]
    v_permlane16_swap_b32 v224, v226
    v_permlane16_swap_b32 v225, v227
    v_mfma_f32_16x16x32_bf16 v[244:247], v[132:135], v[44:47], v[244:247]
    buffer_store_dwordx4 v[224:227], v6, s[16:19], s36 offen offset:2560 sc1
    v_max_f32 v232, 0, v232
    v_max_f32 v233, 0, v233
    v_max_f32 v234, 0, v234
    v_max_f32 v235, 0, v235
    v_max_f32 v236, 0, v236
    v_max_f32 v237, 0, v237
    v_max_f32 v238, 0, v238
    v_max_f32 v239, 0, v239
    v_mul_f32 v240, v240, v21
    v_mul_f32 v241, v241, v21
    v_mul_f32 v242, v242, v21
    v_mul_f32 v243, v243, v21
    v_mul_f32 v244, v244, v22
    v_mul_f32 v245, v245, v22
    v_mul_f32 v246, v246, v22
    v_mul_f32 v247, v247, v22
    v_mul_f32 v232, v232, v240
    v_mul_f32 v233, v233, v241
    v_mul_f32 v234, v234, v242
    v_mul_f32 v235, v235, v243
    v_mul_f32 v236, v236, v244
    v_mul_f32 v237, v237, v245
    v_mul_f32 v238, v238, v246
    v_mul_f32 v239, v239, v247
    v_cvt_pk_bf16_f32 v240, v232, v233
    v_cvt_pk_bf16_f32 v242, v236, v237
    v_cvt_pk_bf16_f32 v241, v234, v235
    v_cvt_pk_bf16_f32 v243, v238, v239
    v_permlane16_swap_b32 v240, v242
    s_nop 0
    v_permlane16_swap_b32 v241, v243
    buffer_store_dwordx4 v[240:243], v6, s[16:19], s36 offen offset:3072 sc1
    s_lshr_b32 s30, s4, 3
    s_lshl_b32 s30, s30, 2
    s_add_u32 s30, s30, s3
    s_mul_i32 s31, s30, 55296
    s_add_u32 s31, s31, s25
    s_add_u32 s31, s31, 393216
    s_lshr_b32 s33, s30, 1
    s_lshl_b32 s33, s33, 7
    s_add_u32 s33, s33, s25
    s_add_u32 s33, s33, 362496
    v_lshlrev_b32 v20, 16, v10
    v_and_b32 v21, 0xffff0000, v10
    v_lshlrev_b32 v22, 16, v11
    v_and_b32 v23, 0xffff0000, v11
    v_lshlrev_b32 v24, 16, v12
    v_and_b32 v25, 0xffff0000, v12
    v_lshlrev_b32 v26, 16, v13
    v_and_b32 v27, 0xffff0000, v13
    v_lshlrev_b32 v28, 16, v14
    v_and_b32 v29, 0xffff0000, v14
    v_lshlrev_b32 v30, 16, v15
    v_and_b32 v31, 0xffff0000, v15
    v_lshlrev_b32 v32, 16, v16
    v_and_b32 v33, 0xffff0000, v16
    v_lshlrev_b32 v34, 16, v17
    v_and_b32 v35, 0xffff0000, v17
    v_lshlrev_b32 v36, 16, v18
    v_and_b32 v37, 0xffff0000, v18
    v_lshlrev_b32 v38, 16, v19
    v_and_b32 v39, 0xffff0000, v19
    ds_read_b128 v[104:107], v249 offset:4096
    ds_read_b128 v[108:111], v249 offset:5120
    ds_read_b128 v[112:115], v249 offset:6144
    ds_read_b128 v[116:119], v249 offset:7168
    ds_read_b128 v[120:123], v249 offset:8192
    ds_read_b128 v[124:127], v249 offset:9216
    ds_read_b128 v[128:131], v249 offset:10240
    ds_read_b128 v[132:135], v249 offset:11264
    ds_read_b128 v[136:139], v249 offset:12288
    ds_read_b128 v[140:143], v249 offset:13312
    s_mov_b32 s8, s78
    s_mov_b32 s9, s79
    s_mov_b32 s10, 2621440
    s_mov_b32 s11, 0x00020000
    s_lshl_b32 s34, s5, 4
    s_add_u32 s34, s34, s30
    s_mul_i32 s34, s34, 20480
    s_and_b32 s35, s4, 7
    s_mul_i32 s35, s35, 160
    s_add_u32 s34, s34, s35
    s_waitcnt vmcnt(0)
    s_cmp_lg_u32 s86, 0
    s_cbranch_scc1 sequentia_s41
    s_mov_b64 exec, 1
    buffer_store_dwordx2 v[252:253], v9, s[16:19], s37 offen
    s_mov_b64 exec, -1
sequentia_b42:
    s_barrier
    s_add_u32 s32, s31, 0
    buffer_load_dwordx4 v[40:43], v2, s[16:19], s32 offen offset:0 sc1
    s_add_u32 s32, s31, 4096
    buffer_load_dwordx4 v[44:47], v2, s[16:19], s32 offen offset:0 sc1
    buffer_load_dwordx4 v[48:51], v2, s[16:19], s32 offen offset:3072 sc1
    s_add_u32 s32, s31, 11264
    buffer_load_dwordx4 v[52:55], v2, s[16:19], s32 offen offset:0 sc1
    buffer_load_dwordx4 v[56:59], v2, s[16:19], s32 offen offset:3072 sc1
    s_add_u32 s32, s31, 18432
    buffer_load_dwordx4 v[60:63], v2, s[16:19], s32 offen offset:0 sc1
    buffer_load_dwordx4 v[64:67], v2, s[16:19], s32 offen offset:3072 sc1
    s_add_u32 s32, s31, 25600
    buffer_load_dwordx4 v[68:71], v2, s[16:19], s32 offen offset:0 sc1
    s_waitcnt vmcnt(7) lgkmcnt(5)
    v_mfma_f32_16x16x32_bf16 v[20:23], v[104:107], v[40:43], v[20:23]
    ds_read_b128 v[144:147], v249 offset:14336
    v_mfma_f32_16x16x32_bf16 v[24:27], v[108:111], v[40:43], v[24:27]
    ds_read_b128 v[148:151], v249 offset:15360
    v_mfma_f32_16x16x32_bf16 v[28:31], v[112:115], v[40:43], v[28:31]
    ds_read_b128 v[152:155], v249 offset:16384
    v_mfma_f32_16x16x32_bf16 v[32:35], v[116:119], v[40:43], v[32:35]
    ds_read_b128 v[156:159], v249 offset:17408
    v_mfma_f32_16x16x32_bf16 v[36:39], v[120:123], v[40:43], v[36:39]
    ds_read_b128 v[160:163], v249 offset:18432
    buffer_load_dwordx4 v[72:75], v2, s[16:19], s32 offen offset:3072 sc1
    s_add_u32 s32, s31, 32768
    buffer_load_dwordx4 v[76:79], v2, s[16:19], s32 offen offset:0 sc1
    s_waitcnt vmcnt(8) lgkmcnt(5)
    v_mfma_f32_16x16x32_bf16 v[20:23], v[124:127], v[44:47], v[20:23]
    ds_read_b128 v[104:107], v249 offset:19456
    v_mfma_f32_16x16x32_bf16 v[24:27], v[128:131], v[44:47], v[24:27]
    ds_read_b128 v[108:111], v249 offset:20480
    v_mfma_f32_16x16x32_bf16 v[28:31], v[132:135], v[44:47], v[28:31]
    ds_read_b128 v[112:115], v249 offset:21504
    v_mfma_f32_16x16x32_bf16 v[32:35], v[136:139], v[44:47], v[32:35]
    ds_read_b128 v[116:119], v249 offset:22528
    v_mfma_f32_16x16x32_bf16 v[36:39], v[140:143], v[44:47], v[36:39]
    ds_read_b128 v[120:123], v249 offset:23552
    buffer_load_dwordx4 v[80:83], v2, s[16:19], s32 offen offset:3072 sc1
    s_add_u32 s32, s31, 39936
    buffer_load_dwordx4 v[84:87], v2, s[16:19], s32 offen offset:0 sc1
    s_waitcnt vmcnt(9) lgkmcnt(5)
    v_mfma_f32_16x16x32_bf16 v[20:23], v[144:147], v[48:51], v[20:23]
    ds_read_b128 v[124:127], v249 offset:24576
    v_mfma_f32_16x16x32_bf16 v[24:27], v[148:151], v[48:51], v[24:27]
    ds_read_b128 v[128:131], v249 offset:25600
    v_mfma_f32_16x16x32_bf16 v[28:31], v[152:155], v[48:51], v[28:31]
    ds_read_b128 v[132:135], v249 offset:26624
    v_mfma_f32_16x16x32_bf16 v[32:35], v[156:159], v[48:51], v[32:35]
    ds_read_b128 v[136:139], v249 offset:27648
    v_mfma_f32_16x16x32_bf16 v[36:39], v[160:163], v[48:51], v[36:39]
    ds_read_b128 v[140:143], v249 offset:28672
    buffer_load_dwordx4 v[88:91], v2, s[16:19], s32 offen offset:3072 sc1
    s_waitcnt vmcnt(9) lgkmcnt(5)
    v_mfma_f32_16x16x32_bf16 v[20:23], v[104:107], v[52:55], v[20:23]
    ds_read_b128 v[144:147], v249 offset:29696
    v_mfma_f32_16x16x32_bf16 v[24:27], v[108:111], v[52:55], v[24:27]
    ds_read_b128 v[148:151], v249 offset:30720
pg_4:
    s_cbranch_execz pg_ret
    v_mfma_f32_16x16x32_bf16 v[28:31], v[112:115], v[52:55], v[28:31]
    ds_read_b128 v[152:155], v249 offset:31744
    v_mfma_f32_16x16x32_bf16 v[32:35], v[116:119], v[52:55], v[32:35]
    ds_read_b128 v[156:159], v249 offset:32768
    v_mfma_f32_16x16x32_bf16 v[36:39], v[120:123], v[52:55], v[36:39]
    ds_read_b128 v[160:163], v249 offset:33792
    s_add_u32 s32, s31, 47104
    buffer_load_dwordx4 v[92:95], v2, s[16:19], s32 offen offset:0 sc1
    s_waitcnt vmcnt(9) lgkmcnt(5)
    v_mfma_f32_16x16x32_bf16 v[20:23], v[124:127], v[56:59], v[20:23]
    ds_read_b128 v[104:107], v249 offset:34816
    v_mfma_f32_16x16x32_bf16 v[24:27], v[128:131], v[56:59], v[24:27]
    ds_read_b128 v[108:111], v249 offset:35840
    v_mfma_f32_16x16x32_bf16 v[28:31], v[132:135], v[56:59], v[28:31]
    ds_read_b128 v[112:115], v249 offset:36864
    v_mfma_f32_16x16x32_bf16 v[32:35], v[136:139], v[56:59], v[32:35]
    ds_read_b128 v[116:119], v249 offset:37888
    v_mfma_f32_16x16x32_bf16 v[36:39], v[140:143], v[56:59], v[36:39]
    ds_read_b128 v[120:123], v249 offset:38912
    buffer_load_dwordx4 v[96:99], v2, s[16:19], s32 offen offset:3072 sc1
    s_waitcnt vmcnt(9) lgkmcnt(5)
    v_mfma_f32_16x16x32_bf16 v[20:23], v[144:147], v[60:63], v[20:23]
    ds_read_b128 v[124:127], v249 offset:39936
    v_mfma_f32_16x16x32_bf16 v[24:27], v[148:151], v[60:63], v[24:27]
    ds_read_b128 v[128:131], v249 offset:40960
    v_mfma_f32_16x16x32_bf16 v[28:31], v[152:155], v[60:63], v[28:31]
    ds_read_b128 v[132:135], v249 offset:41984
    v_mfma_f32_16x16x32_bf16 v[32:35], v[156:159], v[60:63], v[32:35]
    ds_read_b128 v[136:139], v249 offset:43008
    v_mfma_f32_16x16x32_bf16 v[36:39], v[160:163], v[60:63], v[36:39]
    ds_read_b128 v[140:143], v249 offset:44032
    s_add_u32 s32, s31, 54272
    buffer_load_dwordx4 v[100:103], v2, s[16:19], s32 offen offset:0 sc1
    s_waitcnt vmcnt(9) lgkmcnt(5)
    s_barrier
    v_mfma_f32_16x16x32_bf16 v[20:23], v[104:107], v[64:67], v[20:23]
    ds_read_b128 v[144:147], v249 offset:45056
    v_mfma_f32_16x16x32_bf16 v[24:27], v[108:111], v[64:67], v[24:27]
    ds_read_b128 v[148:151], v249 offset:46080
    v_mfma_f32_16x16x32_bf16 v[28:31], v[112:115], v[64:67], v[28:31]
    ds_read_b128 v[152:155], v249 offset:47104
    v_mfma_f32_16x16x32_bf16 v[32:35], v[116:119], v[64:67], v[32:35]
    ds_read_b128 v[156:159], v249 offset:48128
    v_mfma_f32_16x16x32_bf16 v[36:39], v[120:123], v[64:67], v[36:39]
    ds_read_b128 v[160:163], v249 offset:49152
    s_add_u32 s32, s31, 1024
    buffer_load_dwordx4 v[40:43], v2, s[16:19], s32 offen offset:0 sc1
    s_waitcnt vmcnt(9) lgkmcnt(5)
    v_mfma_f32_16x16x32_bf16 v[20:23], v[124:127], v[68:71], v[20:23]
    ds_read_b128 v[104:107], v249 offset:50176
    v_mfma_f32_16x16x32_bf16 v[24:27], v[128:131], v[68:71], v[24:27]
    ds_read_b128 v[108:111], v249 offset:51200
    v_mfma_f32_16x16x32_bf16 v[28:31], v[132:135], v[68:71], v[28:31]
    ds_read_b128 v[112:115], v249 offset:52224
    v_mfma_f32_16x16x32_bf16 v[32:35], v[136:139], v[68:71], v[32:35]
    ds_read_b128 v[116:119], v249 offset:53248
    v_mfma_f32_16x16x32_bf16 v[36:39], v[140:143], v[68:71], v[36:39]
    ds_read_b128 v[120:123], v249 offset:54272
    buffer_load_dwordx4 v[44:47], v2, s[16:19], s32 offen offset:1024 sc1
    s_waitcnt vmcnt(9) lgkmcnt(5)
    v_mfma_f32_16x16x32_bf16 v[20:23], v[144:147], v[72:75], v[20:23]
    ds_read_b128 v[124:127], v249 offset:55296
    v_mfma_f32_16x16x32_bf16 v[24:27], v[148:151], v[72:75], v[24:27]
    ds_read_b128 v[128:131], v249 offset:56320
    v_mfma_f32_16x16x32_bf16 v[28:31], v[152:155], v[72:75], v[28:31]
    ds_read_b128 v[132:135], v249 offset:57344
    v_mfma_f32_16x16x32_bf16 v[32:35], v[156:159], v[72:75], v[32:35]
    ds_read_b128 v[136:139], v249 offset:58368
    v_mfma_f32_16x16x32_bf16 v[36:39], v[160:163], v[72:75], v[36:39]
    ds_read_b128 v[140:143], v249 offset:59392
    buffer_load_dwordx4 v[48:51], v2, s[16:19], s32 offen offset:2048 sc1
    s_waitcnt vmcnt(9) lgkmcnt(5)
    v_mfma_f32_16x16x32_bf16 v[20:23], v[104:107], v[76:79], v[20:23]
    ds_read_b128 v[144:147], v249 offset:60416
    v_mfma_f32_16x16x32_bf16 v[24:27], v[108:111], v[76:79], v[24:27]
    ds_read_b128 v[148:151], v249 offset:61440
    v_mfma_f32_16x16x32_bf16 v[28:31], v[112:115], v[76:79], v[28:31]
    ds_read_b128 v[152:155], v249 offset:62464
    v_mfma_f32_16x16x32_bf16 v[32:35], v[116:119], v[76:79], v[32:35]
    ds_read_b128 v[156:159], v249 offset:63488
    v_mfma_f32_16x16x32_bf16 v[36:39], v[120:123], v[76:79], v[36:39]
    ds_read_b128 v[160:163], v249 offset:64512
    s_add_u32 s32, s31, 5120
    buffer_load_dwordx4 v[52:55], v2, s[16:19], s32 offen offset:0 sc1
    s_waitcnt vmcnt(9) lgkmcnt(5)
    s_barrier
    v_mfma_f32_16x16x32_bf16 v[20:23], v[124:127], v[80:83], v[20:23]
    ds_read_b128 v[104:107], v250 offset:0
    v_mfma_f32_16x16x32_bf16 v[24:27], v[128:131], v[80:83], v[24:27]
    ds_read_b128 v[108:111], v250 offset:1024
    v_mfma_f32_16x16x32_bf16 v[28:31], v[132:135], v[80:83], v[28:31]
    ds_read_b128 v[112:115], v250 offset:2048
    v_mfma_f32_16x16x32_bf16 v[32:35], v[136:139], v[80:83], v[32:35]
    ds_read_b128 v[116:119], v250 offset:3072
    v_mfma_f32_16x16x32_bf16 v[36:39], v[140:143], v[80:83], v[36:39]
    ds_read_b128 v[120:123], v250 offset:4096
    buffer_load_dwordx4 v[56:59], v2, s[16:19], s32 offen offset:1024 sc1
    s_waitcnt vmcnt(9) lgkmcnt(5)
    v_mfma_f32_16x16x32_bf16 v[20:23], v[144:147], v[84:87], v[20:23]
    ds_read_b128 v[124:127], v250 offset:5120
    v_mfma_f32_16x16x32_bf16 v[24:27], v[148:151], v[84:87], v[24:27]
    ds_read_b128 v[128:131], v250 offset:6144
    v_mfma_f32_16x16x32_bf16 v[28:31], v[152:155], v[84:87], v[28:31]
    ds_read_b128 v[132:135], v250 offset:7168
    v_mfma_f32_16x16x32_bf16 v[32:35], v[156:159], v[84:87], v[32:35]
    ds_read_b128 v[136:139], v250 offset:8192
    v_mfma_f32_16x16x32_bf16 v[36:39], v[160:163], v[84:87], v[36:39]
    ds_read_b128 v[140:143], v250 offset:9216
    buffer_load_dwordx4 v[60:63], v2, s[16:19], s32 offen offset:3072 sc1
    s_waitcnt vmcnt(9) lgkmcnt(5)
    v_mfma_f32_16x16x32_bf16 v[20:23], v[104:107], v[88:91], v[20:23]
    ds_read_b128 v[144:147], v250 offset:10240
    v_mfma_f32_16x16x32_bf16 v[24:27], v[108:111], v[88:91], v[24:27]
    ds_read_b128 v[148:151], v250 offset:11264
    v_mfma_f32_16x16x32_bf16 v[28:31], v[112:115], v[88:91], v[28:31]
    ds_read_b128 v[152:155], v250 offset:12288
    v_mfma_f32_16x16x32_bf16 v[32:35], v[116:119], v[88:91], v[32:35]
    ds_read_b128 v[156:159], v250 offset:13312
    v_mfma_f32_16x16x32_bf16 v[36:39], v[120:123], v[88:91], v[36:39]
    ds_read_b128 v[160:163], v250 offset:14336
    s_add_u32 s32, s31, 9216
    buffer_load_dwordx4 v[64:67], v2, s[16:19], s32 offen offset:0 sc1
    s_waitcnt vmcnt(9) lgkmcnt(5)
    v_mfma_f32_16x16x32_bf16 v[20:23], v[124:127], v[92:95], v[20:23]
    ds_read_b128 v[104:107], v250 offset:15360
    v_mfma_f32_16x16x32_bf16 v[24:27], v[128:131], v[92:95], v[24:27]
    ds_read_b128 v[108:111], v250 offset:16384
    v_mfma_f32_16x16x32_bf16 v[28:31], v[132:135], v[92:95], v[28:31]
    ds_read_b128 v[112:115], v250 offset:17408
    v_mfma_f32_16x16x32_bf16 v[32:35], v[136:139], v[92:95], v[32:35]
    ds_read_b128 v[116:119], v250 offset:18432
    v_mfma_f32_16x16x32_bf16 v[36:39], v[140:143], v[92:95], v[36:39]
    ds_read_b128 v[120:123], v250 offset:19456
    buffer_load_dwordx4 v[68:71], v2, s[16:19], s32 offen offset:1024 sc1
    s_waitcnt vmcnt(9) lgkmcnt(5)
    s_barrier
    v_mfma_f32_16x16x32_bf16 v[20:23], v[144:147], v[96:99], v[20:23]
    ds_read_b128 v[124:127], v250 offset:20480
    v_mfma_f32_16x16x32_bf16 v[24:27], v[148:151], v[96:99], v[24:27]
    ds_read_b128 v[128:131], v250 offset:21504
    v_mfma_f32_16x16x32_bf16 v[28:31], v[152:155], v[96:99], v[28:31]
    ds_read_b128 v[132:135], v250 offset:22528
    v_mfma_f32_16x16x32_bf16 v[32:35], v[156:159], v[96:99], v[32:35]
    ds_read_b128 v[136:139], v250 offset:23552
    v_mfma_f32_16x16x32_bf16 v[36:39], v[160:163], v[96:99], v[36:39]
    ds_read_b128 v[140:143], v250 offset:24576
    buffer_load_dwordx4 v[72:75], v2, s[16:19], s32 offen offset:3072 sc1
    s_waitcnt vmcnt(9) lgkmcnt(5)
    v_mfma_f32_16x16x32_bf16 v[20:23], v[104:107], v[100:103], v[20:23]
    ds_read_b128 v[144:147], v250 offset:25600
    v_mfma_f32_16x16x32_bf16 v[24:27], v[108:111], v[100:103], v[24:27]
    ds_read_b128 v[148:151], v250 offset:26624
    v_mfma_f32_16x16x32_bf16 v[28:31], v[112:115], v[100:103], v[28:31]
    ds_read_b128 v[152:155], v250 offset:27648
    v_mfma_f32_16x16x32_bf16 v[32:35], v[116:119], v[100:103], v[32:35]
    ds_read_b128 v[156:159], v248 offset:0
    v_mfma_f32_16x16x32_bf16 v[36:39], v[120:123], v[100:103], v[36:39]
    ds_read_b128 v[160:163], v248 offset:1024
    s_add_u32 s32, s31, 13312
    buffer_load_dwordx4 v[76:79], v2, s[16:19], s32 offen offset:0 sc1
    s_waitcnt vmcnt(9) lgkmcnt(5)
    v_mfma_f32_16x16x32_bf16 v[20:23], v[124:127], v[40:43], v[20:23]
    ds_read_b128 v[104:107], v248 offset:2048
    v_mfma_f32_16x16x32_bf16 v[24:27], v[128:131], v[40:43], v[24:27]
    ds_read_b128 v[108:111], v248 offset:3072
    v_mfma_f32_16x16x32_bf16 v[28:31], v[132:135], v[40:43], v[28:31]
    ds_read_b128 v[112:115], v248 offset:4096
    v_mfma_f32_16x16x32_bf16 v[32:35], v[136:139], v[40:43], v[32:35]
    ds_read_b128 v[116:119], v248 offset:5120
    v_mfma_f32_16x16x32_bf16 v[36:39], v[140:143], v[40:43], v[36:39]
    ds_read_b128 v[120:123], v248 offset:6144
    buffer_load_dwordx4 v[80:83], v2, s[16:19], s32 offen offset:2048 sc1
    s_waitcnt vmcnt(9) lgkmcnt(5)
    v_mfma_f32_16x16x32_bf16 v[20:23], v[144:147], v[44:47], v[20:23]
    ds_read_b128 v[124:127], v248 offset:7168
    v_mfma_f32_16x16x32_bf16 v[24:27], v[148:151], v[44:47], v[24:27]
    ds_read_b128 v[128:131], v248 offset:8192
    v_mfma_f32_16x16x32_bf16 v[28:31], v[152:155], v[44:47], v[28:31]
    ds_read_b128 v[132:135], v248 offset:9216
    v_mfma_f32_16x16x32_bf16 v[32:35], v[156:159], v[44:47], v[32:35]
    ds_read_b128 v[136:139], v248 offset:10240
    v_mfma_f32_16x16x32_bf16 v[36:39], v[160:163], v[44:47], v[36:39]
    ds_read_b128 v[140:143], v248 offset:11264
    buffer_load_dwordx4 v[84:87], v2, s[16:19], s32 offen offset:3072 sc1
    s_waitcnt vmcnt(9) lgkmcnt(5)
    s_barrier
    v_mfma_f32_16x16x32_bf16 v[20:23], v[104:107], v[48:51], v[20:23]
    ds_read_b128 v[144:147], v248 offset:12288
    v_mfma_f32_16x16x32_bf16 v[24:27], v[108:111], v[48:51], v[24:27]
    ds_read_b128 v[148:151], v248 offset:13312
    v_mfma_f32_16x16x32_bf16 v[28:31], v[112:115], v[48:51], v[28:31]
    ds_read_b128 v[152:155], v248 offset:14336
    v_mfma_f32_16x16x32_bf16 v[32:35], v[116:119], v[48:51], v[32:35]
    ds_read_b128 v[156:159], v248 offset:15360
    v_mfma_f32_16x16x32_bf16 v[36:39], v[120:123], v[48:51], v[36:39]
    ds_read_b128 v[160:163], v248 offset:16384
    s_add_u32 s32, s31, 17408
    buffer_load_dwordx4 v[88:91], v2, s[16:19], s32 offen offset:0 sc1
    s_waitcnt vmcnt(9) lgkmcnt(5)
    v_mfma_f32_16x16x32_bf16 v[20:23], v[124:127], v[52:55], v[20:23]
    ds_read_b128 v[104:107], v248 offset:17408
    v_mfma_f32_16x16x32_bf16 v[24:27], v[128:131], v[52:55], v[24:27]
    ds_read_b128 v[108:111], v248 offset:18432
    v_mfma_f32_16x16x32_bf16 v[28:31], v[132:135], v[52:55], v[28:31]
    ds_read_b128 v[112:115], v248 offset:19456
    v_mfma_f32_16x16x32_bf16 v[32:35], v[136:139], v[52:55], v[32:35]
    ds_read_b128 v[116:119], v248 offset:20480
    v_mfma_f32_16x16x32_bf16 v[36:39], v[140:143], v[52:55], v[36:39]
    ds_read_b128 v[120:123], v248 offset:21504
    buffer_load_dwordx4 v[92:95], v2, s[16:19], s32 offen offset:2048 sc1
    s_waitcnt vmcnt(9) lgkmcnt(5)
    v_mfma_f32_16x16x32_bf16 v[20:23], v[144:147], v[56:59], v[20:23]
    ds_read_b128 v[124:127], v248 offset:22528
    v_mfma_f32_16x16x32_bf16 v[24:27], v[148:151], v[56:59], v[24:27]
    ds_read_b128 v[128:131], v248 offset:23552
    v_mfma_f32_16x16x32_bf16 v[28:31], v[152:155], v[56:59], v[28:31]
    ds_read_b128 v[132:135], v248 offset:24576
    v_mfma_f32_16x16x32_bf16 v[32:35], v[156:159], v[56:59], v[32:35]
    ds_read_b128 v[136:139], v248 offset:25600
    v_mfma_f32_16x16x32_bf16 v[36:39], v[160:163], v[56:59], v[36:39]
    ds_read_b128 v[140:143], v248 offset:26624
    buffer_load_dwordx4 v[96:99], v2, s[16:19], s32 offen offset:3072 sc1
    s_waitcnt vmcnt(9) lgkmcnt(5)
    v_mfma_f32_16x16x32_bf16 v[20:23], v[104:107], v[60:63], v[20:23]
    ds_read_b128 v[144:147], v248 offset:27648
    v_mfma_f32_16x16x32_bf16 v[24:27], v[108:111], v[60:63], v[24:27]
    ds_read_b128 v[148:151], v248 offset:28672
    v_mfma_f32_16x16x32_bf16 v[28:31], v[112:115], v[60:63], v[28:31]
    ds_read_b128 v[152:155], v248 offset:29696
    v_mfma_f32_16x16x32_bf16 v[32:35], v[116:119], v[60:63], v[32:35]
    ds_read_b128 v[156:159], v248 offset:30720
    v_mfma_f32_16x16x32_bf16 v[36:39], v[120:123], v[60:63], v[36:39]
    ds_read_b128 v[160:163], v248 offset:31744
    s_add_u32 s32, s31, 22528
    buffer_load_dwordx4 v[100:103], v2, s[16:19], s32 offen offset:0 sc1
    s_waitcnt vmcnt(9) lgkmcnt(5)
    s_barrier
    v_mfma_f32_16x16x32_bf16 v[20:23], v[124:127], v[64:67], v[20:23]
    ds_read_b128 v[104:107], v248 offset:32768
    v_mfma_f32_16x16x32_bf16 v[24:27], v[128:131], v[64:67], v[24:27]
    ds_read_b128 v[108:111], v248 offset:33792
    v_mfma_f32_16x16x32_bf16 v[28:31], v[132:135], v[64:67], v[28:31]
    ds_read_b128 v[112:115], v248 offset:34816
    v_mfma_f32_16x16x32_bf16 v[32:35], v[136:139], v[64:67], v[32:35]
    ds_read_b128 v[116:119], v248 offset:35840
    v_mfma_f32_16x16x32_bf16 v[36:39], v[140:143], v[64:67], v[36:39]
    ds_read_b128 v[120:123], v248 offset:36864
    buffer_load_dwordx4 v[40:43], v2, s[16:19], s32 offen offset:1024 sc1
    s_waitcnt vmcnt(9) lgkmcnt(5)
    v_mfma_f32_16x16x32_bf16 v[20:23], v[144:147], v[68:71], v[20:23]
    ds_read_b128 v[124:127], v248 offset:37888
    v_mfma_f32_16x16x32_bf16 v[24:27], v[148:151], v[68:71], v[24:27]
    ds_read_b128 v[128:131], v248 offset:38912
    v_mfma_f32_16x16x32_bf16 v[28:31], v[152:155], v[68:71], v[28:31]
    ds_read_b128 v[132:135], v248 offset:39936
    v_mfma_f32_16x16x32_bf16 v[32:35], v[156:159], v[68:71], v[32:35]
    ds_read_b128 v[136:139], v248 offset:40960
    v_mfma_f32_16x16x32_bf16 v[36:39], v[160:163], v[68:71], v[36:39]
    ds_read_b128 v[140:143], v248 offset:41984
    buffer_load_dwordx4 v[44:47], v2, s[16:19], s32 offen offset:2048 sc1
    s_waitcnt vmcnt(9) lgkmcnt(5)
    v_mfma_f32_16x16x32_bf16 v[20:23], v[104:107], v[72:75], v[20:23]
    ds_read_b128 v[144:147], v248 offset:43008
    v_mfma_f32_16x16x32_bf16 v[24:27], v[108:111], v[72:75], v[24:27]
    ds_read_b128 v[148:151], v248 offset:44032
    v_mfma_f32_16x16x32_bf16 v[28:31], v[112:115], v[72:75], v[28:31]
    ds_read_b128 v[152:155], v248 offset:45056
    v_mfma_f32_16x16x32_bf16 v[32:35], v[116:119], v[72:75], v[32:35]
    ds_read_b128 v[156:159], v248 offset:46080
    v_mfma_f32_16x16x32_bf16 v[36:39], v[120:123], v[72:75], v[36:39]
    ds_read_b128 v[160:163], v248 offset:47104
    s_add_u32 s32, s31, 26624
    buffer_load_dwordx4 v[48:51], v2, s[16:19], s32 offen offset:0 sc1
    s_waitcnt vmcnt(9) lgkmcnt(5)
    v_mfma_f32_16x16x32_bf16 v[20:23], v[124:127], v[76:79], v[20:23]
    ds_read_b128 v[104:107], v248 offset:48128
    v_mfma_f32_16x16x32_bf16 v[24:27], v[128:131], v[76:79], v[24:27]
    ds_read_b128 v[108:111], v248 offset:49152
    v_mfma_f32_16x16x32_bf16 v[28:31], v[132:135], v[76:79], v[28:31]
    ds_read_b128 v[112:115], v248 offset:50176
    v_mfma_f32_16x16x32_bf16 v[32:35], v[136:139], v[76:79], v[32:35]
    ds_read_b128 v[116:119], v248 offset:51200
    v_mfma_f32_16x16x32_bf16 v[36:39], v[140:143], v[76:79], v[36:39]
    ds_read_b128 v[120:123], v248 offset:52224
    buffer_load_dwordx4 v[52:55], v2, s[16:19], s32 offen offset:1024 sc1
    s_waitcnt vmcnt(9) lgkmcnt(5)
    s_barrier
    v_mfma_f32_16x16x32_bf16 v[20:23], v[144:147], v[80:83], v[20:23]
    ds_read_b128 v[124:127], v248 offset:53248
    v_mfma_f32_16x16x32_bf16 v[24:27], v[148:151], v[80:83], v[24:27]
    ds_read_b128 v[128:131], v248 offset:54272
    v_mfma_f32_16x16x32_bf16 v[28:31], v[152:155], v[80:83], v[28:31]
    ds_read_b128 v[132:135], v248 offset:55296
    v_mfma_f32_16x16x32_bf16 v[32:35], v[156:159], v[80:83], v[32:35]
    ds_read_b128 v[136:139], v248 offset:56320
    v_mfma_f32_16x16x32_bf16 v[36:39], v[160:163], v[80:83], v[36:39]
    ds_read_b128 v[140:143], v248 offset:57344
    buffer_load_dwordx4 v[56:59], v2, s[16:19], s32 offen offset:3072 sc1
    s_waitcnt vmcnt(9) lgkmcnt(5)
    v_mfma_f32_16x16x32_bf16 v[20:23], v[104:107], v[84:87], v[20:23]
    ds_read_b128 v[144:147], v248 offset:58368
    v_mfma_f32_16x16x32_bf16 v[24:27], v[108:111], v[84:87], v[24:27]
    ds_read_b128 v[148:151], v248 offset:59392
    v_mfma_f32_16x16x32_bf16 v[28:31], v[112:115], v[84:87], v[28:31]
    ds_read_b128 v[152:155], v248 offset:60416
    v_mfma_f32_16x16x32_bf16 v[32:35], v[116:119], v[84:87], v[32:35]
    ds_read_b128 v[156:159], v248 offset:61440
    v_mfma_f32_16x16x32_bf16 v[36:39], v[120:123], v[84:87], v[36:39]
    ds_read_b128 v[160:163], v248 offset:62464
    s_add_u32 s32, s31, 30720
    buffer_load_dwordx4 v[60:63], v2, s[16:19], s32 offen offset:0 sc1
    s_waitcnt vmcnt(9) lgkmcnt(5)
    v_mfma_f32_16x16x32_bf16 v[20:23], v[124:127], v[88:91], v[20:23]
    ds_read_b128 v[104:107], v248 offset:63488
    v_mfma_f32_16x16x32_bf16 v[24:27], v[128:131], v[88:91], v[24:27]
    ds_read_b128 v[108:111], v248 offset:64512
    v_mfma_f32_16x16x32_bf16 v[28:31], v[132:135], v[88:91], v[28:31]
    ds_read_b128 v[112:115], v249 offset:0
    v_mfma_f32_16x16x32_bf16 v[32:35], v[136:139], v[88:91], v[32:35]
    ds_read_b128 v[116:119], v249 offset:1024
    v_mfma_f32_16x16x32_bf16 v[36:39], v[140:143], v[88:91], v[36:39]
    ds_read_b128 v[120:123], v249 offset:2048
    buffer_load_dwordx4 v[64:67], v2, s[16:19], s32 offen offset:1024 sc1
    s_waitcnt vmcnt(9) lgkmcnt(5)
    v_mfma_f32_16x16x32_bf16 v[20:23], v[144:147], v[92:95], v[20:23]
    ds_read_b128 v[124:127], v249 offset:3072
    v_mfma_f32_16x16x32_bf16 v[24:27], v[148:151], v[92:95], v[24:27]
    ds_read_b128 v[128:131], v249 offset:4096
    v_mfma_f32_16x16x32_bf16 v[28:31], v[152:155], v[92:95], v[28:31]
    ds_read_b128 v[132:135], v249 offset:5120
    v_mfma_f32_16x16x32_bf16 v[32:35], v[156:159], v[92:95], v[32:35]
    ds_read_b128 v[136:139], v249 offset:6144
    v_mfma_f32_16x16x32_bf16 v[36:39], v[160:163], v[92:95], v[36:39]
    ds_read_b128 v[140:143], v249 offset:7168
    buffer_load_dwordx4 v[68:71], v2, s[16:19], s32 offen offset:3072 sc1
    s_waitcnt vmcnt(9) lgkmcnt(5)
    s_barrier
    v_mfma_f32_16x16x32_bf16 v[20:23], v[104:107], v[96:99], v[20:23]
    ds_read_b128 v[144:147], v249 offset:8192
    v_mfma_f32_16x16x32_bf16 v[24:27], v[108:111], v[96:99], v[24:27]
    ds_read_b128 v[148:151], v249 offset:9216
    v_mfma_f32_16x16x32_bf16 v[28:31], v[112:115], v[96:99], v[28:31]
    ds_read_b128 v[152:155], v249 offset:10240
    v_mfma_f32_16x16x32_bf16 v[32:35], v[116:119], v[96:99], v[32:35]
    ds_read_b128 v[156:159], v249 offset:11264
    v_mfma_f32_16x16x32_bf16 v[36:39], v[120:123], v[96:99], v[36:39]
    ds_read_b128 v[160:163], v249 offset:12288
    s_add_u32 s32, s31, 34816
    buffer_load_dwordx4 v[72:75], v2, s[16:19], s32 offen offset:0 sc1
    s_waitcnt vmcnt(9) lgkmcnt(5)
    v_mfma_f32_16x16x32_bf16 v[20:23], v[124:127], v[100:103], v[20:23]
    ds_read_b128 v[104:107], v249 offset:13312
    v_mfma_f32_16x16x32_bf16 v[24:27], v[128:131], v[100:103], v[24:27]
    ds_read_b128 v[108:111], v249 offset:14336
    v_mfma_f32_16x16x32_bf16 v[28:31], v[132:135], v[100:103], v[28:31]
    ds_read_b128 v[112:115], v249 offset:15360
    v_mfma_f32_16x16x32_bf16 v[32:35], v[136:139], v[100:103], v[32:35]
    ds_read_b128 v[116:119], v249 offset:16384
    v_mfma_f32_16x16x32_bf16 v[36:39], v[140:143], v[100:103], v[36:39]
    ds_read_b128 v[120:123], v249 offset:17408
    buffer_load_dwordx4 v[76:79], v2, s[16:19], s32 offen offset:2048 sc1
    s_waitcnt vmcnt(9) lgkmcnt(5)
    v_mfma_f32_16x16x32_bf16 v[20:23], v[144:147], v[40:43], v[20:23]
    ds_read_b128 v[124:127], v249 offset:18432
    v_mfma_f32_16x16x32_bf16 v[24:27], v[148:151], v[40:43], v[24:27]
    ds_read_b128 v[128:131], v249 offset:19456
    v_mfma_f32_16x16x32_bf16 v[28:31], v[152:155], v[40:43], v[28:31]
    ds_read_b128 v[132:135], v249 offset:20480
    v_mfma_f32_16x16x32_bf16 v[32:35], v[156:159], v[40:43], v[32:35]
    ds_read_b128 v[136:139], v249 offset:21504
    v_mfma_f32_16x16x32_bf16 v[36:39], v[160:163], v[40:43], v[36:39]
    ds_read_b128 v[140:143], v249 offset:22528
    buffer_load_dwordx4 v[80:83], v2, s[16:19], s32 offen offset:3072 sc1
    s_waitcnt vmcnt(9) lgkmcnt(5)
    v_mfma_f32_16x16x32_bf16 v[20:23], v[104:107], v[44:47], v[20:23]
    ds_read_b128 v[144:147], v249 offset:23552
    v_mfma_f32_16x16x32_bf16 v[24:27], v[108:111], v[44:47], v[24:27]
    ds_read_b128 v[148:151], v249 offset:24576
    v_mfma_f32_16x16x32_bf16 v[28:31], v[112:115], v[44:47], v[28:31]
    ds_read_b128 v[152:155], v249 offset:25600
    v_mfma_f32_16x16x32_bf16 v[32:35], v[116:119], v[44:47], v[32:35]
    ds_read_b128 v[156:159], v249 offset:26624
    v_mfma_f32_16x16x32_bf16 v[36:39], v[120:123], v[44:47], v[36:39]
    ds_read_b128 v[160:163], v249 offset:27648
    s_add_u32 s32, s31, 38912
    buffer_load_dwordx4 v[84:87], v2, s[16:19], s32 offen offset:0 sc1
    s_waitcnt vmcnt(9) lgkmcnt(5)
    s_barrier
    v_mfma_f32_16x16x32_bf16 v[20:23], v[124:127], v[48:51], v[20:23]
    ds_read_b128 v[104:107], v249 offset:28672
    v_mfma_f32_16x16x32_bf16 v[24:27], v[128:131], v[48:51], v[24:27]
    ds_read_b128 v[108:111], v249 offset:29696
    v_mfma_f32_16x16x32_bf16 v[28:31], v[132:135], v[48:51], v[28:31]
    ds_read_b128 v[112:115], v249 offset:30720
    v_mfma_f32_16x16x32_bf16 v[32:35], v[136:139], v[48:51], v[32:35]
    ds_read_b128 v[116:119], v249 offset:31744
    v_mfma_f32_16x16x32_bf16 v[36:39], v[140:143], v[48:51], v[36:39]
    ds_read_b128 v[120:123], v249 offset:32768
    buffer_load_dwordx4 v[88:91], v2, s[16:19], s32 offen offset:2048 sc1
    s_waitcnt vmcnt(9) lgkmcnt(5)
    v_mfma_f32_16x16x32_bf16 v[20:23], v[144:147], v[52:55], v[20:23]
    ds_read_b128 v[124:127], v249 offset:33792
    v_mfma_f32_16x16x32_bf16 v[24:27], v[148:151], v[52:55], v[24:27]
    ds_read_b128 v[128:131], v249 offset:34816
    v_mfma_f32_16x16x32_bf16 v[28:31], v[152:155], v[52:55], v[28:31]
    ds_read_b128 v[132:135], v249 offset:35840
    v_mfma_f32_16x16x32_bf16 v[32:35], v[156:159], v[52:55], v[32:35]
    ds_read_b128 v[136:139], v249 offset:36864
    v_mfma_f32_16x16x32_bf16 v[36:39], v[160:163], v[52:55], v[36:39]
    ds_read_b128 v[140:143], v249 offset:37888
    buffer_load_dwordx4 v[92:95], v2, s[16:19], s32 offen offset:3072 sc1
    s_waitcnt vmcnt(9) lgkmcnt(5)
    v_mfma_f32_16x16x32_bf16 v[20:23], v[104:107], v[56:59], v[20:23]
    ds_read_b128 v[144:147], v249 offset:38912
    v_mfma_f32_16x16x32_bf16 v[24:27], v[108:111], v[56:59], v[24:27]
    ds_read_b128 v[148:151], v249 offset:39936
    v_mfma_f32_16x16x32_bf16 v[28:31], v[112:115], v[56:59], v[28:31]
    ds_read_b128 v[152:155], v249 offset:40960
    v_mfma_f32_16x16x32_bf16 v[32:35], v[116:119], v[56:59], v[32:35]
    ds_read_b128 v[156:159], v249 offset:41984
    v_mfma_f32_16x16x32_bf16 v[36:39], v[120:123], v[56:59], v[36:39]
    ds_read_b128 v[160:163], v249 offset:43008
    s_add_u32 s32, s31, 44032
    buffer_load_dwordx4 v[96:99], v2, s[16:19], s32 offen offset:0 sc1
    s_waitcnt vmcnt(9) lgkmcnt(5)
    v_mfma_f32_16x16x32_bf16 v[20:23], v[124:127], v[60:63], v[20:23]
    ds_read_b128 v[104:107], v249 offset:44032
    v_mfma_f32_16x16x32_bf16 v[24:27], v[128:131], v[60:63], v[24:27]
    ds_read_b128 v[108:111], v249 offset:45056
    v_mfma_f32_16x16x32_bf16 v[28:31], v[132:135], v[60:63], v[28:31]
    ds_read_b128 v[112:115], v249 offset:46080
    v_mfma_f32_16x16x32_bf16 v[32:35], v[136:139], v[60:63], v[32:35]
    ds_read_b128 v[116:119], v249 offset:47104
    v_mfma_f32_16x16x32_bf16 v[36:39], v[140:143], v[60:63], v[36:39]
    ds_read_b128 v[120:123], v249 offset:48128
    buffer_load_dwordx4 v[100:103], v2, s[16:19], s32 offen offset:1024 sc1
    s_waitcnt vmcnt(9) lgkmcnt(5)
    s_barrier
    v_mfma_f32_16x16x32_bf16 v[20:23], v[144:147], v[64:67], v[20:23]
    ds_read_b128 v[124:127], v249 offset:49152
    v_mfma_f32_16x16x32_bf16 v[24:27], v[148:151], v[64:67], v[24:27]
    ds_read_b128 v[128:131], v249 offset:50176
    v_mfma_f32_16x16x32_bf16 v[28:31], v[152:155], v[64:67], v[28:31]
    ds_read_b128 v[132:135], v249 offset:51200
    v_mfma_f32_16x16x32_bf16 v[32:35], v[156:159], v[64:67], v[32:35]
    ds_read_b128 v[136:139], v249 offset:52224
    v_mfma_f32_16x16x32_bf16 v[36:39], v[160:163], v[64:67], v[36:39]
    ds_read_b128 v[140:143], v249 offset:53248
    buffer_load_dwordx4 v[40:43], v2, s[16:19], s32 offen offset:2048 sc1
    s_waitcnt vmcnt(9) lgkmcnt(5)
    v_mfma_f32_16x16x32_bf16 v[20:23], v[104:107], v[68:71], v[20:23]
    ds_read_b128 v[144:147], v249 offset:54272
    v_mfma_f32_16x16x32_bf16 v[24:27], v[108:111], v[68:71], v[24:27]
    ds_read_b128 v[148:151], v249 offset:55296
    v_mfma_f32_16x16x32_bf16 v[28:31], v[112:115], v[68:71], v[28:31]
    ds_read_b128 v[152:155], v249 offset:56320
    v_mfma_f32_16x16x32_bf16 v[32:35], v[116:119], v[68:71], v[32:35]
    ds_read_b128 v[156:159], v249 offset:57344
    v_mfma_f32_16x16x32_bf16 v[36:39], v[120:123], v[68:71], v[36:39]
    ds_read_b128 v[160:163], v249 offset:58368
    s_add_u32 s32, s31, 48128
    buffer_load_dwordx4 v[44:47], v2, s[16:19], s32 offen offset:0 sc1
    s_waitcnt vmcnt(9) lgkmcnt(5)
    v_mfma_f32_16x16x32_bf16 v[20:23], v[124:127], v[72:75], v[20:23]
    ds_read_b128 v[104:107], v249 offset:59392
    v_mfma_f32_16x16x32_bf16 v[24:27], v[128:131], v[72:75], v[24:27]
    ds_read_b128 v[108:111], v249 offset:60416
    v_mfma_f32_16x16x32_bf16 v[28:31], v[132:135], v[72:75], v[28:31]
    ds_read_b128 v[112:115], v249 offset:61440
    v_mfma_f32_16x16x32_bf16 v[32:35], v[136:139], v[72:75], v[32:35]
    ds_read_b128 v[116:119], v249 offset:62464
    v_mfma_f32_16x16x32_bf16 v[36:39], v[140:143], v[72:75], v[36:39]
    ds_read_b128 v[120:123], v249 offset:63488
    buffer_load_dwordx4 v[48:51], v2, s[16:19], s32 offen offset:1024 sc1
    s_waitcnt vmcnt(9) lgkmcnt(5)
    v_mfma_f32_16x16x32_bf16 v[20:23], v[144:147], v[76:79], v[20:23]
    ds_read_b128 v[124:127], v249 offset:64512
    v_mfma_f32_16x16x32_bf16 v[24:27], v[148:151], v[76:79], v[24:27]
    ds_read_b128 v[128:131], v250 offset:0
    v_mfma_f32_16x16x32_bf16 v[28:31], v[152:155], v[76:79], v[28:31]
    ds_read_b128 v[132:135], v250 offset:1024
    v_mfma_f32_16x16x32_bf16 v[32:35], v[156:159], v[76:79], v[32:35]
    ds_read_b128 v[136:139], v250 offset:2048
    v_mfma_f32_16x16x32_bf16 v[36:39], v[160:163], v[76:79], v[36:39]
    ds_read_b128 v[140:143], v250 offset:3072
    buffer_load_dwordx4 v[52:55], v2, s[16:19], s32 offen offset:3072 sc1
    s_waitcnt vmcnt(9) lgkmcnt(5)
    s_barrier
    v_mfma_f32_16x16x32_bf16 v[20:23], v[104:107], v[80:83], v[20:23]
    ds_read_b128 v[144:147], v250 offset:4096
    v_mfma_f32_16x16x32_bf16 v[24:27], v[108:111], v[80:83], v[24:27]
    ds_read_b128 v[148:151], v250 offset:5120
    v_mfma_f32_16x16x32_bf16 v[28:31], v[112:115], v[80:83], v[28:31]
    ds_read_b128 v[152:155], v250 offset:6144
    v_mfma_f32_16x16x32_bf16 v[32:35], v[116:119], v[80:83], v[32:35]
    ds_read_b128 v[156:159], v250 offset:7168
    v_mfma_f32_16x16x32_bf16 v[36:39], v[120:123], v[80:83], v[36:39]
    ds_read_b128 v[160:163], v250 offset:8192
    s_add_u32 s32, s31, 52224
    buffer_load_dwordx4 v[56:59], v2, s[16:19], s32 offen offset:0 sc1
    s_waitcnt vmcnt(9) lgkmcnt(5)
    v_mfma_f32_16x16x32_bf16 v[20:23], v[124:127], v[84:87], v[20:23]
    ds_read_b128 v[104:107], v250 offset:9216
    v_mfma_f32_16x16x32_bf16 v[24:27], v[128:131], v[84:87], v[24:27]
    ds_read_b128 v[108:111], v250 offset:10240
    v_mfma_f32_16x16x32_bf16 v[28:31], v[132:135], v[84:87], v[28:31]
    ds_read_b128 v[112:115], v250 offset:11264
    v_mfma_f32_16x16x32_bf16 v[32:35], v[136:139], v[84:87], v[32:35]
    ds_read_b128 v[116:119], v250 offset:12288
    v_mfma_f32_16x16x32_bf16 v[36:39], v[140:143], v[84:87], v[36:39]
    ds_read_b128 v[120:123], v250 offset:13312
    buffer_load_dwordx4 v[60:63], v2, s[16:19], s32 offen offset:1024 sc1
    s_waitcnt vmcnt(9) lgkmcnt(5)
    v_mfma_f32_16x16x32_bf16 v[20:23], v[144:147], v[88:91], v[20:23]
    ds_read_b128 v[124:127], v250 offset:14336
    v_mfma_f32_16x16x32_bf16 v[24:27], v[148:151], v[88:91], v[24:27]
    ds_read_b128 v[128:131], v250 offset:15360
    v_mfma_f32_16x16x32_bf16 v[28:31], v[152:155], v[88:91], v[28:31]
    ds_read_b128 v[132:135], v250 offset:16384
    v_mfma_f32_16x16x32_bf16 v[32:35], v[156:159], v[88:91], v[32:35]
    ds_read_b128 v[136:139], v250 offset:17408
    v_mfma_f32_16x16x32_bf16 v[36:39], v[160:163], v[88:91], v[36:39]
    ds_read_b128 v[140:143], v250 offset:18432
    s_waitcnt vmcnt(8) lgkmcnt(5)
    v_mfma_f32_16x16x32_bf16 v[20:23], v[104:107], v[92:95], v[20:23]
    ds_read_b128 v[144:147], v250 offset:19456
    v_mfma_f32_16x16x32_bf16 v[24:27], v[108:111], v[92:95], v[24:27]
    ds_read_b128 v[148:151], v250 offset:20480
    v_mfma_f32_16x16x32_bf16 v[28:31], v[112:115], v[92:95], v[28:31]
    ds_read_b128 v[152:155], v250 offset:21504
    v_mfma_f32_16x16x32_bf16 v[32:35], v[116:119], v[92:95], v[32:35]
    ds_read_b128 v[156:159], v250 offset:22528
    v_mfma_f32_16x16x32_bf16 v[36:39], v[120:123], v[92:95], v[36:39]
    ds_read_b128 v[160:163], v250 offset:23552
    s_waitcnt vmcnt(7) lgkmcnt(5)
    s_barrier
    v_mfma_f32_16x16x32_bf16 v[20:23], v[124:127], v[96:99], v[20:23]
    ds_read_b128 v[104:107], v250 offset:24576
pg_5:
    s_cbranch_execz pg_ret
    v_mfma_f32_16x16x32_bf16 v[24:27], v[128:131], v[96:99], v[24:27]
    ds_read_b128 v[108:111], v250 offset:25600
    v_mfma_f32_16x16x32_bf16 v[28:31], v[132:135], v[96:99], v[28:31]
    ds_read_b128 v[112:115], v250 offset:26624
    v_mfma_f32_16x16x32_bf16 v[32:35], v[136:139], v[96:99], v[32:35]
    ds_read_b128 v[116:119], v250 offset:27648
    v_mfma_f32_16x16x32_bf16 v[36:39], v[140:143], v[96:99], v[36:39]
    ds_read_b128 v[120:123], v248 offset:0
    s_waitcnt vmcnt(6) lgkmcnt(5)
    v_mfma_f32_16x16x32_bf16 v[20:23], v[144:147], v[100:103], v[20:23]
    ds_read_b128 v[124:127], v248 offset:1024
    v_mfma_f32_16x16x32_bf16 v[24:27], v[148:151], v[100:103], v[24:27]
    ds_read_b128 v[128:131], v248 offset:2048
    v_mfma_f32_16x16x32_bf16 v[28:31], v[152:155], v[100:103], v[28:31]
    ds_read_b128 v[132:135], v248 offset:3072
    v_mfma_f32_16x16x32_bf16 v[32:35], v[156:159], v[100:103], v[32:35]
    ds_read_b128 v[136:139], v248 offset:4096
    v_mfma_f32_16x16x32_bf16 v[36:39], v[160:163], v[100:103], v[36:39]
    ds_read_b128 v[140:143], v248 offset:5120
    s_waitcnt vmcnt(5) lgkmcnt(5)
    v_mfma_f32_16x16x32_bf16 v[20:23], v[104:107], v[40:43], v[20:23]
    ds_read_b128 v[144:147], v248 offset:6144
    v_mfma_f32_16x16x32_bf16 v[24:27], v[108:111], v[40:43], v[24:27]
    ds_read_b128 v[148:151], v248 offset:7168
    v_mfma_f32_16x16x32_bf16 v[28:31], v[112:115], v[40:43], v[28:31]
    ds_read_b128 v[152:155], v248 offset:8192
    v_mfma_f32_16x16x32_bf16 v[32:35], v[116:119], v[40:43], v[32:35]
    ds_read_b128 v[156:159], v248 offset:9216
    v_mfma_f32_16x16x32_bf16 v[36:39], v[120:123], v[40:43], v[36:39]
    ds_read_b128 v[160:163], v248 offset:10240
    s_waitcnt vmcnt(4) lgkmcnt(5)
    v_mfma_f32_16x16x32_bf16 v[20:23], v[124:127], v[44:47], v[20:23]
    ds_read_b128 v[104:107], v248 offset:11264
    v_mfma_f32_16x16x32_bf16 v[24:27], v[128:131], v[44:47], v[24:27]
    ds_read_b128 v[108:111], v248 offset:12288
    v_mfma_f32_16x16x32_bf16 v[28:31], v[132:135], v[44:47], v[28:31]
    ds_read_b128 v[112:115], v248 offset:13312
    v_mfma_f32_16x16x32_bf16 v[32:35], v[136:139], v[44:47], v[32:35]
    ds_read_b128 v[116:119], v248 offset:14336
    v_mfma_f32_16x16x32_bf16 v[36:39], v[140:143], v[44:47], v[36:39]
    ds_read_b128 v[120:123], v248 offset:15360
    s_waitcnt vmcnt(3) lgkmcnt(5)
    s_barrier
    v_mfma_f32_16x16x32_bf16 v[20:23], v[144:147], v[48:51], v[20:23]
    ds_read_b128 v[124:127], v248 offset:16384
    v_mfma_f32_16x16x32_bf16 v[24:27], v[148:151], v[48:51], v[24:27]
    ds_read_b128 v[128:131], v248 offset:17408
    v_mfma_f32_16x16x32_bf16 v[28:31], v[152:155], v[48:51], v[28:31]
    ds_read_b128 v[132:135], v248 offset:18432
    v_mfma_f32_16x16x32_bf16 v[32:35], v[156:159], v[48:51], v[32:35]
    ds_read_b128 v[136:139], v248 offset:19456
    v_mfma_f32_16x16x32_bf16 v[36:39], v[160:163], v[48:51], v[36:39]
    ds_read_b128 v[140:143], v248 offset:20480
    s_waitcnt vmcnt(2) lgkmcnt(5)
    v_mfma_f32_16x16x32_bf16 v[20:23], v[104:107], v[52:55], v[20:23]
    ds_read_b128 v[144:147], v248 offset:21504
    v_mfma_f32_16x16x32_bf16 v[24:27], v[108:111], v[52:55], v[24:27]
    ds_read_b128 v[148:151], v248 offset:22528
    v_mfma_f32_16x16x32_bf16 v[28:31], v[112:115], v[52:55], v[28:31]
    ds_read_b128 v[152:155], v248 offset:23552
    v_mfma_f32_16x16x32_bf16 v[32:35], v[116:119], v[52:55], v[32:35]
    ds_read_b128 v[156:159], v248 offset:24576
    v_mfma_f32_16x16x32_bf16 v[36:39], v[120:123], v[52:55], v[36:39]
    ds_read_b128 v[160:163], v248 offset:25600
    s_waitcnt vmcnt(1) lgkmcnt(5)
    v_mfma_f32_16x16x32_bf16 v[20:23], v[124:127], v[56:59], v[20:23]
    v_mfma_f32_16x16x32_bf16 v[24:27], v[128:131], v[56:59], v[24:27]
    v_mfma_f32_16x16x32_bf16 v[28:31], v[132:135], v[56:59], v[28:31]
    v_mfma_f32_16x16x32_bf16 v[32:35], v[136:139], v[56:59], v[32:35]
    v_mfma_f32_16x16x32_bf16 v[36:39], v[140:143], v[56:59], v[36:39]
    s_waitcnt vmcnt(0) lgkmcnt(0)
    v_mfma_f32_16x16x32_bf16 v[20:23], v[144:147], v[60:63], v[20:23]
    v_mfma_f32_16x16x32_bf16 v[24:27], v[148:151], v[60:63], v[24:27]
    v_mfma_f32_16x16x32_bf16 v[28:31], v[152:155], v[60:63], v[28:31]
    v_mfma_f32_16x16x32_bf16 v[32:35], v[156:159], v[60:63], v[32:35]
    v_mfma_f32_16x16x32_bf16 v[36:39], v[160:163], v[60:63], v[36:39]
    v_cvt_pk_bf16_f32 v10, v20, v21
    v_cvt_pk_bf16_f32 v11, v22, v23
    v_cvt_pk_bf16_f32 v12, v24, v25
    v_cvt_pk_bf16_f32 v13, v26, v27
    buffer_store_dwordx4 v[10:13], v7, s[8:11], s34 offen
    v_cvt_pk_bf16_f32 v14, v28, v29
    v_cvt_pk_bf16_f32 v15, v30, v31
    v_cvt_pk_bf16_f32 v16, v32, v33
    v_cvt_pk_bf16_f32 v17, v34, v35
    buffer_store_dwordx4 v[14:17], v7, s[8:11], s34 offen offset:64
    v_cvt_pk_bf16_f32 v18, v36, v37
    v_cvt_pk_bf16_f32 v19, v38, v39
    buffer_store_dwordx2 v[18:19], v8, s[8:11], s34 offen offset:128
    s_endpgm
k3_loader:
    s_waitcnt vmcnt(2)
    s_barrier
    s_waitcnt vmcnt(0)
    s_cmp_lg_u32 s86, 0
    s_cbranch_scc1 sequentia_s43
    s_mov_b64 exec, 1
    buffer_store_dwordx2 v[208:209], v9, s[16:19], s28 offen
    s_mov_b64 exec, -1
sequentia_b44:
    s_lshl_b32 s29, s7, 10
    s_and_b32 s28, s4, 15
    s_mul_i32 s28, s28, 286720
    s_add_u32 s28, s28, s29
    s_add_u32 s28, s28, 28860416
    s_and_b32 s30, s4, 7
    s_mul_i32 s30, s30, 276480
    s_add_u32 s30, s30, s29
    s_add_u32 s30, s30, 26214400
    s_lshl_b32 s31, s4, 2
    s_add_u32 s31, s31, s7
    s_cmp_lt_u32 s31, 108
    s_cselect_b32 s31, s31, 0
    s_lshl_b32 s31, s31, 13
    s_add_u32 s31, s31, s25
    s_add_u32 s31, s31, 393216
    s_cmp_eq_u32 s86, 0
    s_cselect_b32 s31, s31, 2146435072
    v_add_u32 v24, s29, v4
    v_add_u32 v25, 0x10000, v24
    v_add_u32 v26, 0x20000, v24
    s_add_u32 s33, s30, 278528
    s_add_u32 m0, s29, 126976
    s_nop 0
    buffer_load_dwordx4 v4, s[16:19], s28 offen sc1 lds
    s_add_u32 m0, s29, 131072
    s_add_u32 s28, s28, 4096
    buffer_load_dwordx4 v4, s[16:19], s28 offen sc1 lds
    s_add_u32 m0, s29, 135168
    s_add_u32 s28, s28, 4096
    buffer_load_dwordx4 v4, s[16:19], s28 offen sc1 lds
    s_add_u32 m0, s29, 139264
    s_add_u32 s28, s28, 4096
    buffer_load_dwordx4 v4, s[16:19], s28 offen sc1 lds
    s_add_u32 m0, s29, 143360
    s_add_u32 s28, s28, 4096
    buffer_load_dwordx4 v4, s[16:19], s28 offen sc1 lds
    s_add_u32 m0, s29, 147456
    s_add_u32 s28, s28, 4096
    buffer_load_dwordx4 v4, s[16:19], s28 offen sc1 lds
    s_add_u32 m0, s29, 151552
    s_add_u32 s28, s28, 4096
    buffer_load_dwordx4 v4, s[16:19], s28 offen sc1 lds
    s_add_u32 m0, s29, 155648
    s_add_u32 s28, s28, 4096
    buffer_load_dwordx4 v4, s[16:19], s28 offen sc1 lds
    s_barrier
    s_waitcnt vmcnt(63)
    s_barrier
    s_add_u32 m0, s29, 0
    s_add_u32 s28, s28, 4096
    buffer_load_dwordx4 v4, s[16:19], s28 offen sc1 lds
    s_add_u32 m0, s29, 4096
    s_add_u32 s28, s28, 4096
    buffer_load_dwordx4 v4, s[16:19], s28 offen sc1 lds
    s_add_u32 m0, s29, 8192
    s_add_u32 s28, s28, 4096
    buffer_load_dwordx4 v4, s[16:19], s28 offen sc1 lds
    s_add_u32 m0, s29, 12288
    s_add_u32 s28, s28, 4096
    buffer_load_dwordx4 v4, s[16:19], s28 offen sc1 lds
    s_add_u32 m0, s29, 16384
    s_add_u32 s28, s28, 4096
    buffer_load_dwordx4 v4, s[16:19], s28 offen sc1 lds
    s_add_u32 m0, s29, 20480
    s_add_u32 s28, s28, 4096
    buffer_load_dwordx4 v4, s[16:19], s28 offen sc1 lds
    s_add_u32 m0, s29, 24576
    s_add_u32 s28, s28, 4096
    buffer_load_dwordx4 v4, s[16:19], s28 offen sc1 lds
    s_waitcnt vmcnt(63)
    s_barrier
    s_add_u32 m0, s29, 28672
    s_add_u32 s28, s28, 4096
    buffer_load_dwordx4 v4, s[16:19], s28 offen sc1 lds
    s_add_u32 m0, s29, 32768
    s_add_u32 s28, s28, 4096
    buffer_load_dwordx4 v4, s[16:19], s28 offen sc1 lds
    s_add_u32 m0, s29, 36864
    s_add_u32 s28, s28, 4096
    buffer_load_dwordx4 v4, s[16:19], s28 offen sc1 lds
    s_add_u32 m0, s29, 40960
    s_add_u32 s28, s28, 4096
    buffer_load_dwordx4 v4, s[16:19], s28 offen sc1 lds
    s_add_u32 m0, s29, 45056
    s_add_u32 s28, s28, 4096
    buffer_load_dwordx4 v4, s[16:19], s28 offen sc1 lds
    s_add_u32 m0, s29, 49152
    s_add_u32 s28, s28, 4096
    buffer_load_dwordx4 v4, s[16:19], s28 offen sc1 lds
    s_waitcnt vmcnt(63)
    s_barrier
    s_add_u32 m0, s29, 53248
    s_add_u32 s28, s28, 4096
    buffer_load_dwordx4 v4, s[16:19], s28 offen sc1 lds
    s_add_u32 m0, s29, 57344
    s_add_u32 s28, s28, 4096
    buffer_load_dwordx4 v4, s[16:19], s28 offen sc1 lds
    s_add_u32 m0, s29, 61440
    s_add_u32 s28, s28, 4096
    buffer_load_dwordx4 v4, s[16:19], s28 offen sc1 lds
    s_add_u32 m0, s29, 65536
    s_add_u32 s28, s28, 4096
    buffer_load_dwordx4 v4, s[16:19], s28 offen sc1 lds
    s_waitcnt vmcnt(17)
    s_barrier
    s_add_u32 m0, s29, 69632
    s_add_u32 s28, s28, 4096
    s_waitcnt vmcnt(5)
    buffer_load_dwordx4 v4, s[16:19], s28 offen sc1 lds
    s_add_u32 m0, s29, 73728
    s_add_u32 s28, s28, 4096
    s_waitcnt vmcnt(5)
    buffer_load_dwordx4 v4, s[16:19], s28 offen sc1 lds
    s_add_u32 m0, s29, 77824
    s_add_u32 s28, s28, 4096
    s_waitcnt vmcnt(5)
    buffer_load_dwordx4 v4, s[16:19], s28 offen sc1 lds
    s_add_u32 m0, s29, 81920
    s_add_u32 s28, s28, 4096
    s_waitcnt vmcnt(5)
    buffer_load_dwordx4 v4, s[16:19], s28 offen sc1 lds
    s_add_u32 m0, s29, 86016
    s_add_u32 s28, s28, 4096
    s_waitcnt vmcnt(5)
    buffer_load_dwordx4 v4, s[16:19], s28 offen sc1 lds
    s_add_u32 m0, s29, 90112
    s_add_u32 s28, s28, 4096
    s_waitcnt vmcnt(5)
    buffer_load_dwordx4 v4, s[16:19], s28 offen sc1 lds
    s_add_u32 m0, s29, 94208
    s_add_u32 s28, s28, 4096
    s_waitcnt vmcnt(5)
    buffer_load_dwordx4 v4, s[16:19], s28 offen sc1 lds
    s_add_u32 m0, s29, 98304
    s_add_u32 s28, s28, 4096
    s_waitcnt vmcnt(5)
    buffer_load_dwordx4 v4, s[16:19], s28 offen sc1 lds
    s_waitcnt vmcnt(18)
    s_barrier
    s_add_u32 m0, s29, 102400
    s_add_u32 s28, s28, 4096
    s_waitcnt vmcnt(5)
    buffer_load_dwordx4 v4, s[16:19], s28 offen sc1 lds
    s_add_u32 m0, s29, 106496
    s_add_u32 s28, s28, 4096
    s_waitcnt vmcnt(5)
    buffer_load_dwordx4 v4, s[16:19], s28 offen sc1 lds
    s_add_u32 m0, s29, 110592
    s_add_u32 s28, s28, 4096
    s_waitcnt vmcnt(5)
    buffer_load_dwordx4 v4, s[16:19], s28 offen sc1 lds
    s_add_u32 m0, s29, 114688
    s_add_u32 s28, s28, 4096
    s_waitcnt vmcnt(5)
    buffer_load_dwordx4 v4, s[16:19], s28 offen sc1 lds
    s_add_u32 m0, s29, 118784
    s_add_u32 s28, s28, 4096
    s_waitcnt vmcnt(5)
    buffer_load_dwordx4 v4, s[16:19], s28 offen sc1 lds
    s_add_u32 m0, s29, 122880
    s_add_u32 s28, s28, 4096
    s_waitcnt vmcnt(5)
    buffer_load_dwordx4 v4, s[16:19], s28 offen sc1 lds
    s_waitcnt vmcnt(17)
    s_barrier
    s_add_u32 m0, s29, 126976
    s_add_u32 s28, s28, 4096
    s_waitcnt vmcnt(5)
    buffer_load_dwordx4 v4, s[16:19], s28 offen sc1 lds
    s_add_u32 m0, s29, 131072
    s_add_u32 s28, s28, 4096
    s_waitcnt vmcnt(5)
    buffer_load_dwordx4 v4, s[16:19], s28 offen sc1 lds
    s_add_u32 m0, s29, 135168
    s_add_u32 s28, s28, 4096
    s_waitcnt vmcnt(5)
    buffer_load_dwordx4 v4, s[16:19], s28 offen sc1 lds
    s_add_u32 m0, s29, 139264
    s_add_u32 s28, s28, 4096
    s_waitcnt vmcnt(5)
    buffer_load_dwordx4 v4, s[16:19], s28 offen sc1 lds
    s_add_u32 m0, s29, 143360
    s_add_u32 s28, s28, 4096
    s_waitcnt vmcnt(5)
    buffer_load_dwordx4 v4, s[16:19], s28 offen sc1 lds
    s_add_u32 m0, s29, 147456
    s_add_u32 s28, s28, 4096
    s_waitcnt vmcnt(5)
    buffer_load_dwordx4 v4, s[16:19], s28 offen sc1 lds
    s_waitcnt vmcnt(16)
    s_barrier
    s_add_u32 m0, s29, 151552
    s_add_u32 s28, s28, 4096
    s_waitcnt vmcnt(5)
    buffer_load_dwordx4 v4, s[16:19], s28 offen sc1 lds
    s_add_u32 m0, s29, 155648
    s_add_u32 s28, s28, 4096
    s_waitcnt vmcnt(5)
    buffer_load_dwordx4 v4, s[16:19], s28 offen sc1 lds
    s_add_u32 m0, s29, 0
    s_add_u32 s28, s28, 4096
    s_waitcnt vmcnt(5)
    buffer_load_dwordx4 v4, s[16:19], s28 offen sc1 lds
    s_add_u32 m0, s29, 4096
    s_add_u32 s28, s28, 4096
    s_waitcnt vmcnt(5)
    buffer_load_dwordx4 v4, s[16:19], s28 offen sc1 lds
    s_add_u32 m0, s29, 8192
    s_add_u32 s28, s28, 4096
    s_waitcnt vmcnt(5)
    buffer_load_dwordx4 v4, s[16:19], s28 offen sc1 lds
    s_add_u32 m0, s29, 12288
    s_add_u32 s28, s28, 4096
    s_waitcnt vmcnt(5)
    buffer_load_dwordx4 v4, s[16:19], s28 offen sc1 lds
    s_waitcnt vmcnt(15)
    s_barrier
    s_add_u32 m0, s29, 16384
    s_add_u32 s28, s28, 4096
    s_waitcnt vmcnt(5)
    buffer_load_dwordx4 v4, s[16:19], s28 offen sc1 lds
    s_add_u32 m0, s29, 20480
    s_add_u32 s28, s28, 4096
    s_waitcnt vmcnt(5)
    buffer_load_dwordx4 v4, s[16:19], s28 offen sc1 lds
    s_add_u32 m0, s29, 24576
    s_add_u32 s28, s28, 4096
    s_waitcnt vmcnt(5)
    buffer_load_dwordx4 v4, s[16:19], s28 offen sc1 lds
    s_add_u32 m0, s29, 28672
    s_add_u32 s28, s28, 4096
    s_waitcnt vmcnt(5)
    buffer_load_dwordx4 v4, s[16:19], s28 offen sc1 lds
    s_add_u32 m0, s29, 32768
    s_add_u32 s28, s28, 4096
    s_waitcnt vmcnt(5)
    buffer_load_dwordx4 v4, s[16:19], s28 offen sc1 lds
    s_add_u32 m0, s29, 36864
    s_add_u32 s28, s28, 4096
    s_waitcnt vmcnt(5)
    buffer_load_dwordx4 v4, s[16:19], s28 offen sc1 lds
    s_waitcnt vmcnt(14)
    s_barrier
    s_add_u32 m0, s29, 40960
    s_add_u32 s28, s28, 4096
    s_waitcnt vmcnt(5)
    buffer_load_dwordx4 v4, s[16:19], s28 offen sc1 lds
    s_add_u32 m0, s29, 45056
    s_add_u32 s28, s28, 4096
    s_waitcnt vmcnt(5)
    buffer_load_dwordx4 v4, s[16:19], s28 offen sc1 lds
    s_add_u32 m0, s29, 49152
    s_add_u32 s28, s28, 4096
    s_waitcnt vmcnt(5)
    buffer_load_dwordx4 v4, s[16:19], s28 offen sc1 lds
    s_add_u32 m0, s29, 53248
    s_add_u32 s28, s28, 4096
    s_waitcnt vmcnt(5)
    buffer_load_dwordx4 v4, s[16:19], s28 offen sc1 lds
    s_add_u32 m0, s29, 57344
    s_add_u32 s28, s28, 4096
    s_waitcnt vmcnt(5)
    buffer_load_dwordx4 v4, s[16:19], s28 offen sc1 lds
    s_add_u32 m0, s29, 61440
    s_add_u32 s28, s28, 4096
    s_waitcnt vmcnt(5)
    buffer_load_dwordx4 v4, s[16:19], s28 offen sc1 lds
    s_waitcnt vmcnt(13)
    s_barrier
    s_add_u32 m0, s29, 65536
    s_add_u32 s28, s28, 4096
    s_waitcnt vmcnt(5)
    buffer_load_dwordx4 v4, s[16:19], s28 offen sc1 lds
    s_add_u32 m0, s29, 69632
    s_mov_b32 s28, s30
    s_waitcnt vmcnt(5)
    buffer_load_dwordx4 v4, s[16:19], s28 offen sc1 lds
    s_add_u32 m0, s29, 73728
    s_add_u32 s28, s28, 4096
    s_waitcnt vmcnt(5)
    buffer_load_dwordx4 v4, s[16:19], s28 offen sc1 lds
    s_add_u32 m0, s29, 77824
    s_add_u32 s28, s28, 4096
    s_waitcnt vmcnt(5)
    buffer_load_dwordx4 v4, s[16:19], s28 offen sc1 lds
    s_add_u32 m0, s29, 81920
    s_add_u32 s28, s28, 4096
    s_waitcnt vmcnt(5)
    buffer_load_dwordx4 v4, s[16:19], s28 offen sc1 lds
    s_add_u32 m0, s29, 86016
    s_add_u32 s28, s28, 4096
    s_waitcnt vmcnt(5)
    buffer_load_dwordx4 v4, s[16:19], s28 offen sc1 lds
    s_add_u32 m0, s29, 90112
    s_add_u32 s28, s28, 4096
    s_waitcnt vmcnt(5)
    buffer_load_dwordx4 v4, s[16:19], s28 offen sc1 lds
    s_waitcnt vmcnt(13)
    s_barrier
    s_add_u32 m0, s29, 94208
    s_add_u32 s28, s28, 4096
    buffer_load_dwordx4 v4, s[16:19], s28 offen sc1 lds
    s_add_u32 m0, s29, 98304
    s_add_u32 s28, s28, 4096
    buffer_load_dwordx4 v4, s[16:19], s28 offen sc1 lds
    s_add_u32 m0, s29, 102400
    s_add_u32 s28, s28, 4096
    buffer_load_dwordx4 v4, s[16:19], s28 offen sc1 lds
    s_add_u32 m0, s29, 106496
    s_add_u32 s28, s28, 4096
    buffer_load_dwordx4 v4, s[16:19], s28 offen sc1 lds
    s_add_u32 m0, s29, 110592
    s_add_u32 s28, s28, 4096
    buffer_load_dwordx4 v4, s[16:19], s28 offen sc1 lds
    s_add_u32 m0, s29, 114688
    s_add_u32 s28, s28, 4096
    buffer_load_dwordx4 v4, s[16:19], s28 offen sc1 lds
    s_add_u32 m0, s29, 118784
    s_add_u32 s28, s28, 4096
    buffer_load_dwordx4 v4, s[16:19], s28 offen sc1 lds
    s_add_u32 m0, s29, 122880
    s_add_u32 s28, s28, 4096
    buffer_load_dwordx4 v4, s[16:19], s28 offen sc1 lds
    s_add_u32 m0, s29, 126976
    s_add_u32 s28, s28, 4096
    buffer_load_dwordx4 v4, s[16:19], s28 offen sc1 lds
    s_add_u32 m0, s29, 131072
    s_add_u32 s28, s28, 4096
    buffer_load_dwordx4 v4, s[16:19], s28 offen sc1 lds
    s_waitcnt vmcnt(16)
    s_barrier
    s_add_u32 m0, s29, 135168
    s_add_u32 s28, s28, 4096
    buffer_load_dwordx4 v4, s[16:19], s28 offen sc1 lds
    s_add_u32 m0, s29, 139264
    s_add_u32 s28, s28, 4096
    buffer_load_dwordx4 v4, s[16:19], s28 offen sc1 lds
    s_add_u32 m0, s29, 143360
    s_add_u32 s28, s28, 4096
    buffer_load_dwordx4 v4, s[16:19], s28 offen sc1 lds
    s_add_u32 m0, s29, 147456
    s_add_u32 s28, s28, 4096
    buffer_load_dwordx4 v4, s[16:19], s28 offen sc1 lds
    s_add_u32 m0, s29, 151552
    s_add_u32 s28, s28, 4096
    buffer_load_dwordx4 v4, s[16:19], s28 offen sc1 lds
    s_add_u32 m0, s29, 155648
    s_add_u32 s28, s28, 4096
    buffer_load_dwordx4 v4, s[16:19], s28 offen sc1 lds
    s_add_u32 m0, s29, 0
    s_add_u32 s28, s28, 4096
    buffer_load_dwordx4 v4, s[16:19], s28 offen sc1 lds
    s_add_u32 m0, s29, 4096
    s_add_u32 s28, s28, 4096
    buffer_load_dwordx4 v4, s[16:19], s28 offen sc1 lds
    s_add_u32 m0, s29, 8192
    s_add_u32 s28, s28, 4096
    buffer_load_dwordx4 v4, s[16:19], s28 offen sc1 lds
    s_add_u32 m0, s29, 12288
    s_add_u32 s28, s28, 4096
    buffer_load_dwordx4 v4, s[16:19], s28 offen sc1 lds
    s_waitcnt vmcnt(26)
    s_barrier
    s_add_u32 m0, s29, 16384
    s_add_u32 s28, s28, 4096
    buffer_load_dwordx4 v4, s[16:19], s28 offen sc1 lds
    s_add_u32 m0, s29, 20480
    s_add_u32 s28, s28, 4096
    buffer_load_dwordx4 v4, s[16:19], s28 offen sc1 lds
    s_add_u32 m0, s29, 24576
    s_add_u32 s28, s28, 4096
    buffer_load_dwordx4 v4, s[16:19], s28 offen sc1 lds
    s_add_u32 m0, s29, 28672
    s_add_u32 s28, s28, 4096
    buffer_load_dwordx4 v4, s[16:19], s28 offen sc1 lds
    s_add_u32 m0, s29, 32768
    s_add_u32 s28, s28, 4096
    buffer_load_dwordx4 v4, s[16:19], s28 offen sc1 lds
    s_cmp_lg_u32 s7, 0
    s_cbranch_scc1 sequentia_lp45
    s_lshr_b32 s35, s4, 3
    s_lshl_b32 s35, s35, 8
    s_add_u32 s35, s35, s25
    s_add_u32 s35, s35, 363520
    v_lshlrev_b32 v21, 3, v1
    s_mov_b32 exec_lo, 0xffffffff
    s_mov_b32 exec_hi, 0x0
    s_max_i32 s87, s87, 100
sequentia_p46:
    buffer_load_dwordx2 v[240:241], v21, s[16:19], s35 offen sc1
sequentia_t48:
    s_waitcnt vmcnt(0)
    v_cmp_ne_u64 vcc, s[84:85], v[240:241]
    s_sub_u32 s87, s87, 1
    s_cbranch_scc1 sequentia_d47
    s_cbranch_vccnz sequentia_p46
sequentia_d47:
    s_mov_b64 exec, -1
sequentia_lp45:
    s_add_u32 m0, s29, 36864
    s_add_u32 s28, s28, 4096
    buffer_load_dwordx4 v4, s[16:19], s28 offen sc1 lds
    s_add_u32 m0, s29, 40960
    s_add_u32 s28, s28, 4096
    buffer_load_dwordx4 v4, s[16:19], s28 offen sc1 lds
    s_add_u32 m0, s29, 45056
    s_add_u32 s28, s28, 4096
    buffer_load_dwordx4 v4, s[16:19], s28 offen sc1 lds
    s_add_u32 m0, s29, 49152
    s_add_u32 s28, s28, 4096
    buffer_load_dwordx4 v4, s[16:19], s28 offen sc1 lds
    s_add_u32 m0, s29, 53248
    s_add_u32 s28, s28, 4096
    buffer_load_dwordx4 v4, s[16:19], s28 offen sc1 lds
    s_add_u32 m0, s29, 57344
    s_add_u32 s28, s28, 4096
    buffer_load_dwordx4 v4, s[16:19], s28 offen sc1 lds
    s_add_u32 m0, s29, 61440
    s_add_u32 s28, s28, 4096
    buffer_load_dwordx4 v4, s[16:19], s28 offen sc1 lds
    s_add_u32 m0, s29, 65536
    s_add_u32 s28, s28, 4096
    buffer_load_dwordx4 v4, s[16:19], s28 offen sc1 lds
    s_waitcnt vmcnt(29)
    s_barrier
    s_cmp_lg_u32 s7, 0
    s_cbranch_scc1 sequentia_lp49
    s_lshr_b32 s35, s4, 3
    s_lshl_b32 s35, s35, 8
    s_add_u32 s35, s35, s25
    s_add_u32 s35, s35, 362496
    v_lshlrev_b32 v21, 3, v1
    s_mov_b32 exec_lo, 0xffffffff
    s_mov_b32 exec_hi, 0x0
    s_max_i32 s87, s87, 100
sequentia_p50:
    buffer_load_dwordx2 v[240:241], v21, s[16:19], s35 offen sc1
sequentia_t52:
    s_waitcnt vmcnt(0)
    v_cmp_ne_u64 vcc, s[84:85], v[240:241]
    s_sub_u32 s87, s87, 1
    s_cbranch_scc1 sequentia_d51
    s_cbranch_vccnz sequentia_p50
sequentia_d51:
    s_mov_b64 exec, -1
sequentia_lp49:
    s_waitcnt vmcnt(24)
    s_barrier
    s_add_u32 m0, s29, 69632
    s_add_u32 s28, s28, 4096
    buffer_load_dwordx4 v4, s[16:19], s28 offen sc1 lds
    s_add_u32 m0, s29, 73728
    s_add_u32 s28, s28, 4096
    buffer_load_dwordx4 v4, s[16:19], s28 offen sc1 lds
    s_add_u32 m0, s29, 77824
    s_add_u32 s28, s28, 4096
    buffer_load_dwordx4 v4, s[16:19], s28 offen sc1 lds
    s_add_u32 m0, s29, 81920
    s_add_u32 s28, s28, 4096
    buffer_load_dwordx4 v4, s[16:19], s28 offen sc1 lds
    s_waitcnt vmcnt(23)
    s_barrier
    s_add_u32 m0, s29, 86016
    s_add_u32 s28, s28, 4096
    buffer_load_dwordx4 v4, s[16:19], s28 offen sc1 lds
    s_add_u32 m0, s29, 90112
    s_add_u32 s28, s28, 4096
    buffer_load_dwordx4 v4, s[16:19], s28 offen sc1 lds
    s_add_u32 m0, s29, 94208
    s_add_u32 s28, s28, 4096
    buffer_load_dwordx4 v4, s[16:19], s28 offen sc1 lds
    s_add_u32 m0, s29, 98304
    s_add_u32 s28, s28, 4096
    buffer_load_dwordx4 v4, s[16:19], s28 offen sc1 lds
    s_waitcnt vmcnt(22)
    s_barrier
    s_add_u32 m0, s29, 102400
    s_add_u32 s28, s28, 4096
    buffer_load_dwordx4 v4, s[16:19], s28 offen sc1 lds
    s_add_u32 m0, s29, 106496
    s_add_u32 s28, s28, 4096
    buffer_load_dwordx4 v4, s[16:19], s28 offen sc1 lds
    s_add_u32 m0, s29, 110592
    s_add_u32 s28, s28, 4096
    buffer_load_dwordx4 v4, s[16:19], s28 offen sc1 lds
    s_add_u32 m0, s29, 114688
    s_add_u32 s28, s28, 4096
    buffer_load_dwordx4 v4, s[16:19], s28 offen sc1 lds
    s_waitcnt vmcnt(21)
    s_barrier
    s_add_u32 m0, s29, 118784
    s_add_u32 s28, s28, 4096
pg_6:
    s_cbranch_execz pg_ret
    buffer_load_dwordx4 v4, s[16:19], s28 offen sc1 lds
    s_add_u32 m0, s29, 122880
    s_add_u32 s28, s28, 4096
    buffer_load_dwordx4 v4, s[16:19], s28 offen sc1 lds
    s_add_u32 m0, s29, 126976
    s_add_u32 s28, s28, 4096
    buffer_load_dwordx4 v4, s[16:19], s28 offen sc1 lds
    s_add_u32 m0, s29, 131072
    s_add_u32 s28, s28, 4096
    buffer_load_dwordx4 v4, s[16:19], s28 offen sc1 lds
    s_waitcnt vmcnt(20)
    s_barrier
    s_add_u32 m0, s29, 135168
    s_add_u32 s28, s28, 4096
    buffer_load_dwordx4 v4, s[16:19], s28 offen sc1 lds
    s_add_u32 m0, s29, 139264
    s_add_u32 s28, s28, 4096
    buffer_load_dwordx4 v4, s[16:19], s28 offen sc1 lds
    s_add_u32 m0, s29, 143360
    s_add_u32 s28, s28, 4096
    buffer_load_dwordx4 v4, s[16:19], s28 offen sc1 lds
    s_add_u32 m0, s29, 147456
    s_add_u32 s28, s28, 4096
    buffer_load_dwordx4 v4, s[16:19], s28 offen sc1 lds
    s_waitcnt vmcnt(19)
    s_barrier
    s_add_u32 m0, s29, 151552
    s_add_u32 s28, s28, 4096
    buffer_load_dwordx4 v4, s[16:19], s28 offen sc1 lds
    s_add_u32 m0, s29, 155648
    s_add_u32 s28, s28, 4096
    buffer_load_dwordx4 v4, s[16:19], s28 offen sc1 lds
    s_add_u32 m0, s29, 0
    s_add_u32 s28, s28, 4096
    buffer_load_dwordx4 v4, s[16:19], s28 offen sc1 lds
    s_add_u32 m0, s29, 4096
    s_add_u32 s28, s28, 4096
    buffer_load_dwordx4 v4, s[16:19], s28 offen sc1 lds
    s_waitcnt vmcnt(18)
    s_barrier
    s_add_u32 m0, s29, 8192
    s_add_u32 s28, s28, 4096
    buffer_load_dwordx4 v4, s[16:19], s28 offen sc1 lds
    s_add_u32 m0, s29, 12288
    s_add_u32 s28, s28, 4096
    buffer_load_dwordx4 v4, s[16:19], s28 offen sc1 lds
    s_add_u32 m0, s29, 16384
    s_add_u32 s28, s28, 4096
    buffer_load_dwordx4 v4, s[16:19], s28 offen sc1 lds
    s_add_u32 m0, s29, 20480
    s_add_u32 s28, s28, 4096
    buffer_load_dwordx4 v4, s[16:19], s28 offen sc1 lds
    s_waitcnt vmcnt(17)
    s_barrier
    s_add_u32 m0, s29, 24576
    s_add_u32 s28, s28, 4096
    buffer_load_dwordx4 v4, s[16:19], s28 offen sc1 lds
    s_waitcnt vmcnt(13)
    s_barrier
    s_waitcnt vmcnt(8)
    s_barrier
    s_waitcnt vmcnt(3)
    s_barrier
    s_waitcnt vmcnt(0)
    s_barrier
    s_endpgm
k1_spare:
    s_getpc_b64 s[28:29]
    s_lshl_b32 s30, s3, 9
    v_lshl_add_u32 v2, v1, 3, s30
    global_load_dwordx2 v[200:201], v2, s[28:29]
    s_and_b32 s44, s3, 4
    s_bfe_u32 s45, s3, 0x10001
    s_add_u32 s44, s44, s45
    s_and_b32 s45, s3, 1
    s_lshl_b32 s45, s45, 1
    s_add_u32 s44, s44, s45
    s_waitcnt lgkmcnt(0)
    s_mov_b32 s16, s82
    s_mov_b32 s17, s83
    s_mov_b32 s18, 33554432
    s_mov_b32 s19, 0x00020000
    v_mov_b32 v40, 0
    v_mov_b32 v42, 0
    v_mov_b32 v192, 0
    s_add_u32 s41, s5, 0
    s_sub_u32 s42, s41, 20
    s_cselect_b32 s41, s41, s42
    s_cselect_b32 s8, s68, s76
    s_cselect_b32 s9, s69, s77
    s_cselect_b32 s10, 20, 24
    s_cselect_b32 s30, s44, s44
    s_mul_i32 s10, s10, 40960
    s_mov_b32 s11, 0x00020000
    s_lshl_b32 s31, s41, 3
    s_add_u32 s30, s30, s31
    s_mul_i32 s30, s30, 5120
    s_and_b32 s28, s3, 1
    s_lshl_b32 s28, s28, 2
    s_mul_i32 s29, s3, 5120
    s_add_u32 s29, s29, 0
    v_add_u32 v8, 0, v1
    v_mul_u32_u24 v9, 205, v8
    v_lshrrev_b32 v9, 14, v9
    v_add_u32 v9, s28, v9
    v_lshlrev_b32 v9, 1, v9
    v_xor_b32 v8, v8, v9
    v_lshlrev_b32 v8, 4, v8
    s_add_u32 m0, s29, 0
    s_nop 0
    buffer_load_dwordx4 v8, s[8:11], s30 offen lds
    v_add_u32 v8, 64, v1
    v_mul_u32_u24 v9, 205, v8
    v_lshrrev_b32 v9, 14, v9
    v_add_u32 v9, s28, v9
    v_lshlrev_b32 v9, 1, v9
    v_xor_b32 v8, v8, v9
    v_lshlrev_b32 v8, 4, v8
    s_add_u32 m0, s29, 1024
    s_nop 0
    buffer_load_dwordx4 v8, s[8:11], s30 offen lds
    v_add_u32 v8, 128, v1
    v_mul_u32_u24 v9, 205, v8
    v_lshrrev_b32 v9, 14, v9
    v_add_u32 v9, s28, v9
    v_lshlrev_b32 v9, 1, v9
    v_xor_b32 v8, v8, v9
    v_lshlrev_b32 v8, 4, v8
    s_add_u32 m0, s29, 2048
    s_nop 0
    buffer_load_dwordx4 v8, s[8:11], s30 offen lds
    v_add_u32 v8, 192, v1
    v_mul_u32_u24 v9, 205, v8
    v_lshrrev_b32 v9, 14, v9
    v_add_u32 v9, s28, v9
    v_lshlrev_b32 v9, 1, v9
    v_xor_b32 v8, v8, v9
    v_lshlrev_b32 v8, 4, v8
    s_add_u32 m0, s29, 3072
    s_nop 0
    buffer_load_dwordx4 v8, s[8:11], s30 offen lds
    v_add_u32 v8, 256, v1
    v_mul_u32_u24 v9, 205, v8
    v_lshrrev_b32 v9, 14, v9
    v_add_u32 v9, s28, v9
    v_lshlrev_b32 v9, 1, v9
    v_xor_b32 v8, v8, v9
    v_lshlrev_b32 v8, 4, v8
    s_add_u32 m0, s29, 4096
    s_nop 0
    buffer_load_dwordx4 v8, s[8:11], s30 offen lds
    s_add_u32 s41, s5, 16
    s_sub_u32 s42, s41, 20
    s_cselect_b32 s41, s41, s42
    s_cselect_b32 s8, s68, s76
    s_cselect_b32 s9, s69, s77
    s_cselect_b32 s10, 20, 24
    s_cselect_b32 s30, s44, s44
    s_mul_i32 s10, s10, 40960
    s_mov_b32 s11, 0x00020000
    s_lshl_b32 s31, s41, 3
    s_add_u32 s30, s30, s31
    s_mul_i32 s30, s30, 5120
    s_and_b32 s28, s3, 1
    s_lshl_b32 s28, s28, 2
    s_mul_i32 s29, s3, 5120
    s_add_u32 s29, s29, 40960
    v_add_u32 v8, 0, v1
    v_mul_u32_u24 v9, 205, v8
    v_lshrrev_b32 v9, 14, v9
    v_add_u32 v9, s28, v9
    v_lshlrev_b32 v9, 1, v9
    v_xor_b32 v8, v8, v9
    v_lshlrev_b32 v8, 4, v8
    s_add_u32 m0, s29, 0
    s_nop 0
    buffer_load_dwordx4 v8, s[8:11], s30 offen lds
    v_add_u32 v8, 64, v1
    v_mul_u32_u24 v9, 205, v8
    v_lshrrev_b32 v9, 14, v9
    v_add_u32 v9, s28, v9
    v_lshlrev_b32 v9, 1, v9
    v_xor_b32 v8, v8, v9
    v_lshlrev_b32 v8, 4, v8
    s_add_u32 m0, s29, 1024
    s_nop 0
    buffer_load_dwordx4 v8, s[8:11], s30 offen lds
    v_add_u32 v8, 128, v1
    v_mul_u32_u24 v9, 205, v8
    v_lshrrev_b32 v9, 14, v9
    v_add_u32 v9, s28, v9
    v_lshlrev_b32 v9, 1, v9
    v_xor_b32 v8, v8, v9
    v_lshlrev_b32 v8, 4, v8
    s_add_u32 m0, s29, 2048
    s_nop 0
    buffer_load_dwordx4 v8, s[8:11], s30 offen lds
    v_add_u32 v8, 192, v1
    v_mul_u32_u24 v9, 205, v8
    v_lshrrev_b32 v9, 14, v9
    v_add_u32 v9, s28, v9
    v_lshlrev_b32 v9, 1, v9
    v_xor_b32 v8, v8, v9
    v_lshlrev_b32 v8, 4, v8
    s_add_u32 m0, s29, 3072
    s_nop 0
    buffer_load_dwordx4 v8, s[8:11], s30 offen lds
    v_add_u32 v8, 256, v1
    v_mul_u32_u24 v9, 205, v8
    v_lshrrev_b32 v9, 14, v9
    v_add_u32 v9, s28, v9
    v_lshlrev_b32 v9, 1, v9
    v_xor_b32 v8, v8, v9
    v_lshlrev_b32 v8, 4, v8
    s_add_u32 m0, s29, 4096
    s_nop 0
    buffer_load_dwordx4 v8, s[8:11], s30 offen lds
    s_waitcnt vmcnt(5)
    s_barrier
    s_add_u32 s41, s5, 0
    s_sub_u32 s42, s41, 20
    s_cselect_b32 s41, s41, s42
    s_cselect_b32 s31, 20, 54
    s_cselect_b32 s32, 0, 1048576
    s_mul_i32 s28, s41, 37
    s_lshr_b32 s28, s28, 8
    s_mul_i32 s29, s28, 28
    s_lshl_b32 s33, s41, 2
    s_sub_u32 s29, s33, s29
    s_lshr_b32 s29, 0x4392108, s29
    s_bitcmp1_b32 s29, 3
    s_cselect_b32 s33, 2, 5
    s_mul_i32 s28, s28, s33
    s_cselect_b32 s33, 0, 16
    s_and_b32 s29, s29, 7
    s_add_u32 s33, s33, s28
    s_add_u32 s33, s33, s29
    s_cmp_eq_u32 s32, 0
    s_cselect_b32 s33, s41, s33
    s_mul_i32 s31, s31, s3
    s_add_u32 s31, s31, s33
    s_mul_i32 s31, s31, 5120
    s_add_u32 s31, s31, s32
    s_add_u32 s31, s31, 25165824
    v_lshrrev_b32 v8, 5, v1
    v_lshlrev_b32 v8, 4, v8
    v_bfe_u32 v9, v1, 2, 3
    v_add_u32 v8, v8, v9
    v_mul_u32_u24 v8, 1280, v8
    v_add_u32 v8, 0, v8
    v_lshlrev_b32 v9, 1, v9
    v_and_b32 v10, 3, v1
    s_mul_i32 s28, s3, 10
    v_add_u32 v11, s28, v10
    v_xor_b32 v12, v11, v9
    v_lshl_add_u32 v12, v12, 4, v8
    v_add_u32 v11, 4, v11
    v_xor_b32 v13, v11, v9
    v_lshl_add_u32 v13, v13, 4, v8
    v_lshrrev_b32 v11, 1, v10
    s_add_u32 s28, s28, 8
    v_add_u32 v11, s28, v11
    v_xor_b32 v14, v11, v9
    v_lshl_add_u32 v14, v14, 4, v8
    v_and_b32 v10, 1, v1
    v_lshl_add_u32 v14, v10, 3, v14
    v_lshlrev_b32 v15, 4, v1
    ds_read_b64_tr_b16 v[16:17], v12 offset:0
    ds_read_b64_tr_b16 v[18:19], v12 offset:10240
    ds_read_b64_tr_b16 v[20:21], v12 offset:8
    ds_read_b64_tr_b16 v[22:23], v12 offset:10248
    ds_read_b64_tr_b16 v[24:25], v13 offset:0
    ds_read_b64_tr_b16 v[26:27], v13 offset:10240
    ds_read_b64_tr_b16 v[28:29], v13 offset:8
    ds_read_b64_tr_b16 v[30:31], v13 offset:10248
    ds_read_b64_tr_b16 v[32:33], v14 offset:0
    ds_read_b64_tr_b16 v[34:35], v14 offset:10240
    s_waitcnt lgkmcnt(8)
    buffer_store_dwordx4 v[16:19], v15, s[16:19], s31 offen offset:0 sc1
    s_waitcnt lgkmcnt(6)
    buffer_store_dwordx4 v[20:23], v15, s[16:19], s31 offen offset:1024 sc1
    s_waitcnt lgkmcnt(4)
    buffer_store_dwordx4 v[24:27], v15, s[16:19], s31 offen offset:2048 sc1
    s_waitcnt lgkmcnt(2)
    buffer_store_dwordx4 v[28:31], v15, s[16:19], s31 offen offset:3072 sc1
    s_waitcnt lgkmcnt(0)
    s_add_u32 s31, s31, 4096
    buffer_store_dwordx4 v[32:35], v15, s[16:19], s31 offen offset:0 sc1
    v_lshrrev_b32 v60, 4, v1
    v_and_b32 v61, 15, v1
    v_mul_u32_u24 v62, 1280, v60
    v_lshl_add_u32 v62, v61, 4, v62
    s_mul_i32 s28, s3, 5120
    s_add_u32 s28, s28, 0
    v_add_u32 v62, s28, v62
    v_mov_b32 v63, 0x3f803f80
    ds_read_b128 v[64:67], v62 offset:0
    ds_read_b128 v[68:71], v62 offset:256
    ds_read_b128 v[72:75], v62 offset:512
    ds_read_b128 v[76:79], v62 offset:768
    ds_read_b128 v[80:83], v62 offset:1024
    s_lshl_b32 s28, s41, 7
    s_lshr_b32 s29, s44, 1
    s_lshl_b32 s29, s29, 5
    s_add_u32 s28, s28, s29
    s_and_b32 s29, s44, 1
    s_lshl_b32 s29, s29, 3
    s_add_u32 s28, s28, s29
    s_add_u32 s28, s28, 8617984
    s_cmp_eq_u32 s32, 0
    s_cselect_b32 s28, s28, 2146435072
    v_lshlrev_b32 v60, 1, v60
    v_lshl_add_u32 v60, v61, 4, v60
    s_waitcnt lgkmcnt(0)
    v_dot2_f32_bf16 v84, v64, v63, 0
    v_dot2_f32_bf16 v85, v65, v63, 0
    v_dot2_f32_bf16 v84, v66, v63, v84
    v_dot2_f32_bf16 v85, v67, v63, v85
    v_dot2_f32_bf16 v84, v68, v63, v84
    v_dot2_f32_bf16 v85, v69, v63, v85
    v_dot2_f32_bf16 v84, v70, v63, v84
    v_dot2_f32_bf16 v85, v71, v63, v85
    v_dot2_f32_bf16 v84, v72, v63, v84
    v_dot2_f32_bf16 v85, v73, v63, v85
    v_dot2_f32_bf16 v84, v74, v63, v84
    v_dot2_f32_bf16 v85, v75, v63, v85
    v_dot2_f32_bf16 v84, v76, v63, v84
    v_dot2_f32_bf16 v85, v77, v63, v85
    v_dot2_f32_bf16 v84, v78, v63, v84
    v_dot2_f32_bf16 v85, v79, v63, v85
    v_dot2_f32_bf16 v84, v80, v63, v84
    v_dot2_f32_bf16 v85, v81, v63, v85
    v_dot2_f32_bf16 v84, v82, v63, v84
    v_dot2_f32_bf16 v85, v83, v63, v85
    s_nop 2
    v_add_f32 v84, v84, v85
    s_nop 1
    v_add_f32_dpp v84, v84, v84 row_ror:8 row_mask:0xf bank_mask:0xf
    s_nop 1
    v_add_f32_dpp v84, v84, v84 row_ror:4 row_mask:0xf bank_mask:0xf
    s_nop 1
    v_add_f32_dpp v84, v84, v84 row_ror:2 row_mask:0xf bank_mask:0xf
    s_nop 1
    v_add_f32_dpp v84, v84, v84 row_ror:1 row_mask:0xf bank_mask:0xf
    v_mul_f32 v84, 0x3acccccd, v84
    v_cvt_pk_bf16_f32 v85, v84, v84
    v_lshlrev_b32 v86, 16, v85
    v_sub_f32 v84, v84, v86
    v_cvt_pk_bf16_f32 v84, v84, v84
    v_cmp_eq_u32 vcc, 0, v61
    s_nop 1
    v_cndmask_b32 v84, v84, v85, vcc
    s_mov_b32 exec_lo, 0x30003
    s_mov_b32 exec_hi, 0x30003
    buffer_store_short v84, v60, s[16:19], s28 offen sc1
    s_mov_b64 exec, -1
    s_waitcnt vmcnt(6)
    s_barrier
    global_load_dwordx2 v[42:43], v40, s[80:81] sc1
    s_add_u32 s41, s5, 16
    s_sub_u32 s42, s41, 20
    s_cselect_b32 s41, s41, s42
    s_cselect_b32 s31, 20, 54
    s_cselect_b32 s32, 0, 1048576
    s_mul_i32 s28, s41, 37
    s_lshr_b32 s28, s28, 8
    s_mul_i32 s29, s28, 28
    s_lshl_b32 s33, s41, 2
    s_sub_u32 s29, s33, s29
    s_lshr_b32 s29, 0x4392108, s29
    s_bitcmp1_b32 s29, 3
    s_cselect_b32 s33, 2, 5
    s_mul_i32 s28, s28, s33
    s_cselect_b32 s33, 0, 16
    s_and_b32 s29, s29, 7
    s_add_u32 s33, s33, s28
    s_add_u32 s33, s33, s29
    s_cmp_eq_u32 s32, 0
    s_cselect_b32 s33, s41, s33
    s_mul_i32 s31, s31, s3
    s_add_u32 s31, s31, s33
    s_mul_i32 s31, s31, 5120
    s_add_u32 s31, s31, s32
    s_add_u32 s31, s31, 25165824
    v_lshrrev_b32 v8, 5, v1
    v_lshlrev_b32 v8, 4, v8
    v_bfe_u32 v9, v1, 2, 3
    v_add_u32 v8, v8, v9
    v_mul_u32_u24 v8, 1280, v8
    v_add_u32 v8, 40960, v8
    v_lshlrev_b32 v9, 1, v9
    v_and_b32 v10, 3, v1
    s_mul_i32 s28, s3, 10
    v_add_u32 v11, s28, v10
    v_xor_b32 v12, v11, v9
    v_lshl_add_u32 v12, v12, 4, v8
    v_add_u32 v11, 4, v11
    v_xor_b32 v13, v11, v9
    v_lshl_add_u32 v13, v13, 4, v8
    v_lshrrev_b32 v11, 1, v10
    s_add_u32 s28, s28, 8
    v_add_u32 v11, s28, v11
    v_xor_b32 v14, v11, v9
    v_lshl_add_u32 v14, v14, 4, v8
    v_and_b32 v10, 1, v1
    v_lshl_add_u32 v14, v10, 3, v14
    v_lshlrev_b32 v15, 4, v1
    ds_read_b64_tr_b16 v[16:17], v12 offset:0
    ds_read_b64_tr_b16 v[18:19], v12 offset:10240
    ds_read_b64_tr_b16 v[20:21], v12 offset:8
    ds_read_b64_tr_b16 v[22:23], v12 offset:10248
    ds_read_b64_tr_b16 v[24:25], v13 offset:0
    ds_read_b64_tr_b16 v[26:27], v13 offset:10240
    ds_read_b64_tr_b16 v[28:29], v13 offset:8
    ds_read_b64_tr_b16 v[30:31], v13 offset:10248
    ds_read_b64_tr_b16 v[32:33], v14 offset:0
    ds_read_b64_tr_b16 v[34:35], v14 offset:10240
    s_waitcnt lgkmcnt(8)
    buffer_store_dwordx4 v[16:19], v15, s[16:19], s31 offen offset:0 sc1
    s_waitcnt lgkmcnt(6)
    buffer_store_dwordx4 v[20:23], v15, s[16:19], s31 offen offset:1024 sc1
    s_waitcnt lgkmcnt(4)
    buffer_store_dwordx4 v[24:27], v15, s[16:19], s31 offen offset:2048 sc1
    s_waitcnt lgkmcnt(2)
    buffer_store_dwordx4 v[28:31], v15, s[16:19], s31 offen offset:3072 sc1
    s_waitcnt lgkmcnt(0)
    s_add_u32 s31, s31, 4096
    buffer_store_dwordx4 v[32:35], v15, s[16:19], s31 offen offset:0 sc1
    v_lshrrev_b32 v60, 4, v1
    v_and_b32 v61, 15, v1
    v_mul_u32_u24 v62, 1280, v60
    v_lshl_add_u32 v62, v61, 4, v62
    s_mul_i32 s28, s3, 5120
    s_add_u32 s28, s28, 40960
    v_add_u32 v62, s28, v62
    v_mov_b32 v63, 0x3f803f80
    ds_read_b128 v[64:67], v62 offset:0
    ds_read_b128 v[68:71], v62 offset:256
    ds_read_b128 v[72:75], v62 offset:512
    ds_read_b128 v[76:79], v62 offset:768
    ds_read_b128 v[80:83], v62 offset:1024
    s_lshl_b32 s28, s41, 7
    s_lshr_b32 s29, s44, 1
    s_lshl_b32 s29, s29, 5
    s_add_u32 s28, s28, s29
    s_and_b32 s29, s44, 1
    s_lshl_b32 s29, s29, 3
    s_add_u32 s28, s28, s29
    s_add_u32 s28, s28, 8617984
    s_cmp_eq_u32 s32, 0
    s_cselect_b32 s28, s28, 2146435072
    v_lshlrev_b32 v60, 1, v60
    v_lshl_add_u32 v60, v61, 4, v60
    s_waitcnt lgkmcnt(0)
    v_dot2_f32_bf16 v84, v64, v63, 0
    v_dot2_f32_bf16 v85, v65, v63, 0
    v_dot2_f32_bf16 v84, v66, v63, v84
    v_dot2_f32_bf16 v85, v67, v63, v85
    v_dot2_f32_bf16 v84, v68, v63, v84
    v_dot2_f32_bf16 v85, v69, v63, v85
    v_dot2_f32_bf16 v84, v70, v63, v84
    v_dot2_f32_bf16 v85, v71, v63, v85
    v_dot2_f32_bf16 v84, v72, v63, v84
    v_dot2_f32_bf16 v85, v73, v63, v85
    v_dot2_f32_bf16 v84, v74, v63, v84
    v_dot2_f32_bf16 v85, v75, v63, v85
    v_dot2_f32_bf16 v84, v76, v63, v84
    v_dot2_f32_bf16 v85, v77, v63, v85
    v_dot2_f32_bf16 v84, v78, v63, v84
    v_dot2_f32_bf16 v85, v79, v63, v85
    v_dot2_f32_bf16 v84, v80, v63, v84
    v_dot2_f32_bf16 v85, v81, v63, v85
    v_dot2_f32_bf16 v84, v82, v63, v84
    v_dot2_f32_bf16 v85, v83, v63, v85
    s_nop 2
    v_add_f32 v84, v84, v85
    s_nop 1
    v_add_f32_dpp v84, v84, v84 row_ror:8 row_mask:0xf bank_mask:0xf
    s_nop 1
    v_add_f32_dpp v84, v84, v84 row_ror:4 row_mask:0xf bank_mask:0xf
    s_nop 1
    v_add_f32_dpp v84, v84, v84 row_ror:2 row_mask:0xf bank_mask:0xf
    s_nop 1
    v_add_f32_dpp v84, v84, v84 row_ror:1 row_mask:0xf bank_mask:0xf
    v_mul_f32 v84, 0x3acccccd, v84
    v_cvt_pk_bf16_f32 v85, v84, v84
    v_lshlrev_b32 v86, 16, v85
    v_sub_f32 v84, v84, v86
    v_cvt_pk_bf16_f32 v84, v84, v84
    v_cmp_eq_u32 vcc, 0, v61
    s_nop 1
    v_cndmask_b32 v84, v84, v85, vcc
    s_mov_b32 exec_lo, 0x30003
    s_mov_b32 exec_hi, 0x30003
    buffer_store_short v84, v60, s[16:19], s28 offen sc1
    s_mov_b64 exec, -1
    s_add_u32 s41, s5, 32
    s_sub_u32 s42, s41, 20
    s_cselect_b32 s41, s41, s42
    s_cselect_b32 s8, s68, s76
    s_cselect_b32 s9, s69, s77
    s_cselect_b32 s10, 20, 24
    s_cselect_b32 s30, s44, s44
    s_mul_i32 s10, s10, 40960
    s_mov_b32 s11, 0x00020000
    s_lshl_b32 s31, s41, 3
    s_add_u32 s30, s30, s31
    s_mul_i32 s30, s30, 5120
    s_and_b32 s28, s3, 1
    s_lshl_b32 s28, s28, 2
    s_mul_i32 s29, s3, 5120
    s_add_u32 s29, s29, 81920
    v_add_u32 v8, 0, v1
    v_mul_u32_u24 v9, 205, v8
    v_lshrrev_b32 v9, 14, v9
    v_add_u32 v9, s28, v9
    v_lshlrev_b32 v9, 1, v9
    v_xor_b32 v8, v8, v9
    v_lshlrev_b32 v8, 4, v8
    s_add_u32 m0, s29, 0
    s_nop 0
    buffer_load_dwordx4 v8, s[8:11], s30 offen lds
    v_add_u32 v8, 64, v1
    v_mul_u32_u24 v9, 205, v8
    v_lshrrev_b32 v9, 14, v9
    v_add_u32 v9, s28, v9
    v_lshlrev_b32 v9, 1, v9
    v_xor_b32 v8, v8, v9
    v_lshlrev_b32 v8, 4, v8
    s_add_u32 m0, s29, 1024
    s_nop 0
    buffer_load_dwordx4 v8, s[8:11], s30 offen lds
    v_add_u32 v8, 128, v1
    v_mul_u32_u24 v9, 205, v8
    v_lshrrev_b32 v9, 14, v9
    v_add_u32 v9, s28, v9
    v_lshlrev_b32 v9, 1, v9
    v_xor_b32 v8, v8, v9
    v_lshlrev_b32 v8, 4, v8
    s_add_u32 m0, s29, 2048
    s_nop 0
    buffer_load_dwordx4 v8, s[8:11], s30 offen lds
    v_add_u32 v8, 192, v1
    v_mul_u32_u24 v9, 205, v8
    v_lshrrev_b32 v9, 14, v9
    v_add_u32 v9, s28, v9
    v_lshlrev_b32 v9, 1, v9
    v_xor_b32 v8, v8, v9
    v_lshlrev_b32 v8, 4, v8
    s_add_u32 m0, s29, 3072
    s_nop 0
    buffer_load_dwordx4 v8, s[8:11], s30 offen lds
    v_add_u32 v8, 256, v1
    v_mul_u32_u24 v9, 205, v8
    v_lshrrev_b32 v9, 14, v9
    v_add_u32 v9, s28, v9
    v_lshlrev_b32 v9, 1, v9
    v_xor_b32 v8, v8, v9
    v_lshlrev_b32 v8, 4, v8
    s_add_u32 m0, s29, 4096
    s_nop 0
    buffer_load_dwordx4 v8, s[8:11], s30 offen lds
    s_waitcnt vmcnt(11)
    s_max_i32 s87, s87, 100
    s_branch sequentia_t15
sequentia_n13:
    global_load_dwordx2 v[42:43], v40, s[80:81] sc1
    s_waitcnt vmcnt(0)
sequentia_t15:
    v_readfirstlane_b32 s84, v42
    v_readfirstlane_b32 s85, v43
    s_sub_u32 s87, s87, 1
    s_cbranch_scc1 sequentia_d14
    s_cmp_eq_u32 s84, 0
    s_cbranch_scc1 sequentia_n13
sequentia_d14:
    s_waitcnt vmcnt(5)
    s_barrier
    s_lshl_b32 s28, s5, 3
    s_add_u32 s28, s28, 8527872
    s_cmp_eq_u32 s3, 0
    s_cselect_b32 s28, s28, 2146435072
    v_lshlrev_b32 v4, 7, v1
    s_mov_b64 exec, 3
    buffer_store_dwordx2 v[42:43], v4, s[16:19], s28 offen sc1
    s_mov_b64 exec, -1
    s_waitcnt vmcnt(1)
    s_barrier
    s_add_u32 s41, s5, 32
    s_sub_u32 s42, s41, 20
    s_cselect_b32 s41, s41, s42
    s_cselect_b32 s31, 20, 54
    s_cselect_b32 s32, 0, 1048576
    s_mul_i32 s28, s41, 37
    s_lshr_b32 s28, s28, 8
    s_mul_i32 s29, s28, 28
    s_lshl_b32 s33, s41, 2
    s_sub_u32 s29, s33, s29
    s_lshr_b32 s29, 0x4392108, s29
    s_bitcmp1_b32 s29, 3
    s_cselect_b32 s33, 2, 5
    s_mul_i32 s28, s28, s33
    s_cselect_b32 s33, 0, 16
    s_and_b32 s29, s29, 7
    s_add_u32 s33, s33, s28
    s_add_u32 s33, s33, s29
    s_cmp_eq_u32 s32, 0
    s_cselect_b32 s33, s41, s33
    s_mul_i32 s31, s31, s3
    s_add_u32 s31, s31, s33
    s_mul_i32 s31, s31, 5120
    s_add_u32 s31, s31, s32
    s_add_u32 s31, s31, 25165824
    s_cmp_lt_u32 s41, 24
    s_cselect_b32 s31, s31, 2146435072
    v_lshrrev_b32 v8, 5, v1
    v_lshlrev_b32 v8, 4, v8
    v_bfe_u32 v9, v1, 2, 3
    v_add_u32 v8, v8, v9
    v_mul_u32_u24 v8, 1280, v8
    v_add_u32 v8, 81920, v8
    v_lshlrev_b32 v9, 1, v9
    v_and_b32 v10, 3, v1
    s_mul_i32 s28, s3, 10
    v_add_u32 v11, s28, v10
    v_xor_b32 v12, v11, v9
    v_lshl_add_u32 v12, v12, 4, v8
    v_add_u32 v11, 4, v11
    v_xor_b32 v13, v11, v9
    v_lshl_add_u32 v13, v13, 4, v8
    v_lshrrev_b32 v11, 1, v10
    s_add_u32 s28, s28, 8
    v_add_u32 v11, s28, v11
    v_xor_b32 v14, v11, v9
    v_lshl_add_u32 v14, v14, 4, v8
    v_and_b32 v10, 1, v1
    v_lshl_add_u32 v14, v10, 3, v14
    v_lshlrev_b32 v15, 4, v1
    ds_read_b64_tr_b16 v[16:17], v12 offset:0
    ds_read_b64_tr_b16 v[18:19], v12 offset:10240
    ds_read_b64_tr_b16 v[20:21], v12 offset:8
    ds_read_b64_tr_b16 v[22:23], v12 offset:10248
    ds_read_b64_tr_b16 v[24:25], v13 offset:0
    ds_read_b64_tr_b16 v[26:27], v13 offset:10240
    ds_read_b64_tr_b16 v[28:29], v13 offset:8
    ds_read_b64_tr_b16 v[30:31], v13 offset:10248
    ds_read_b64_tr_b16 v[32:33], v14 offset:0
    ds_read_b64_tr_b16 v[34:35], v14 offset:10240
    s_waitcnt lgkmcnt(8)
    buffer_store_dwordx4 v[16:19], v15, s[16:19], s31 offen offset:0 sc1
    s_waitcnt lgkmcnt(6)
    buffer_store_dwordx4 v[20:23], v15, s[16:19], s31 offen offset:1024 sc1
    s_waitcnt lgkmcnt(4)
    buffer_store_dwordx4 v[24:27], v15, s[16:19], s31 offen offset:2048 sc1
    s_waitcnt lgkmcnt(2)
    buffer_store_dwordx4 v[28:31], v15, s[16:19], s31 offen offset:3072 sc1
    s_waitcnt lgkmcnt(0)
    s_add_u32 s31, s31, 4096
    buffer_store_dwordx4 v[32:35], v15, s[16:19], s31 offen offset:0 sc1
    s_waitcnt vmcnt(0)
    s_barrier
    s_lshl_b32 s28, s5, 3
    s_add_u32 s28, s28, 8527872
    s_cmp_eq_u32 s3, 0
    s_cselect_b32 s28, s28, 2146435072
    v_lshlrev_b32 v4, 7, v1
    s_mov_b64 exec, 4
    buffer_store_dwordx2 v[42:43], v4, s[16:19], s28 offen sc1
    s_mov_b64 exec, -1
    s_mov_b32 s26, 2146435072
    s_mov_b32 s27, 2146435072
    s_lshl_b32 s53, s3, 5
    s_lshr_b32 s28, s2, 3
    s_add_u32 s53, s53, s28
    s_cmp_lt_u32 s53, 1
    s_cselect_b32 s28, 0, 2146435072
    s_lshl_b32 s53, s53, 13
    s_and_b32 s29, s2, 7
    s_mul_i32 s29, s29, 1310720
    s_add_u32 s53, s53, s29
    s_add_u32 s53, s53, 13991936
    s_max_u32 s53, s53, s28
    buffer_load_dword v46, v4, s[16:19], s53 offen
    s_cmp_ge_u32 s3, 4
    s_cbranch_scc1 k1_join
    s_branch k2_setup
k2_first:
    s_waitcnt lgkmcnt(4)
    v_mfma_f32_32x32x16_bf16 v[64:79], v[32:35], v[212:215], 0
    buffer_load_dwordx4 v4, s[16:19], s20 offen sc1 lds
    s_add_u32 m0, s21, 135488
    s_add_u32 s20, s20, 4096
    ds_read_b128 v[56:59], v220 offset:1024
    ds_read_b128 v[60:63], v221 offset:1024
    s_waitcnt lgkmcnt(4)
    v_mfma_f32_32x32x16_bf16 v[192:207], v[40:43], v[212:215], 0
    buffer_load_dwordx4 v4, s[16:19], s20 offen sc1 lds
    s_add_u32 m0, s21, 143744
    s_add_u32 s20, s20, 4096
    v_mfma_f32_32x32x16_bf16 v[64:79], v[36:39], v[216:219], v[64:79]
    ds_read_b128 v[32:35], v220 offset:1536
    ds_read_b128 v[36:39], v221 offset:1536
    buffer_load_dwordx4 v4, s[16:19], s20 offen sc1 lds
    s_waitcnt lgkmcnt(4)
    v_mfma_f32_32x32x16_bf16 v[80:95], v[48:51], v[212:215], 0
    buffer_load_dwordx4 v[236:239], v244, s[16:19], 0 offen sc1
    s_and_b32 s20, s4, 7
    s_mul_i32 s20, s20, 102400
    s_add_u32 s20, s20, 25165824
    s_add_u32 s21, s21, 98304
pg_7:
    s_cbranch_execz pg_ret
    s_add_u32 s31, s20, s21
    s_add_u32 s28, s21, 8515584
    s_add_u32 s29, s21, 57344
    s_cmp_lt_u32 s3, 4
    s_cselect_b32 s31, s31, s28
    s_cselect_b32 s21, s21, s29
    s_mul_i32 s28, s3, 12288
    s_add_u32 s28, s28, 0
    s_add_u32 s20, s20, s28
    s_mov_b32 m0, s28
    v_mfma_f32_32x32x16_bf16 v[192:207], v[44:47], v[216:219], v[192:207]
    ds_read_b128 v[40:43], v220 offset:2048
    ds_read_b128 v[44:47], v221 offset:2048
    s_waitcnt lgkmcnt(4)
    v_mfma_f32_32x32x16_bf16 v[96:111], v[56:59], v[212:215], 0
    v_mfma_f32_32x32x16_bf16 v[80:95], v[52:55], v[216:219], v[80:95]
    ds_read_b128 v[48:51], v220 offset:2560
    ds_read_b128 v[52:55], v221 offset:2560
    s_waitcnt lgkmcnt(4)
    v_mfma_f32_32x32x16_bf16 v[112:127], v[32:35], v[212:215], 0
    v_mfma_f32_32x32x16_bf16 v[96:111], v[60:63], v[216:219], v[96:111]
    ds_read_b128 v[56:59], v220 offset:3072
    ds_read_b128 v[60:63], v221 offset:3072
    s_waitcnt lgkmcnt(4)
    v_mfma_f32_32x32x16_bf16 v[128:143], v[40:43], v[212:215], 0
    v_mfma_f32_32x32x16_bf16 v[112:127], v[36:39], v[216:219], v[112:127]
    ds_read_b128 v[32:35], v220 offset:3584
    ds_read_b128 v[36:39], v221 offset:3584
    s_waitcnt lgkmcnt(4)
    v_mfma_f32_32x32x16_bf16 v[144:159], v[48:51], v[212:215], 0
    v_mfma_f32_32x32x16_bf16 v[128:143], v[44:47], v[216:219], v[128:143]
    s_waitcnt lgkmcnt(2)
    v_mfma_f32_32x32x16_bf16 v[160:175], v[56:59], v[212:215], 0
    v_mfma_f32_32x32x16_bf16 v[144:159], v[52:55], v[216:219], v[144:159]
    s_waitcnt lgkmcnt(0)
    v_mfma_f32_32x32x16_bf16 v[176:191], v[32:35], v[212:215], 0
    v_mfma_f32_32x32x16_bf16 v[160:175], v[60:63], v[216:219], v[160:175]
    v_mfma_f32_32x32x16_bf16 v[176:191], v[36:39], v[216:219], v[176:191]
    s_cmp_ge_u32 s3, 8
    s_cbranch_scc1 k2_nofix
    v_mov_b32 v64, 0xf149f2ca
    v_mov_b32 v65, 0xf149f2ca
    v_mov_b32 v66, 0xf149f2ca
    v_mov_b32 v67, 0xf149f2ca
    v_mov_b32 v68, 0xf149f2ca
    v_mov_b32 v69, 0xf149f2ca
    v_mov_b32 v70, 0xf149f2ca
    v_mov_b32 v71, 0xf149f2ca
    v_mov_b32 v72, 0xf149f2ca
    v_mov_b32 v73, 0xf149f2ca
    v_mov_b32 v74, 0xf149f2ca
    v_mov_b32 v75, 0xf149f2ca
    v_mov_b32 v76, 0xf149f2ca
    v_mov_b32 v77, 0xf149f2ca
    v_mov_b32 v78, 0xf149f2ca
    v_mov_b32 v79, 0xf149f2ca
    s_cmp_ge_u32 s3, 7
    s_cbranch_scc1 k2_nofix
    v_mov_b32 v80, 0xf149f2ca
    v_mov_b32 v81, 0xf149f2ca
    v_mov_b32 v82, 0xf149f2ca
    v_mov_b32 v83, 0xf149f2ca
    v_mov_b32 v84, 0xf149f2ca
    v_mov_b32 v85, 0xf149f2ca
    v_mov_b32 v86, 0xf149f2ca
    v_mov_b32 v87, 0xf149f2ca
    v_mov_b32 v88, 0xf149f2ca
    v_mov_b32 v89, 0xf149f2ca
    v_mov_b32 v90, 0xf149f2ca
    v_mov_b32 v91, 0xf149f2ca
    v_mov_b32 v92, 0xf149f2ca
    v_mov_b32 v93, 0xf149f2ca
    v_mov_b32 v94, 0xf149f2ca
    v_mov_b32 v95, 0xf149f2ca
    s_cmp_ge_u32 s3, 6
    s_cbranch_scc1 k2_nofix
    v_mov_b32 v96, 0xf149f2ca
    v_mov_b32 v97, 0xf149f2ca
    v_mov_b32 v98, 0xf149f2ca
    v_mov_b32 v99, 0xf149f2ca
    v_mov_b32 v100, 0xf149f2ca
    v_mov_b32 v101, 0xf149f2ca
    v_mov_b32 v102, 0xf149f2ca
    v_mov_b32 v103, 0xf149f2ca
    v_mov_b32 v104, 0xf149f2ca
    v_mov_b32 v105, 0xf149f2ca
    v_mov_b32 v106, 0xf149f2ca
    v_mov_b32 v107, 0xf149f2ca
    v_mov_b32 v108, 0xf149f2ca
    v_mov_b32 v109, 0xf149f2ca
    v_mov_b32 v110, 0xf149f2ca
    v_mov_b32 v111, 0xf149f2ca
    s_cmp_ge_u32 s3, 5
    s_cbranch_scc1 k2_nofix
    v_mov_b32 v112, 0xf149f2ca
    v_mov_b32 v113, 0xf149f2ca
    v_mov_b32 v114, 0xf149f2ca
    v_mov_b32 v115, 0xf149f2ca
    v_mov_b32 v116, 0xf149f2ca
    v_mov_b32 v117, 0xf149f2ca
    v_mov_b32 v118, 0xf149f2ca
    v_mov_b32 v119, 0xf149f2ca
    v_mov_b32 v120, 0xf149f2ca
    v_mov_b32 v121, 0xf149f2ca
    v_mov_b32 v122, 0xf149f2ca
    v_mov_b32 v123, 0xf149f2ca
    v_mov_b32 v124, 0xf149f2ca
    v_mov_b32 v125, 0xf149f2ca
    v_mov_b32 v126, 0xf149f2ca
    v_mov_b32 v127, 0xf149f2ca
    s_cmp_ge_u32 s3, 4
    s_cbranch_scc1 k2_nofix
    v_mov_b32 v128, 0xf149f2ca
    v_mov_b32 v129, 0xf149f2ca
    v_mov_b32 v130, 0xf149f2ca
    v_mov_b32 v131, 0xf149f2ca
    v_mov_b32 v132, 0xf149f2ca
    v_mov_b32 v133, 0xf149f2ca
    v_mov_b32 v134, 0xf149f2ca
    v_mov_b32 v135, 0xf149f2ca
    v_mov_b32 v136, 0xf149f2ca
    v_mov_b32 v137, 0xf149f2ca
    v_mov_b32 v138, 0xf149f2ca
    v_mov_b32 v139, 0xf149f2ca
    v_mov_b32 v140, 0xf149f2ca
    v_mov_b32 v141, 0xf149f2ca
    v_mov_b32 v142, 0xf149f2ca
    v_mov_b32 v143, 0xf149f2ca
    s_cmp_ge_u32 s3, 3
    s_cbranch_scc1 k2_nofix
    v_mov_b32 v144, 0xf149f2ca
    v_mov_b32 v145, 0xf149f2ca
    v_mov_b32 v146, 0xf149f2ca
    v_mov_b32 v147, 0xf149f2ca
    v_mov_b32 v148, 0xf149f2ca
    v_mov_b32 v149, 0xf149f2ca
    v_mov_b32 v150, 0xf149f2ca
    v_mov_b32 v151, 0xf149f2ca
    v_mov_b32 v152, 0xf149f2ca
    v_mov_b32 v153, 0xf149f2ca
    v_mov_b32 v154, 0xf149f2ca
    v_mov_b32 v155, 0xf149f2ca
    v_mov_b32 v156, 0xf149f2ca
    v_mov_b32 v157, 0xf149f2ca
    v_mov_b32 v158, 0xf149f2ca
    v_mov_b32 v159, 0xf149f2ca
    s_cmp_ge_u32 s3, 2
    s_cbranch_scc1 k2_nofix
    v_mov_b32 v160, 0xf149f2ca
    v_mov_b32 v161, 0xf149f2ca
    v_mov_b32 v162, 0xf149f2ca
    v_mov_b32 v163, 0xf149f2ca
    v_mov_b32 v164, 0xf149f2ca
    v_mov_b32 v165, 0xf149f2ca
    v_mov_b32 v166, 0xf149f2ca
    v_mov_b32 v167, 0xf149f2ca
    v_mov_b32 v168, 0xf149f2ca
    v_mov_b32 v169, 0xf149f2ca
    v_mov_b32 v170, 0xf149f2ca
    v_mov_b32 v171, 0xf149f2ca
    v_mov_b32 v172, 0xf149f2ca
    v_mov_b32 v173, 0xf149f2ca
    v_mov_b32 v174, 0xf149f2ca
    v_mov_b32 v175, 0xf149f2ca
    s_cmp_ge_u32 s3, 1
    s_cbranch_scc1 k2_nofix
    v_mov_b32 v176, 0xf149f2ca
    v_mov_b32 v177, 0xf149f2ca
    v_mov_b32 v178, 0xf149f2ca
    v_mov_b32 v179, 0xf149f2ca
    v_mov_b32 v180, 0xf149f2ca
    v_mov_b32 v181, 0xf149f2ca
    v_mov_b32 v182, 0xf149f2ca
    v_mov_b32 v183, 0xf149f2ca
    v_mov_b32 v184, 0xf149f2ca
    v_mov_b32 v185, 0xf149f2ca
    v_mov_b32 v186, 0xf149f2ca
    v_mov_b32 v187, 0xf149f2ca
    v_mov_b32 v188, 0xf149f2ca
    v_mov_b32 v189, 0xf149f2ca
    v_mov_b32 v190, 0xf149f2ca
    v_mov_b32 v191, 0xf149f2ca
k2_nofix:
    v_cndmask_b32 v64, v64, v192, s[32:33]
    v_cndmask_b32 v65, v65, v193, s[34:35]
    v_cndmask_b32 v66, v66, v194, s[36:37]
    v_cndmask_b32 v67, v67, v195, s[38:39]
    v_cndmask_b32 v68, v68, v196, s[40:41]
    v_cndmask_b32 v69, v69, v197, s[42:43]
    v_cndmask_b32 v70, v70, v198, s[44:45]
    v_cndmask_b32 v71, v71, v199, s[46:47]
    v_cndmask_b32 v72, v72, v200, s[48:49]
    v_cndmask_b32 v73, v73, v201, s[50:51]
    v_cndmask_b32 v74, v74, v202, s[52:53]
    v_cndmask_b32 v75, v75, v203, s[54:55]
    v_cndmask_b32 v76, v76, v204, s[56:57]
    v_cndmask_b32 v77, v77, v205, s[58:59]
    v_cndmask_b32 v78, v78, v206, s[60:61]
    v_cndmask_b32 v79, v79, v207, s[62:63]
    v_max_f32 v208, v64, v65
    v_max_f32 v209, v66, v67
    v_max_f32 v210, v68, v69
    v_max_f32 v211, v70, v71
    v_max3_f32 v208, v208, v72, v73
    v_max3_f32 v209, v209, v74, v75
    v_max3_f32 v210, v210, v76, v77
    v_max3_f32 v211, v211, v78, v79
    v_max3_f32 v208, v208, v80, v81
    v_max3_f32 v209, v209, v82, v83
    v_max3_f32 v210, v210, v84, v85
    v_max3_f32 v211, v211, v86, v87
    v_max3_f32 v208, v208, v88, v89
    v_max3_f32 v209, v209, v90, v91
    v_max3_f32 v210, v210, v92, v93
    v_max3_f32 v211, v211, v94, v95
    v_max3_f32 v208, v208, v96, v97
    v_max3_f32 v209, v209, v98, v99
    v_max3_f32 v210, v210, v100, v101
    v_max3_f32 v211, v211, v102, v103
    v_max3_f32 v208, v208, v104, v105
    v_max3_f32 v209, v209, v106, v107
    v_max3_f32 v210, v210, v108, v109
    v_max3_f32 v211, v211, v110, v111
    v_max3_f32 v208, v208, v112, v113
    v_max3_f32 v209, v209, v114, v115
    v_max3_f32 v210, v210, v116, v117
    v_max3_f32 v211, v211, v118, v119
    v_max3_f32 v208, v208, v120, v121
    v_max3_f32 v209, v209, v122, v123
    v_max3_f32 v210, v210, v124, v125
    v_max3_f32 v211, v211, v126, v127
    v_max3_f32 v208, v208, v128, v129
    v_max3_f32 v209, v209, v130, v131
    v_max3_f32 v210, v210, v132, v133
    v_max3_f32 v211, v211, v134, v135
    v_max3_f32 v208, v208, v136, v137
    v_max3_f32 v209, v209, v138, v139
    v_max3_f32 v210, v210, v140, v141
    v_max3_f32 v211, v211, v142, v143
    v_max3_f32 v208, v208, v144, v145
    v_max3_f32 v209, v209, v146, v147
    v_max3_f32 v210, v210, v148, v149
    v_max3_f32 v211, v211, v150, v151
    v_max3_f32 v208, v208, v152, v153
    v_max3_f32 v209, v209, v154, v155
    v_max3_f32 v210, v210, v156, v157
    v_max3_f32 v211, v211, v158, v159
    v_max3_f32 v208, v208, v160, v161
    v_max3_f32 v209, v209, v162, v163
    v_max3_f32 v210, v210, v164, v165
    v_max3_f32 v211, v211, v166, v167
    v_max3_f32 v208, v208, v168, v169
    v_max3_f32 v209, v209, v170, v171
    v_max3_f32 v210, v210, v172, v173
    v_max3_f32 v211, v211, v174, v175
    v_max3_f32 v208, v208, v176, v177
    v_max3_f32 v209, v209, v178, v179
    v_max3_f32 v210, v210, v180, v181
    v_max3_f32 v211, v211, v182, v183
    v_max3_f32 v208, v208, v184, v185
    v_max3_f32 v209, v209, v186, v187
    v_max3_f32 v210, v210, v188, v189
    v_max3_f32 v211, v211, v190, v191
    s_branch k2_back
k2_xw:
    s_max_i32 s87, s87, 100
    buffer_load_dwordx4 v[236:239], v244, s[16:19], 0 offen sc1
    s_branch sequentia_t24
sequentia_p22:
    s_sleep 8
    buffer_load_dwordx4 v[236:239], v244, s[16:19], 0 offen sc1
sequentia_t24:
    s_waitcnt vmcnt(0)
    v_cmp_ne_u64 vcc, s[84:85], v[236:237]
    v_cmp_ne_u64 s[88:89], s[84:85], v[238:239]
    s_nop 1
    s_lshr_b64 s[88:89], s[88:89], 32
    s_or_b64 vcc, vcc, s[88:89]
    s_sub_u32 s87, s87, 1
    s_cbranch_scc1 sequentia_d23
    s_cbranch_vccnz sequentia_p22
sequentia_d23:
    s_branch k2_xb
sequentia_s25:
    buffer_store_dwordx4 v[212:215], v5, s[16:19], s22 offen sc1
    s_mov_b32 exec_hi, 0
    buffer_store_dwordx2 v[216:217], v6, s[16:19], s23 offen sc1
    s_mov_b32 exec_hi, -1
    s_branch sequentia_b26
sequentia_s27:
    s_mov_b64 exec, 1
    buffer_store_dwordx2 v[252:253], v9, s[16:19], s28 offen sc1
    s_mov_b64 exec, -1
    s_branch sequentia_b28
sequentia_s32:
    buffer_store_dwordx4 v[64:67], v5, s[16:19], s34 offen sc1
    buffer_store_dwordx4 v[68:71], v5, s[16:19], s34 offen offset:2048 sc1
    buffer_store_dwordx2 v[72:73], v9, s[16:19], s36 offen sc1
    s_branch sequentia_b33
sequentia_s34:
    s_mov_b64 exec, 0xffff
    buffer_store_dwordx4 v[240:243], v6, s[16:19], s37 offen sc1
    s_mov_b64 exec, -1
    s_branch sequentia_b35
sequentia_s39:
    s_mov_b64 exec, 1
    buffer_store_dwordx2 v[252:253], v9, s[16:19], s37 offen offset:1024 sc1
    s_mov_b64 exec, -1
    s_branch sequentia_b40
sequentia_s41:
    s_mov_b64 exec, 1
    buffer_store_dwordx2 v[252:253], v9, s[16:19], s37 offen sc1
    s_mov_b64 exec, -1
    s_branch sequentia_b42
sequentia_s43:
    s_mov_b64 exec, 1
    buffer_store_dwordx2 v[208:209], v9, s[16:19], s28 offen sc1
    s_mov_b64 exec, -1
    s_branch sequentia_b44
sequential_preLN__sliding_block__glu_gated_reglu__prompt_kernel_done:
    s_endpgm
code_end:
.section .rodata,"a"
.p2align 6
.amdhsa_kernel sequential_preLN__sliding_block__glu_gated_reglu__prompt_kernel
  .amdhsa_next_free_vgpr 256
  .amdhsa_next_free_sgpr 102
  .amdhsa_accum_offset 256
  .amdhsa_group_segment_fixed_size 0
  .amdhsa_kernarg_size 80
  .amdhsa_user_sgpr_count 2
  .amdhsa_user_sgpr_kernarg_segment_ptr 1
  .amdhsa_system_sgpr_workgroup_id_x 1
.end_amdhsa_kernel
```
